```python
import torch

def _softmax(x, axis=-1):
    return torch.softmax(x, dim=axis)
def _gelu(x):
    return torch.nn.functional.gelu(x, approximate="tanh")
def _silu(x):
    return torch.nn.functional.silu(x)
def _sigmoid(x):
    return torch.sigmoid(x)
def _layernorm(x, axis=-1, eps=1e-5):
    m = x.mean(dim=axis, keepdim=True)
    v = x.var(dim=axis, keepdim=True, unbiased=False)
    return (x - m) / torch.sqrt(v + eps)
def _scatter_add(tgt, idx, src, axis=0):
    return tgt.clone().index_add_(axis, idx, src)
def _segment_sum(src, seg, n):
    out = torch.zeros((n,) + src.shape[1:], dtype=src.dtype)
    return out.index_add_(0, seg, src)
def _pad(x, pw):
    flat = tuple(v for pair in reversed(pw) for v in pair)
    return torch.nn.functional.pad(x, flat)

kernel_name = 'interleave_layers__sliding_local_dilated__dense_activation_gelu__prompt'

def setup_inputs():

    _w = (lambda a: (lambda t: t.to(torch.bfloat16) if t.is_floating_point() else t)(torch.as_tensor(a)))
    def _A_setup():
        B, S, D = 1, 2048, 576
        return {
            "x": _w((lambda *s: torch.randn(*s, dtype=torch.bfloat16) * 0.05)(B, S, D)),
            "wqkv": _w((lambda *s: torch.randn(*s, dtype=torch.bfloat16) * 0.05)(D, 3 * D)),
            "wo": _w((lambda *s: torch.randn(*s, dtype=torch.bfloat16) * 0.05)(D, D)),
        }
    _A_in = _A_setup()

    def _B_setup():
        B, S, D, F = 1, 2048, 576, 4608
        return {
            "x": _w((lambda *s: torch.randn(*s, dtype=torch.bfloat16) * 0.05)(B, S, D)),
            "w1": _w((lambda *s: torch.randn(*s, dtype=torch.bfloat16) * 0.8)(D, F) * (D ** -0.5)),
            "b1": _w((lambda *s: torch.randn(*s, dtype=torch.bfloat16) * 0.8)(F) * 0.01),
            "w2": _w((lambda *s: torch.randn(*s, dtype=torch.bfloat16) * 0.8)(F, D) * (F ** -0.5)),
            "b2": _w((lambda *s: torch.randn(*s, dtype=torch.bfloat16) * 0.8)(D) * 0.01),
        }
    _B_in = _B_setup()

    return {
        "A_x": _A_in["x"],
        "A_wqkv": _A_in["wqkv"],
        "A_wo": _A_in["wo"],
        "B_x": _B_in["x"],
        "B_w1": _B_in["w1"],
        "B_b1": _B_in["b1"],
        "B_w2": _B_in["w2"],
        "B_b2": _B_in["b2"],
    }

def reference(A_x, A_wqkv, A_wo, B_x, B_w1, B_b1, B_w2, B_b2):
    def _A_ref(x, wqkv, wo):
        B, S, D = x.shape
        H = 32; Dh = D // H
        W, dil = 8, 2
        qkv = (lambda x, *d: x.permute(*d))((x @ wqkv).reshape(B, S, 3, H, Dh), 2, 0, 3, 1, 4)
        q, k, v = qkv[0], qkv[1], qkv[2]
        scale = Dh ** -0.5
        pos = torch.arange(S)
        off = torch.arange(W) * dil
        idx = pos[:, None] - off[None, :]
        mask = idx >= 0
        idx_c = torch.where(mask, idx, 0).reshape(-1)
        kg = k[:, :, idx_c, :].reshape(B, H, S, W, Dh)
        vg = v[:, :, idx_c, :].reshape(B, H, S, W, Dh)
        logits = torch.einsum("bhsd,bhswd->bhsw", q, kg) * scale
        logits = torch.where(mask[None, None, :, :], logits, -1e9)
        attn = _softmax(logits, axis=-1)
        o = torch.einsum("bhsw,bhswd->bhsd", attn, vg)
        return (lambda x, *d: x.permute(*d))(o, 0, 2, 1, 3).reshape(B, S, D) @ wo

    def _B_ref(x, w1, b1, w2, b2):
        h = torch.einsum("bsd,df->bsf", x, w1) + b1
        h = _gelu(h)
        return torch.einsum("bsf,fd->bsd", h, w2) + b2

    x = A_x
    x = x + _A_ref(_layernorm(x, axis=-1), A_wqkv, A_wo)
    x = x + _B_ref(_layernorm(x, axis=-1), B_w1, B_b1, B_w2, B_b2)
    x = x + _A_ref(_layernorm(x, axis=-1), A_wqkv, A_wo)
    x = x + _B_ref(_layernorm(x, axis=-1), B_w1, B_b1, B_w2, B_b2)
    return x
```

```asm
; @launch kernel=k0_kernel grid=(256,1,1) block=(768,1,1) lds=41984
; @launch kernel=km_kernel grid=(256,1,1) block=(256,1,1) lds=157184
.amdgcn_target "amdgcn-amd-amdhsa--gfx950"
.text
.p2align 8
CODE_START:
.globl k0_kernel
.p2align 8
.type k0_kernel,@function
k0_kernel:
    s_cmp_ge_u32 s2, 256
    s_cbranch_scc1 K0_end
    s_load_dwordx8 s[16:23], s[0:1], 0
    s_load_dwordx2 s[32:33], s[0:1], 80
    v_lshrrev_b32 v1, 6, v0
    v_and_b32 v2, 63, v0
    v_readfirstlane_b32 s3, v1
    s_nop 3
    s_cmp_ge_u32 s3, 9
    s_cbranch_scc1 K1_side
    v_lshrrev_b32 v9, 3, v0
    v_and_b32 v10, 7, v0
    s_lshl_b32 s5, s2, 3
    v_add_u32 v4, s5, v10
    v_mul_u32_u24 v12, 1152, v4
    v_lshl_add_u32 v12, v9, 4, v12
    s_lshr_b32 s5, s2, 2
    s_mul_i32 s5, s5, 36864
    v_and_b32 v4, 31, v4
    v_lshlrev_b32 v4, 4, v4
    v_lshl_add_u32 v11, v9, 9, v4
    v_add_u32 v11, s5, v11
    v_mul_u32_u24 v14, 48, v10
    s_lshl_b32 s5, s3, 2
    v_add_u32 v13, s5, v14
    v_bfe_u32 v3, v2, 2, 3
    v_lshrrev_b32 v4, 5, v2
    v_and_b32 v5, 3, v2
    v_lshlrev_b32 v6, 4, v5
    v_lshl_add_u32 v6, v4, 6, v6
    v_lshlrev_b32 v8, 4, v2
    s_mul_i32 s4, s2, 19
    s_lshr_b32 s4, s4, 9
    s_mul_i32 s5, s4, 27
    s_sub_u32 s5, s2, s5
    s_lshl_b32 s6, s4, 3
    s_add_u32 s6, s6, s3
    s_mul_i32 s6, s6, 27648
    s_lshl_b32 s7, s5, 7
    s_add_u32 s40, s6, s7
    v_mul_u32_u24 v16, 3456, v3
    v_add_u32 v16, v16, v6
    s_lshl_b32 s43, s3, 10
    s_sub_u32 s44, s2, 175
    s_mul_i32 s45, s44, 57
    s_lshr_b32 s45, s45, 9
    s_mul_i32 s46, s45, 9
    s_sub_u32 s46, s44, s46
    s_lshl_b32 s6, s45, 3
    s_add_u32 s6, s6, s3
    s_mul_i32 s7, s6, 57
    s_lshr_b32 s7, s7, 9
    s_mul_i32 s34, s7, 9
    s_sub_u32 s34, s6, s34
    s_mul_i32 s7, s7, 72
    s_lshr_b32 s6, s34, 2
    s_mul_i32 s6, s6, 36
    s_bfe_u32 s35, s34, 0x10001
    s_mul_i32 s35, s35, 20
    s_add_u32 s6, s6, s35
    s_and_b32 s35, s34, 1
    s_lshl_b32 s35, s35, 3
    s_add_u32 s6, s6, s35
    s_cmp_eq_u32 s34, 8
    s_cselect_b32 s6, 16, s6
    s_cselect_b32 s35, 32, 0
    s_add_u32 s6, s6, s7
    s_mul_i32 s6, s6, 1152
    s_lshl_b32 s7, s46, 7
    s_add_u32 s41, s6, s7
    v_bfe_u32 v17, v2, 4, 1
    v_mul_u32_u24 v17, s35, v17
    v_add_u32 v17, v17, v3
    v_mul_u32_u24 v17, 1152, v17
    v_add_u32 v17, v17, v6
    s_waitcnt lgkmcnt(0)
    s_mov_b32 s8, s32
    s_mov_b32 s9, s33
    s_mov_b32 s10, 117440512
    s_mov_b32 s11, 0x00020000
    s_mov_b32 s12, s16
    s_mov_b32 s13, s17
    s_mov_b32 s14, 2359296
    s_mov_b32 s15, 0x00020000
    s_mov_b32 s36, s18
    s_mov_b32 s37, s19
    s_mov_b32 s38, 1990656
    s_mov_b32 s39, 0x00020000
    s_mov_b32 s48, s20
    s_mov_b32 s49, s21
    s_mov_b32 s50, 663552
    s_mov_b32 s51, 0x00020000
    buffer_load_dwordx4 v[56:59], v12, s[12:15], 0 offen nt
    s_cmp_eq_u32 s3, 8
    s_cbranch_scc1 K0_pf
    s_cmp_ge_u32 s2, 243
    s_cbranch_scc1 K0_nq
    s_add_u32 m0, s43, 1024
    s_nop 0
    buffer_load_dwordx4 v16, s[36:39], s40 offen nt lds
K0_nq:
    s_cmp_lt_u32 s2, 175
    s_cbranch_scc1 K0_ln
    s_add_u32 m0, s43, 9216
    s_nop 0
    buffer_load_dwordx4 v17, s[48:51], s41 offen nt lds
    s_branch K0_ln
K0_pf:
    v_mov_b32 v28, 0
    v_mov_b32 v29, 0
    v_mov_b32 v30, 0
    v_mov_b32 v31, 0
    v_lshrrev_b32 v27, 3, v2
    s_cmp_lt_u32 s2, 64
    s_cselect_b32 s6, 2, 99
    v_cmp_eq_u32 vcc, s6, v27
    s_nop 1
    v_cndmask_b32 v28, 0, 1, vcc
    v_cndmask_b32 v29, 0, 1, vcc
    v_cndmask_b32 v30, 0, 1, vcc
    v_cndmask_b32 v31, 0, 1, vcc
    s_and_b32 s6, s2, 63
    s_mul_i32 s6, s6, 4352
    s_bfe_u32 s7, s2, 0x10006
    s_mul_i32 s7, s7, 50331648
    s_add_u32 s6, s6, s7
    s_add_u32 s6, s6, 9699328
    s_sub_u32 s7, s2, 128
    s_lshl_b32 s7, s7, 10
    s_add_u32 s7, s7, 116916224
    s_cmp_ge_u32 s2, 128
    s_cselect_b32 s6, s7, s6
    s_cmp_gt_u32 s2, 131
    s_cbranch_scc1 K0_noclr
    buffer_store_dwordx4 v[28:31], v8, s[8:11], s6 offen
K0_noclr:
    s_nop 1
    v_mov_b32 v28, 0
    v_mov_b32 v29, 0
    v_mov_b32 v30, 0
    v_mov_b32 v31, 0
    s_cmp_ge_u32 s2, 72
    s_cbranch_scc1 K0_nopad
    v_lshrrev_b32 v26, 4, v2
    v_mul_u32_u24 v26, 7168, v26
    v_bfe_u32 v27, v2, 2, 2
    v_lshl_add_u32 v26, v27, 8, v26
    v_lshl_add_u32 v26, v5, 4, v26
    s_mul_i32 s6, s2, 28672
    s_add_u32 s6, s6, 100669632
    buffer_store_dwordx4 v[28:31], v26, s[8:11], s6 offen
K0_nopad:
    s_lshr_b32 s6, s2, 7
    s_mul_i32 s6, s6, 50331648
    s_bfe_u32 s7, s2, 0x60001
    s_mul_i32 s34, s7, 36864
    s_and_b32 s35, s2, 1
    s_mul_i32 s35, s35, 18432
    s_add_u32 s34, s34, s35
    s_add_u32 s34, s34, s6
    s_add_u32 s34, s34, 4722688
    v_and_b32 v27, 31, v2
    v_lshlrev_b32 v27, 4, v27
    v_mul_u32_u24 v26, 4608, v4
    v_add_u32 v27, v27, v26
    buffer_store_dwordx4 v[28:31], v27, s[8:11], s34 offen sc1
    s_add_u32 s34, s34, 9216
    buffer_store_dwordx4 v[28:31], v27, s[8:11], s34 offen sc1
    s_and_b32 s34, s2, 127
    s_mul_i32 s34, s34, 768
    s_add_u32 s34, s34, s6
    s_add_u32 s34, s34, 9437184
    v_min_u32 v27, 752, v8
    buffer_store_dwordx4 v[28:31], v27, s[8:11], s34 offen sc1
    s_getpc_b64 s[52:53]
K0_pc:
    s_sub_u32 s52, s52, K0_pc-CODE_START
    s_subb_u32 s53, s53, 0
    s_lshr_b32 s6, s2, 3
    s_lshl_b32 s6, s6, 11
    v_add_u32 v16, s6, v8
    s_mov_b32 s6, CODE_END-CODE_START-16
    v_min_u32 v17, s6, v16
    global_load_dwordx4 v[32:35], v17, s[52:53]
    v_add_u32 v16, 1024, v16
    v_min_u32 v17, s6, v16
    global_load_dwordx4 v[36:39], v17, s[52:53]
K0_ln:
    v_lshrrev_b32 v18, 4, v2
    v_bfe_u32 v19, v2, 2, 2
    v_lshlrev_b32 v20, 6, v19
    v_lshl_add_u32 v20, v18, 10, v20
    s_lshr_b32 s6, s3, 2
    s_lshl_b32 s7, s6, 12
    s_bfe_u32 s34, s3, 0x10001
    s_lshl_b32 s35, s34, 9
    s_add_u32 s7, s7, s35
    s_and_b32 s35, s3, 1
    s_lshl_b32 s42, s35, 5
    s_add_u32 s42, s42, s7
    v_lshl_add_u32 v21, v5, 3, v20
    v_add_u32 v21, s42, v21
    s_lshl_b32 s42, s35, 3
    s_add_u32 s42, s42, s7
    v_lshl_add_u32 v22, v5, 4, v20
    v_add_u32 v22, s42, v22
    s_lshl_b32 s7, s5, 4
    s_and_b32 s42, s3, 3
    s_lshl_b32 s42, s42, 2
    s_add_u32 s7, s7, s42
    v_add_u32 v49, s7, v19
    v_mul_u32_u24 v50, 57, v49
    v_lshrrev_b32 v50, 13, v50
    v_mul_u32_u24 v51, 144, v50
    v_sub_u32 v51, v49, v51
    v_mul_u32_u24 v52, 57, v51
    v_lshrrev_b32 v52, 9, v52
    v_mul_u32_u24 v53, 9, v52
    v_sub_u32 v53, v51, v53
    v_mul_u32_u24 v50, 9, v50
    v_add_u32 v50, v50, v53
    v_mul_u32_u24 v52, 129024, v52
    v_lshrrev_b32 v53, 2, v50
    v_lshl_add_u32 v52, v53, 10, v52
    v_and_b32 v53, 3, v50
    v_lshl_add_u32 v52, v53, 6, v52
    v_lshl_add_u32 v52, v18, 8, v52
    v_lshl_add_u32 v52, v5, 4, v52
    s_lshl_b32 s7, s4, 1
    s_add_u32 s7, s7, s6
    s_mul_i32 s7, s7, 7168
    s_add_u32 s54, s7, 100663296
    s_lshl_b32 s7, s46, 1
    s_add_u32 s7, s7, s34
    s_mul_i32 s42, s7, 43
    s_lshr_b32 s42, s42, 7
    s_mul_i32 s55, s42, 3
    s_sub_u32 s7, s7, s55
    s_mul_i32 s42, s42, 110592
    s_lshl_b32 s7, s7, 1
    s_add_u32 s7, s7, s35
    s_lshl_b32 s55, s45, 1
    s_add_u32 s55, s55, s6
    s_mul_i32 s55, s55, 6
    s_add_u32 s7, s7, s55
    s_lshl_b32 s7, s7, 10
    s_add_u32 s42, s42, s7
    s_add_u32 s55, s42, 102760448
    s_waitcnt vmcnt(5)
    s_cmp_eq_u32 s3, 8
    s_cbranch_scc1 K0_w8
    s_waitcnt vmcnt(0)
K0_w8:
    s_mov_b32 s7, 2359296
    buffer_store_dwordx4 v[56:59], v11, s[8:11], s7 offen sc1
    v_lshlrev_b32 v60, 16, v56
    v_and_b32 v61, 0xffff0000, v56
    v_lshlrev_b32 v62, 16, v57
    v_and_b32 v63, 0xffff0000, v57
    v_lshlrev_b32 v64, 16, v58
    v_and_b32 v65, 0xffff0000, v58
    v_lshlrev_b32 v66, 16, v59
    v_and_b32 v67, 0xffff0000, v59
    v_add_f32 v72, v60, v61
    v_add_f32 v72, v72, v62
    v_add_f32 v72, v72, v63
    v_add_f32 v72, v72, v64
    v_add_f32 v72, v72, v65
    v_add_f32 v72, v72, v66
    v_add_f32 v72, v72, v67
    s_nop 1
    v_add_f32_dpp v72, v72, v72 row_ror:8 row_mask:0xf bank_mask:0xf
    v_mov_b32 v73, v72
    s_nop 1
    v_permlane16_swap_b32 v72, v73
    v_add_f32 v72, v72, v73
    v_mov_b32 v73, v72
    s_nop 1
    v_permlane32_swap_b32 v72, v73
    v_add_f32 v72, v72, v73
    ds_write_b32 v13, v72 offset:0
    s_waitcnt lgkmcnt(0)
    s_barrier
    ds_read_b128 v[76:79], v14 offset:0
    ds_read_b128 v[80:83], v14 offset:16
    ds_read_b32 v84, v14 offset:32
    s_waitcnt lgkmcnt(0)
    v_add_f32 v72, v76, v77
    v_add_f32 v72, v72, v78
    v_add_f32 v72, v72, v79
    v_add_f32 v72, v72, v80
    v_add_f32 v72, v72, v81
    v_add_f32 v72, v72, v82
    v_add_f32 v72, v72, v83
    v_add_f32 v72, v72, v84
    s_cmp_eq_u32 s3, 8
    s_cbranch_scc1 K0_r2
    s_cmp_ge_u32 s2, 243
    s_cbranch_scc1 K0_r1
    ds_read_b64_tr_b16 v[24:25], v21 offset:1024
    ds_read_b64_tr_b16 v[26:27], v21 offset:1280
    s_waitcnt lgkmcnt(0)
    buffer_store_dwordx4 v[24:27], v52, s[8:11], s54 offen
K0_r1:
    s_cmp_lt_u32 s2, 175
    s_cbranch_scc1 K0_r2
    ds_read_b64_tr_b16 v[28:29], v22 offset:9216
    ds_read_b64_tr_b16 v[30:31], v22 offset:9472
    s_waitcnt lgkmcnt(0)
    buffer_store_dwordx4 v[28:31], v8, s[8:11], s55 offen sc1
K0_r2:
    v_mul_f32 v74, 0x3ae38e39, v72
    v_sub_f32 v86, v60, v74
    v_sub_f32 v87, v61, v74
    v_sub_f32 v88, v62, v74
    v_sub_f32 v89, v63, v74
    v_sub_f32 v90, v64, v74
    v_sub_f32 v91, v65, v74
    v_sub_f32 v92, v66, v74
    v_sub_f32 v93, v67, v74
    v_mul_f32 v72, v86, v86
    v_fmac_f32 v72, v87, v87
    v_fmac_f32 v72, v88, v88
    v_fmac_f32 v72, v89, v89
    v_fmac_f32 v72, v90, v90
    v_fmac_f32 v72, v91, v91
    v_fmac_f32 v72, v92, v92
    v_fmac_f32 v72, v93, v93
    s_nop 1
    v_add_f32_dpp v72, v72, v72 row_ror:8 row_mask:0xf bank_mask:0xf
    v_mov_b32 v73, v72
    s_nop 1
    v_permlane16_swap_b32 v72, v73
    v_add_f32 v72, v72, v73
    v_mov_b32 v73, v72
    s_nop 1
    v_permlane32_swap_b32 v72, v73
    v_add_f32 v72, v72, v73
    ds_write_b32 v13, v72 offset:512
    s_waitcnt lgkmcnt(0)
    s_barrier
    ds_read_b128 v[76:79], v14 offset:512
    ds_read_b128 v[80:83], v14 offset:528
    ds_read_b32 v84, v14 offset:544
    s_waitcnt lgkmcnt(0)
    v_add_f32 v72, v76, v77
    v_add_f32 v72, v72, v78
    v_add_f32 v72, v72, v79
    v_add_f32 v72, v72, v80
    v_add_f32 v72, v72, v81
    v_add_f32 v72, v72, v82
    v_add_f32 v72, v72, v83
    v_add_f32 v72, v72, v84
    v_mul_f32 v72, 0x3ae38e39, v72
    v_cvt_pk_bf16_f32 v73, v72, v72
    v_lshlrev_b32 v72, 16, v73
    v_add_f32 v72, 0x3727c5ac, v72
    v_cvt_pk_bf16_f32 v73, v72, v72
    v_lshlrev_b32 v72, 16, v73
    v_sqrt_f32 v72, v72
    s_nop 0
    v_cvt_pk_bf16_f32 v73, v72, v72
    v_lshlrev_b32 v72, 16, v73
    v_rcp_f32 v72, v72
    v_cvt_pk_bf16_f32 v73, v74, v74
    v_lshlrev_b32 v74, 16, v73
    v_sub_f32 v86, v60, v74
    v_sub_f32 v87, v61, v74
    v_sub_f32 v88, v62, v74
    v_sub_f32 v89, v63, v74
    v_sub_f32 v90, v64, v74
    v_sub_f32 v91, v65, v74
    v_sub_f32 v92, v66, v74
    v_sub_f32 v93, v67, v74
    v_cvt_pk_bf16_f32 v76, v86, v87
    v_cvt_pk_bf16_f32 v77, v88, v89
    v_cvt_pk_bf16_f32 v78, v90, v91
    v_cvt_pk_bf16_f32 v79, v92, v93
    v_lshlrev_b32 v86, 16, v76
    v_and_b32 v87, 0xffff0000, v76
    v_lshlrev_b32 v88, 16, v77
    v_and_b32 v89, 0xffff0000, v77
    v_lshlrev_b32 v90, 16, v78
    v_and_b32 v91, 0xffff0000, v78
    v_lshlrev_b32 v92, 16, v79
    v_and_b32 v93, 0xffff0000, v79
    v_mul_f32 v86, v86, v72
    v_mul_f32 v87, v87, v72
    v_mul_f32 v88, v88, v72
    v_mul_f32 v89, v89, v72
    v_mul_f32 v90, v90, v72
    v_mul_f32 v91, v91, v72
    v_mul_f32 v92, v92, v72
    v_mul_f32 v93, v93, v72
    v_cvt_pk_bf16_f32 v68, v86, v87
    v_cvt_pk_bf16_f32 v69, v88, v89
    v_cvt_pk_bf16_f32 v70, v90, v91
    v_cvt_pk_bf16_f32 v71, v92, v93
    buffer_store_dwordx4 v[68:71], v11, s[8:11], 0 offen offset:0 sc1
K0_end:
    s_endpgm
K1_side:
    s_load_dwordx2 s[56:57], s[0:1], 32
    s_load_dwordx2 s[58:59], s[0:1], 48
    v_lshlrev_b32 v4, 4, v2
    s_sub_u32 s3, s3, 9
    s_mul_i32 s4, s2, 3
    s_add_u32 s4, s4, s3
    s_lshl_b32 s43, s3, 13
    s_add_u32 s43, s43, 17408
    v_bfe_u32 v3, v2, 2, 3
    v_lshrrev_b32 v5, 5, v2
    v_and_b32 v6, 3, v2
    v_lshlrev_b32 v6, 4, v6
    v_lshl_add_u32 v6, v5, 6, v6
    v_mul_u32_u24 v8, 9216, v3
    v_add_u32 v8, v8, v6
    v_bfe_u32 v7, v2, 2, 2
    v_lshlrev_b32 v7, 6, v7
    v_add_u32 v7, s43, v7
    v_lshl_add_u32 v7, v5, 10, v7
    v_bfe_u32 v10, v2, 4, 1
    v_lshl_add_u32 v7, v10, 5, v7
    v_and_b32 v10, 1, v2
    v_lshl_add_u32 v7, v10, 4, v7
    v_bfe_u32 v10, v2, 1, 1
    v_lshl_add_u32 v7, v10, 3, v7
    s_mul_i32 s5, s4, 911
    s_lshr_b32 s5, s5, 16
    s_mul_i32 s6, s5, 72
    s_sub_u32 s6, s4, s6
    s_mul_i32 s40, s5, 589824
    s_lshl_b32 s7, s6, 7
    s_add_u32 s40, s40, s7
    s_waitcnt lgkmcnt(0)
    s_mov_b32 s8, s32
    s_mov_b32 s9, s33
    s_mov_b32 s10, 117440512
    s_mov_b32 s11, 0x00020000
    s_mov_b32 s36, s56
    s_mov_b32 s37, s57
    s_mov_b32 s38, 5308416
    s_mov_b32 s39, 0x00020000
    s_mov_b32 s44, s58
    s_mov_b32 s45, s59
    s_mov_b32 s46, 5308416
    s_mov_b32 s47, 0x00020000
    s_lshl_b32 s7, s6, 1
    s_mul_i32 s23, s7, 57
    s_lshr_b32 s23, s23, 9
    s_mul_i32 s24, s23, 9
    s_sub_u32 s24, s7, s24
    s_mul_i32 s23, s23, 331776
    s_add_u32 s23, s23, 103809024
    s_mul_i32 s25, s5, 12
    s_add_u32 s25, s25, s24
    s_mul_i32 s26, s24, 36
    s_lshl_b32 s27, s5, 2
    s_add_u32 s26, s26, s27
    s_cmp_lt_u32 s24, 3
    s_cselect_b32 s25, s25, s26
    s_cselect_b32 s50, 3, 1
    s_lshl_b32 s50, s50, 10
    s_lshl_b32 s25, s25, 10
    s_add_u32 s48, s23, s25
    s_lshl_b32 s7, s6, 1
    s_add_u32 s7, s7, 1
    s_mul_i32 s23, s7, 57
    s_lshr_b32 s23, s23, 9
    s_mul_i32 s24, s23, 9
    s_sub_u32 s24, s7, s24
    s_mul_i32 s23, s23, 331776
    s_add_u32 s23, s23, 103809024
    s_mul_i32 s25, s5, 12
    s_add_u32 s25, s25, s24
    s_mul_i32 s26, s24, 36
    s_lshl_b32 s27, s5, 2
    s_add_u32 s26, s26, s27
    s_cmp_lt_u32 s24, 3
    s_cselect_b32 s25, s25, s26
    s_cselect_b32 s51, 3, 1
    s_lshl_b32 s51, s51, 10
    s_lshl_b32 s25, s25, 10
    s_add_u32 s49, s23, s25
    v_mov_b32 v51, 0x3f803f80
    v_lshlrev_b32 v54, 2, v2
    s_lshl_b32 s28, s4, 8
    s_add_u32 s28, s28, 116391936
    s_cmp_ge_u32 s4, 648
    s_cbranch_scc1 K1_s5
    s_add_u32 m0, s43, 0
    s_nop 0
    buffer_load_dwordx4 v8, s[36:39], s40 offen nt lds
    s_add_u32 m0, s43, 1024
    s_add_u32 s40, s40, 73728
    buffer_load_dwordx4 v8, s[36:39], s40 offen nt lds
    s_add_u32 m0, s43, 2048
    s_add_u32 s40, s40, 73728
    buffer_load_dwordx4 v8, s[36:39], s40 offen nt lds
    s_add_u32 m0, s43, 3072
    s_add_u32 s40, s40, 73728
    buffer_load_dwordx4 v8, s[36:39], s40 offen nt lds
    s_add_u32 m0, s43, 4096
    s_add_u32 s40, s40, 73728
    buffer_load_dwordx4 v8, s[36:39], s40 offen nt lds
    s_add_u32 m0, s43, 5120
    s_add_u32 s40, s40, 73728
    buffer_load_dwordx4 v8, s[36:39], s40 offen nt lds
    s_add_u32 m0, s43, 6144
    s_add_u32 s40, s40, 73728
    buffer_load_dwordx4 v8, s[36:39], s40 offen nt lds
    s_add_u32 m0, s43, 7168
    s_add_u32 s40, s40, 73728
    buffer_load_dwordx4 v8, s[36:39], s40 offen nt lds
K1_s5:
    s_barrier
    s_barrier
    s_cmp_ge_u32 s4, 648
    s_cbranch_scc1 K1_s4
    s_waitcnt vmcnt(0)
    ds_read_b64_tr_b16 v[16:17], v7 offset:0
    ds_read_b64_tr_b16 v[18:19], v7 offset:256
    ds_read_b64_tr_b16 v[20:21], v7 offset:512
    ds_read_b64_tr_b16 v[22:23], v7 offset:768
    ds_read_b64_tr_b16 v[24:25], v7 offset:2048
    ds_read_b64_tr_b16 v[26:27], v7 offset:2304
    ds_read_b64_tr_b16 v[28:29], v7 offset:2560
    ds_read_b64_tr_b16 v[30:31], v7 offset:2816
    ds_read_b64_tr_b16 v[32:33], v7 offset:4096
    ds_read_b64_tr_b16 v[34:35], v7 offset:4352
    ds_read_b64_tr_b16 v[36:37], v7 offset:4608
    ds_read_b64_tr_b16 v[38:39], v7 offset:4864
    ds_read_b64_tr_b16 v[40:41], v7 offset:6144
    ds_read_b64_tr_b16 v[42:43], v7 offset:6400
    ds_read_b64_tr_b16 v[44:45], v7 offset:6656
    ds_read_b64_tr_b16 v[46:47], v7 offset:6912
    s_waitcnt lgkmcnt(0)
    buffer_store_dwordx4 v[16:19], v4, s[8:11], s48 offen sc1
    s_add_u32 s48, s48, s50
    v_dot2_f32_bf16 v52, v16, v51, 0
    v_dot2_f32_bf16 v52, v17, v51, v52
    v_dot2_f32_bf16 v52, v18, v51, v52
    v_dot2_f32_bf16 v52, v19, v51, v52
    buffer_store_dwordx4 v[20:23], v4, s[8:11], s49 offen sc1
    s_add_u32 s49, s49, s51
    v_dot2_f32_bf16 v53, v20, v51, 0
    v_dot2_f32_bf16 v53, v21, v51, v53
    v_dot2_f32_bf16 v53, v22, v51, v53
    v_dot2_f32_bf16 v53, v23, v51, v53
    buffer_store_dwordx4 v[24:27], v4, s[8:11], s48 offen sc1
    s_add_u32 s48, s48, s50
    v_dot2_f32_bf16 v52, v24, v51, v52
    v_dot2_f32_bf16 v52, v25, v51, v52
    v_dot2_f32_bf16 v52, v26, v51, v52
    v_dot2_f32_bf16 v52, v27, v51, v52
    buffer_store_dwordx4 v[28:31], v4, s[8:11], s49 offen sc1
    s_add_u32 s49, s49, s51
    v_dot2_f32_bf16 v53, v28, v51, v53
    v_dot2_f32_bf16 v53, v29, v51, v53
    v_dot2_f32_bf16 v53, v30, v51, v53
    v_dot2_f32_bf16 v53, v31, v51, v53
    buffer_store_dwordx4 v[32:35], v4, s[8:11], s48 offen sc1
    s_add_u32 s48, s48, s50
    v_dot2_f32_bf16 v52, v32, v51, v52
    v_dot2_f32_bf16 v52, v33, v51, v52
    v_dot2_f32_bf16 v52, v34, v51, v52
    v_dot2_f32_bf16 v52, v35, v51, v52
    buffer_store_dwordx4 v[36:39], v4, s[8:11], s49 offen sc1
    s_add_u32 s49, s49, s51
    v_dot2_f32_bf16 v53, v36, v51, v53
    v_dot2_f32_bf16 v53, v37, v51, v53
    v_dot2_f32_bf16 v53, v38, v51, v53
    v_dot2_f32_bf16 v53, v39, v51, v53
    buffer_store_dwordx4 v[40:43], v4, s[8:11], s48 offen sc1
    v_dot2_f32_bf16 v52, v40, v51, v52
    v_dot2_f32_bf16 v52, v41, v51, v52
    v_dot2_f32_bf16 v52, v42, v51, v52
    v_dot2_f32_bf16 v52, v43, v51, v52
    buffer_store_dwordx4 v[44:47], v4, s[8:11], s49 offen sc1
    v_dot2_f32_bf16 v53, v44, v51, v53
    v_dot2_f32_bf16 v53, v45, v51, v53
    v_dot2_f32_bf16 v53, v46, v51, v53
    v_dot2_f32_bf16 v53, v47, v51, v53
    s_nop 2
    v_permlane32_swap_b32 v52, v53
    v_add_f32 v52, v52, v53
    buffer_store_dword v52, v54, s[8:11], s28 offen
K1_s4:
    s_endpgm
.globl km_kernel
.p2align 8
.type km_kernel,@function
km_kernel:
    s_cmp_ge_u32 s2, 256
    s_cbranch_scc1 KM_end
    s_load_dwordx2 s[32:33], s[0:1], 80
    s_load_dwordx8 s[40:47], s[0:1], 40
    s_load_dwordx2 s[82:83], s[0:1], 32
    s_mov_b32 s60, 0
    s_mov_b32 s55, 0
    v_lshrrev_b32 v1, 6, v0
    v_and_b32 v0, 63, v0
    v_readfirstlane_b32 s3, v1
    v_lshlrev_b32 v1, 4, v0
    s_and_b32 s4, s2, 7
    s_lshr_b32 s5, s2, 3
    s_lshl_b32 s6, s4, 1
    s_and_b32 s7, s5, 1
    s_add_u32 s6, s6, s7
    s_lshr_b32 s7, s5, 1
    s_cselect_b32 s98, 1, 0
    s_lshl_b32 s16, s7, 2
    s_add_u32 s16, s16, s3
    s_mul_i32 s18, s3, 9216
    s_mul_i32 s17, s6, 331776
    s_add_u32 s17, s17, s18
    s_add_u32 s17, s17, 103809024
    s_lshr_b32 s31, s5, 2
    s_mul_i32 s67, s31, 3
    s_and_b32 s61, s5, 3
    s_add_u32 s67, s67, s61
    s_cmp_eq_u32 s61, 3
    s_cselect_b32 s61, 1, 0
    s_lshl_b32 s31, s31, 3
    s_add_u32 s31, s31, s4
    s_mul_i32 s64, s67, 43
    s_lshr_b32 s64, s64, 8
    s_mul_i32 s65, s64, 6
    s_sub_u32 s65, s67, s65
    s_lshl_b32 s66, s4, 2
    s_add_u32 s70, s66, s64
    s_lshl_b32 s64, s70, 2
    s_add_u32 s64, s64, s3
    s_lshr_b32 s66, s64, 1
    s_mul_i32 s66, s66, 36864
    s_and_b32 s67, s64, 1
    s_lshl_b32 s67, s67, 8
    s_add_u32 s66, s66, s67
    s_mul_i32 s71, s65, 110592
    s_mul_i32 s69, s3, 27648
    s_add_u32 s71, s71, s69
    s_add_u32 s71, s71, 102760448
    s_add_u32 s69, s69, 36864
    s_and_b32 s72, s4, 1
    s_lshl_b32 s72, s72, 3
    s_lshr_b32 s73, s5, 2
    s_add_u32 s72, s72, s73
    s_lshr_b32 s73, s4, 1
    s_lshl_b32 s73, s73, 2
    s_and_b32 s74, s5, 3
    s_add_u32 s73, s73, s74
    s_waitcnt lgkmcnt(0)
    s_mov_b32 s8, s32
    s_mov_b32 s9, s33
    s_mov_b32 s10, 117440512
    s_mov_b32 s11, 0x00020000
    s_mov_b32 s12, s32
    s_mov_b32 s13, s33
    s_mov_b32 s14, 117440512
    s_mov_b32 s15, 0x00020000
    s_mov_b32 s36, s42
    s_mov_b32 s37, s43
    s_mov_b32 s38, 5308416
    s_mov_b32 s39, 0x00020000
    s_mov_b32 s34, s40
    s_mov_b32 s35, s41
    s_branch KM_A1
KM_B:
    s_cmp_eq_u32 s61, 1
    s_cbranch_scc1 KM_Bskip
    v_lshrrev_b32 v5, 4, v0
    v_and_b32 v6, 15, v0
    v_lshlrev_b32 v4, 4, v6
    v_lshl_add_u32 v4, v5, 9, v4
    v_add_u32 v7, 36864, v1
    v_add_u32 v8, 102400, v1
    s_add_u32 s68, s66, 4718592
    s_mul_i32 s75, s65, 6144
    s_add_u32 s75, s75, s66
    v_lshlrev_b32 v9, 2, v6
    s_lshr_b32 s76, s70, 1
    s_mul_i32 s76, s76, 4352
    s_add_u32 s76, s76, 9699712
    s_cmp_lg_u32 s3, 0
    s_cbranch_scc1 KM_go_o
KM_spin_o:
    buffer_load_dword v10, v9, s[8:11], s76 offen sc1
    s_add_u32 s55, s55, 1
    s_waitcnt vmcnt(0)
    v_cmp_eq_u32 vcc, 0, v10
    s_cbranch_vccz KM_go_o
    s_sleep 6
    s_cmp_lt_u32 s55, 262144
    s_cbranch_scc1 KM_spin_o
KM_go_o:
    s_waitcnt vmcnt(0)
    s_barrier
KM_Bgo:
    buffer_load_dwordx4 v[16:19], v4, s[8:11], s68 offen offset:0 sc1
    buffer_load_dwordx4 v[20:23], v4, s[8:11], s68 offen offset:2048 sc1
    s_add_u32 s68, s68, 4096
    buffer_load_dwordx4 v[24:27], v4, s[8:11], s68 offen offset:0 sc1
    buffer_load_dwordx4 v[28:31], v4, s[8:11], s68 offen offset:2048 sc1
    s_add_u32 s68, s68, 4096
    buffer_load_dwordx4 v[32:35], v4, s[8:11], s68 offen offset:0 sc1
    buffer_load_dwordx4 v[36:39], v4, s[8:11], s68 offen offset:2048 sc1
    s_add_u32 s68, s68, 4096
    buffer_load_dwordx4 v[40:43], v4, s[8:11], s68 offen offset:0 sc1
    buffer_load_dwordx4 v[44:47], v4, s[8:11], s68 offen offset:2048 sc1
    s_add_u32 s68, s68, 4096
    buffer_load_dwordx4 v[48:51], v4, s[8:11], s68 offen offset:0 sc1
    buffer_load_dwordx4 v[52:55], v4, s[8:11], s68 offen offset:2048 sc1
    s_add_u32 s68, s68, 4096
    buffer_load_dwordx4 v[56:59], v4, s[8:11], s68 offen offset:0 sc1
    buffer_load_dwordx4 v[60:63], v4, s[8:11], s68 offen offset:2048 sc1
    s_add_u32 s68, s68, 4096
    buffer_load_dwordx4 v[64:67], v4, s[8:11], s68 offen offset:0 sc1
    buffer_load_dwordx4 v[68:71], v4, s[8:11], s68 offen offset:2048 sc1
    s_add_u32 s68, s68, 4096
    buffer_load_dwordx4 v[72:75], v4, s[8:11], s68 offen offset:0 sc1
    buffer_load_dwordx4 v[76:79], v4, s[8:11], s68 offen offset:2048 sc1
    s_add_u32 s68, s68, 4096
    buffer_load_dwordx4 v[80:83], v4, s[8:11], s68 offen offset:0 sc1
    buffer_load_dwordx4 v[84:87], v4, s[8:11], s68 offen offset:2048 sc1
    s_add_u32 s76, s75, 2359296
    s_add_u32 s77, s76, 4096
    buffer_load_dwordx4 v[160:163], v4, s[8:11], s76 offen sc1
    buffer_load_dwordx4 v[164:167], v4, s[8:11], s76 offen offset:2048 sc1
    buffer_load_dwordx4 v[168:171], v4, s[8:11], s77 offen sc1
    ds_read_b128 v[112:115], v7 offset:0
    ds_read_b128 v[116:119], v7 offset:1024
    ds_read_b128 v[120:123], v7 offset:2048
    ds_read_b128 v[124:127], v7 offset:3072
    ds_read_b128 v[128:131], v7 offset:4096
    ds_read_b128 v[132:135], v7 offset:5120
    ds_read_b128 v[136:139], v7 offset:6144
    ds_read_b128 v[140:143], v7 offset:7168
    ds_read_b128 v[144:147], v7 offset:8192
    ds_read_b128 v[148:151], v7 offset:9216
    ds_read_b128 v[152:155], v7 offset:10240
    ds_read_b128 v[156:159], v7 offset:11264
    s_waitcnt vmcnt(20) lgkmcnt(11)
    v_mfma_f32_16x16x32_bf16 v[88:91], v[112:115], v[16:19], 0
    ds_read_b128 v[112:115], v7 offset:12288
    s_waitcnt lgkmcnt(11)
    v_mfma_f32_16x16x32_bf16 v[92:95], v[116:119], v[16:19], 0
    ds_read_b128 v[116:119], v7 offset:13312
    s_waitcnt lgkmcnt(11)
    v_mfma_f32_16x16x32_bf16 v[96:99], v[120:123], v[16:19], 0
    ds_read_b128 v[120:123], v7 offset:14336
    s_waitcnt lgkmcnt(11)
    v_mfma_f32_16x16x32_bf16 v[100:103], v[124:127], v[16:19], 0
    ds_read_b128 v[124:127], v7 offset:15360
    s_waitcnt lgkmcnt(11)
    v_mfma_f32_16x16x32_bf16 v[104:107], v[128:131], v[16:19], 0
    ds_read_b128 v[128:131], v7 offset:16384
    s_waitcnt lgkmcnt(11)
    v_mfma_f32_16x16x32_bf16 v[108:111], v[132:135], v[16:19], 0
    ds_read_b128 v[132:135], v7 offset:17408
    s_waitcnt vmcnt(19) lgkmcnt(11)
    v_mfma_f32_16x16x32_bf16 v[88:91], v[136:139], v[20:23], v[88:91]
    ds_read_b128 v[136:139], v7 offset:18432
    s_waitcnt lgkmcnt(11)
    v_mfma_f32_16x16x32_bf16 v[92:95], v[140:143], v[20:23], v[92:95]
    ds_read_b128 v[140:143], v7 offset:19456
    s_waitcnt lgkmcnt(11)
    v_mfma_f32_16x16x32_bf16 v[96:99], v[144:147], v[20:23], v[96:99]
    ds_read_b128 v[144:147], v7 offset:20480
    s_waitcnt lgkmcnt(11)
    v_mfma_f32_16x16x32_bf16 v[100:103], v[148:151], v[20:23], v[100:103]
    ds_read_b128 v[148:151], v7 offset:21504
    s_waitcnt lgkmcnt(11)
    v_mfma_f32_16x16x32_bf16 v[104:107], v[152:155], v[20:23], v[104:107]
    ds_read_b128 v[152:155], v7 offset:22528
    s_waitcnt lgkmcnt(11)
    v_mfma_f32_16x16x32_bf16 v[108:111], v[156:159], v[20:23], v[108:111]
    ds_read_b128 v[156:159], v7 offset:23552
    s_waitcnt vmcnt(18) lgkmcnt(11)
    v_mfma_f32_16x16x32_bf16 v[88:91], v[112:115], v[24:27], v[88:91]
    ds_read_b128 v[112:115], v7 offset:24576
    s_waitcnt lgkmcnt(11)
    v_mfma_f32_16x16x32_bf16 v[92:95], v[116:119], v[24:27], v[92:95]
    ds_read_b128 v[116:119], v7 offset:25600
    s_waitcnt lgkmcnt(11)
    v_mfma_f32_16x16x32_bf16 v[96:99], v[120:123], v[24:27], v[96:99]
    ds_read_b128 v[120:123], v7 offset:26624
    s_waitcnt lgkmcnt(11)
    v_mfma_f32_16x16x32_bf16 v[100:103], v[124:127], v[24:27], v[100:103]
    ds_read_b128 v[124:127], v7 offset:27648
    s_waitcnt lgkmcnt(11)
    v_mfma_f32_16x16x32_bf16 v[104:107], v[128:131], v[24:27], v[104:107]
    ds_read_b128 v[128:131], v7 offset:28672
    s_waitcnt lgkmcnt(11)
    v_mfma_f32_16x16x32_bf16 v[108:111], v[132:135], v[24:27], v[108:111]
    ds_read_b128 v[132:135], v7 offset:29696
    s_waitcnt vmcnt(17) lgkmcnt(11)
    v_mfma_f32_16x16x32_bf16 v[88:91], v[136:139], v[28:31], v[88:91]
    ds_read_b128 v[136:139], v7 offset:30720
    s_waitcnt lgkmcnt(11)
    v_mfma_f32_16x16x32_bf16 v[92:95], v[140:143], v[28:31], v[92:95]
    ds_read_b128 v[140:143], v7 offset:31744
    s_waitcnt lgkmcnt(11)
    v_mfma_f32_16x16x32_bf16 v[96:99], v[144:147], v[28:31], v[96:99]
    ds_read_b128 v[144:147], v7 offset:32768
    s_waitcnt lgkmcnt(11)
    v_mfma_f32_16x16x32_bf16 v[100:103], v[148:151], v[28:31], v[100:103]
    ds_read_b128 v[148:151], v7 offset:33792
    s_waitcnt lgkmcnt(11)
    v_mfma_f32_16x16x32_bf16 v[104:107], v[152:155], v[28:31], v[104:107]
    ds_read_b128 v[152:155], v7 offset:34816
    s_waitcnt lgkmcnt(11)
    v_mfma_f32_16x16x32_bf16 v[108:111], v[156:159], v[28:31], v[108:111]
    ds_read_b128 v[156:159], v7 offset:35840
    s_waitcnt vmcnt(16) lgkmcnt(11)
    v_mfma_f32_16x16x32_bf16 v[88:91], v[112:115], v[32:35], v[88:91]
    ds_read_b128 v[112:115], v7 offset:36864
    s_waitcnt lgkmcnt(11)
    v_mfma_f32_16x16x32_bf16 v[92:95], v[116:119], v[32:35], v[92:95]
    ds_read_b128 v[116:119], v7 offset:37888
    s_waitcnt lgkmcnt(11)
    v_mfma_f32_16x16x32_bf16 v[96:99], v[120:123], v[32:35], v[96:99]
    ds_read_b128 v[120:123], v7 offset:38912
    s_waitcnt lgkmcnt(11)
    v_mfma_f32_16x16x32_bf16 v[100:103], v[124:127], v[32:35], v[100:103]
    ds_read_b128 v[124:127], v7 offset:39936
    s_waitcnt lgkmcnt(11)
    v_mfma_f32_16x16x32_bf16 v[104:107], v[128:131], v[32:35], v[104:107]
    ds_read_b128 v[128:131], v7 offset:40960
    s_waitcnt lgkmcnt(11)
    v_mfma_f32_16x16x32_bf16 v[108:111], v[132:135], v[32:35], v[108:111]
    ds_read_b128 v[132:135], v7 offset:41984
    s_waitcnt vmcnt(15) lgkmcnt(11)
    v_mfma_f32_16x16x32_bf16 v[88:91], v[136:139], v[36:39], v[88:91]
    s_add_u32 m0, s18, 0
    s_add_u32 s19, s17, 0
    ds_read_b128 v[136:139], v7 offset:43008
    s_waitcnt lgkmcnt(11)
    v_mfma_f32_16x16x32_bf16 v[92:95], v[140:143], v[36:39], v[92:95]
    ds_read_b128 v[140:143], v7 offset:44032
    s_waitcnt lgkmcnt(11)
    v_mfma_f32_16x16x32_bf16 v[96:99], v[144:147], v[36:39], v[96:99]
    ds_read_b128 v[144:147], v7 offset:45056
    s_waitcnt lgkmcnt(11)
    v_mfma_f32_16x16x32_bf16 v[100:103], v[148:151], v[36:39], v[100:103]
    ds_read_b128 v[148:151], v7 offset:46080
    s_waitcnt lgkmcnt(11)
    v_mfma_f32_16x16x32_bf16 v[104:107], v[152:155], v[36:39], v[104:107]
    ds_read_b128 v[152:155], v7 offset:47104
    s_waitcnt lgkmcnt(11)
    v_mfma_f32_16x16x32_bf16 v[108:111], v[156:159], v[36:39], v[108:111]
    ds_read_b128 v[156:159], v7 offset:48128
    s_waitcnt vmcnt(14) lgkmcnt(11)
    v_mfma_f32_16x16x32_bf16 v[88:91], v[112:115], v[40:43], v[88:91]
    buffer_load_dwordx4 v1, s[12:15], s19 offen offset:0 lds
    ds_read_b128 v[112:115], v7 offset:49152
    s_waitcnt lgkmcnt(11)
    v_mfma_f32_16x16x32_bf16 v[92:95], v[116:119], v[40:43], v[92:95]
    ds_read_b128 v[116:119], v7 offset:50176
    s_waitcnt lgkmcnt(11)
    v_mfma_f32_16x16x32_bf16 v[96:99], v[120:123], v[40:43], v[96:99]
    ds_read_b128 v[120:123], v7 offset:51200
    s_waitcnt lgkmcnt(11)
    v_mfma_f32_16x16x32_bf16 v[100:103], v[124:127], v[40:43], v[100:103]
    ds_read_b128 v[124:127], v7 offset:52224
    s_waitcnt lgkmcnt(11)
    v_mfma_f32_16x16x32_bf16 v[104:107], v[128:131], v[40:43], v[104:107]
    ds_read_b128 v[128:131], v7 offset:53248
    s_waitcnt lgkmcnt(11)
    v_mfma_f32_16x16x32_bf16 v[108:111], v[132:135], v[40:43], v[108:111]
    ds_read_b128 v[132:135], v7 offset:54272
    s_waitcnt vmcnt(14) lgkmcnt(11)
    v_mfma_f32_16x16x32_bf16 v[88:91], v[136:139], v[44:47], v[88:91]
    buffer_load_dwordx4 v1, s[12:15], s19 offen offset:1024 lds
    ds_read_b128 v[136:139], v7 offset:55296
    s_waitcnt lgkmcnt(11)
    v_mfma_f32_16x16x32_bf16 v[92:95], v[140:143], v[44:47], v[92:95]
    ds_read_b128 v[140:143], v7 offset:56320
    s_waitcnt lgkmcnt(11)
    v_mfma_f32_16x16x32_bf16 v[96:99], v[144:147], v[44:47], v[96:99]
    ds_read_b128 v[144:147], v7 offset:57344
    s_waitcnt lgkmcnt(11)
    v_mfma_f32_16x16x32_bf16 v[100:103], v[148:151], v[44:47], v[100:103]
    ds_read_b128 v[148:151], v7 offset:58368
    s_waitcnt lgkmcnt(11)
    v_mfma_f32_16x16x32_bf16 v[104:107], v[152:155], v[44:47], v[104:107]
    ds_read_b128 v[152:155], v7 offset:59392
    s_waitcnt lgkmcnt(11)
    v_mfma_f32_16x16x32_bf16 v[108:111], v[156:159], v[44:47], v[108:111]
    ds_read_b128 v[156:159], v7 offset:60416
    s_waitcnt vmcnt(14) lgkmcnt(11)
    v_mfma_f32_16x16x32_bf16 v[88:91], v[112:115], v[48:51], v[88:91]
    buffer_load_dwordx4 v1, s[12:15], s19 offen offset:2048 lds
    ds_read_b128 v[112:115], v7 offset:61440
    s_waitcnt lgkmcnt(11)
    v_mfma_f32_16x16x32_bf16 v[92:95], v[116:119], v[48:51], v[92:95]
    ds_read_b128 v[116:119], v7 offset:62464
    s_waitcnt lgkmcnt(11)
    v_mfma_f32_16x16x32_bf16 v[96:99], v[120:123], v[48:51], v[96:99]
    ds_read_b128 v[120:123], v7 offset:63488
    s_waitcnt lgkmcnt(11)
    v_mfma_f32_16x16x32_bf16 v[100:103], v[124:127], v[48:51], v[100:103]
    ds_read_b128 v[124:127], v7 offset:64512
    s_waitcnt lgkmcnt(11)
    v_mfma_f32_16x16x32_bf16 v[104:107], v[128:131], v[48:51], v[104:107]
    ds_read_b128 v[128:131], v8 offset:0
    s_waitcnt lgkmcnt(11)
    v_mfma_f32_16x16x32_bf16 v[108:111], v[132:135], v[48:51], v[108:111]
    ds_read_b128 v[132:135], v8 offset:1024
    s_waitcnt vmcnt(14) lgkmcnt(11)
    v_mfma_f32_16x16x32_bf16 v[88:91], v[136:139], v[52:55], v[88:91]
    buffer_load_dwordx4 v1, s[12:15], s19 offen offset:3072 lds
    ds_read_b128 v[136:139], v8 offset:2048
    s_waitcnt lgkmcnt(11)
    v_mfma_f32_16x16x32_bf16 v[92:95], v[140:143], v[52:55], v[92:95]
    ds_read_b128 v[140:143], v8 offset:3072
    s_waitcnt lgkmcnt(11)
    v_mfma_f32_16x16x32_bf16 v[96:99], v[144:147], v[52:55], v[96:99]
    ds_read_b128 v[144:147], v8 offset:4096
    s_waitcnt lgkmcnt(11)
    v_mfma_f32_16x16x32_bf16 v[100:103], v[148:151], v[52:55], v[100:103]
    ds_read_b128 v[148:151], v8 offset:5120
    s_waitcnt lgkmcnt(11)
    v_mfma_f32_16x16x32_bf16 v[104:107], v[152:155], v[52:55], v[104:107]
    ds_read_b128 v[152:155], v8 offset:6144
    s_waitcnt lgkmcnt(11)
    v_mfma_f32_16x16x32_bf16 v[108:111], v[156:159], v[52:55], v[108:111]
    ds_read_b128 v[156:159], v8 offset:7168
    s_waitcnt vmcnt(14) lgkmcnt(11)
    v_mfma_f32_16x16x32_bf16 v[88:91], v[112:115], v[56:59], v[88:91]
    s_add_u32 m0, s18, 4096
    s_add_u32 s19, s17, 4096
    ds_read_b128 v[112:115], v8 offset:8192
    s_waitcnt lgkmcnt(11)
    v_mfma_f32_16x16x32_bf16 v[92:95], v[116:119], v[56:59], v[92:95]
    ds_read_b128 v[116:119], v8 offset:9216
    s_waitcnt lgkmcnt(11)
    v_mfma_f32_16x16x32_bf16 v[96:99], v[120:123], v[56:59], v[96:99]
    ds_read_b128 v[120:123], v8 offset:10240
    s_waitcnt lgkmcnt(11)
    v_mfma_f32_16x16x32_bf16 v[100:103], v[124:127], v[56:59], v[100:103]
    ds_read_b128 v[124:127], v8 offset:11264
    s_waitcnt lgkmcnt(11)
    v_mfma_f32_16x16x32_bf16 v[104:107], v[128:131], v[56:59], v[104:107]
    ds_read_b128 v[128:131], v8 offset:12288
    s_waitcnt lgkmcnt(11)
    v_mfma_f32_16x16x32_bf16 v[108:111], v[132:135], v[56:59], v[108:111]
    ds_read_b128 v[132:135], v8 offset:13312
    s_waitcnt vmcnt(13) lgkmcnt(11)
    v_mfma_f32_16x16x32_bf16 v[88:91], v[136:139], v[60:63], v[88:91]
    buffer_load_dwordx4 v1, s[12:15], s19 offen offset:0 lds
    ds_read_b128 v[136:139], v8 offset:14336
    s_waitcnt lgkmcnt(11)
    v_mfma_f32_16x16x32_bf16 v[92:95], v[140:143], v[60:63], v[92:95]
    ds_read_b128 v[140:143], v8 offset:15360
    s_waitcnt lgkmcnt(11)
    v_mfma_f32_16x16x32_bf16 v[96:99], v[144:147], v[60:63], v[96:99]
    ds_read_b128 v[144:147], v8 offset:16384
    s_waitcnt lgkmcnt(11)
    v_mfma_f32_16x16x32_bf16 v[100:103], v[148:151], v[60:63], v[100:103]
    ds_read_b128 v[148:151], v8 offset:17408
    s_waitcnt lgkmcnt(11)
    v_mfma_f32_16x16x32_bf16 v[104:107], v[152:155], v[60:63], v[104:107]
    ds_read_b128 v[152:155], v8 offset:18432
    s_waitcnt lgkmcnt(11)
    v_mfma_f32_16x16x32_bf16 v[108:111], v[156:159], v[60:63], v[108:111]
    ds_read_b128 v[156:159], v8 offset:19456
    s_waitcnt vmcnt(13) lgkmcnt(11)
    v_mfma_f32_16x16x32_bf16 v[88:91], v[112:115], v[64:67], v[88:91]
    buffer_load_dwordx4 v1, s[12:15], s19 offen offset:1024 lds
    ds_read_b128 v[112:115], v8 offset:20480
    s_waitcnt lgkmcnt(11)
    v_mfma_f32_16x16x32_bf16 v[92:95], v[116:119], v[64:67], v[92:95]
    ds_read_b128 v[116:119], v8 offset:21504
    s_waitcnt lgkmcnt(11)
    v_mfma_f32_16x16x32_bf16 v[96:99], v[120:123], v[64:67], v[96:99]
    ds_read_b128 v[120:123], v8 offset:22528
    s_waitcnt lgkmcnt(11)
    v_mfma_f32_16x16x32_bf16 v[100:103], v[124:127], v[64:67], v[100:103]
    ds_read_b128 v[124:127], v8 offset:23552
    s_waitcnt lgkmcnt(11)
    v_mfma_f32_16x16x32_bf16 v[104:107], v[128:131], v[64:67], v[104:107]
    ds_read_b128 v[128:131], v8 offset:24576
    s_waitcnt lgkmcnt(11)
    v_mfma_f32_16x16x32_bf16 v[108:111], v[132:135], v[64:67], v[108:111]
    ds_read_b128 v[132:135], v8 offset:25600
    s_waitcnt vmcnt(13) lgkmcnt(11)
    v_mfma_f32_16x16x32_bf16 v[88:91], v[136:139], v[68:71], v[88:91]
    buffer_load_dwordx4 v1, s[12:15], s19 offen offset:2048 lds
    ds_read_b128 v[136:139], v8 offset:26624
    s_waitcnt lgkmcnt(11)
    v_mfma_f32_16x16x32_bf16 v[92:95], v[140:143], v[68:71], v[92:95]
    ds_read_b128 v[140:143], v8 offset:27648
    s_waitcnt lgkmcnt(11)
    v_mfma_f32_16x16x32_bf16 v[96:99], v[144:147], v[68:71], v[96:99]
    ds_read_b128 v[144:147], v8 offset:28672
    s_waitcnt lgkmcnt(11)
    v_mfma_f32_16x16x32_bf16 v[100:103], v[148:151], v[68:71], v[100:103]
    ds_read_b128 v[148:151], v8 offset:29696
    s_waitcnt lgkmcnt(11)
    v_mfma_f32_16x16x32_bf16 v[104:107], v[152:155], v[68:71], v[104:107]
    ds_read_b128 v[152:155], v8 offset:30720
    s_waitcnt lgkmcnt(11)
    v_mfma_f32_16x16x32_bf16 v[108:111], v[156:159], v[68:71], v[108:111]
    ds_read_b128 v[156:159], v8 offset:31744
    s_waitcnt vmcnt(13) lgkmcnt(11)
    v_mfma_f32_16x16x32_bf16 v[88:91], v[112:115], v[72:75], v[88:91]
    buffer_load_dwordx4 v1, s[12:15], s19 offen offset:3072 lds
    ds_read_b128 v[112:115], v8 offset:32768
    s_waitcnt lgkmcnt(11)
    v_mfma_f32_16x16x32_bf16 v[92:95], v[116:119], v[72:75], v[92:95]
    ds_read_b128 v[116:119], v8 offset:33792
    s_waitcnt lgkmcnt(11)
    v_mfma_f32_16x16x32_bf16 v[96:99], v[120:123], v[72:75], v[96:99]
    ds_read_b128 v[120:123], v8 offset:34816
    s_waitcnt lgkmcnt(11)
    v_mfma_f32_16x16x32_bf16 v[100:103], v[124:127], v[72:75], v[100:103]
    ds_read_b128 v[124:127], v8 offset:35840
    s_waitcnt lgkmcnt(11)
    v_mfma_f32_16x16x32_bf16 v[104:107], v[128:131], v[72:75], v[104:107]
    ds_read_b128 v[128:131], v8 offset:36864
    s_waitcnt lgkmcnt(11)
    v_mfma_f32_16x16x32_bf16 v[108:111], v[132:135], v[72:75], v[108:111]
    ds_read_b128 v[132:135], v8 offset:37888
    s_waitcnt vmcnt(13) lgkmcnt(11)
    v_mfma_f32_16x16x32_bf16 v[88:91], v[136:139], v[76:79], v[88:91]
    s_add_u32 m0, s18, 8192
    s_add_u32 s19, s17, 8192
    ds_read_b128 v[136:139], v8 offset:38912
    s_waitcnt lgkmcnt(11)
    v_mfma_f32_16x16x32_bf16 v[92:95], v[140:143], v[76:79], v[92:95]
    ds_read_b128 v[140:143], v8 offset:39936
    s_waitcnt lgkmcnt(11)
    v_mfma_f32_16x16x32_bf16 v[96:99], v[144:147], v[76:79], v[96:99]
    ds_read_b128 v[144:147], v8 offset:40960
    s_waitcnt lgkmcnt(11)
    v_mfma_f32_16x16x32_bf16 v[100:103], v[148:151], v[76:79], v[100:103]
    ds_read_b128 v[148:151], v8 offset:41984
    s_waitcnt lgkmcnt(11)
    v_mfma_f32_16x16x32_bf16 v[104:107], v[152:155], v[76:79], v[104:107]
    ds_read_b128 v[152:155], v8 offset:43008
    s_waitcnt lgkmcnt(11)
    v_mfma_f32_16x16x32_bf16 v[108:111], v[156:159], v[76:79], v[108:111]
    ds_read_b128 v[156:159], v8 offset:44032
    s_waitcnt vmcnt(12) lgkmcnt(11)
    v_mfma_f32_16x16x32_bf16 v[88:91], v[112:115], v[80:83], v[88:91]
    buffer_load_dwordx4 v1, s[12:15], s19 offen offset:0 lds
    s_waitcnt lgkmcnt(10)
    v_mfma_f32_16x16x32_bf16 v[92:95], v[116:119], v[80:83], v[92:95]
    s_waitcnt lgkmcnt(9)
    v_mfma_f32_16x16x32_bf16 v[96:99], v[120:123], v[80:83], v[96:99]
    s_waitcnt lgkmcnt(8)
    v_mfma_f32_16x16x32_bf16 v[100:103], v[124:127], v[80:83], v[100:103]
    s_waitcnt lgkmcnt(7)
    v_mfma_f32_16x16x32_bf16 v[104:107], v[128:131], v[80:83], v[104:107]
    s_waitcnt lgkmcnt(6)
    v_mfma_f32_16x16x32_bf16 v[108:111], v[132:135], v[80:83], v[108:111]
    s_waitcnt vmcnt(12) lgkmcnt(5)
    v_mfma_f32_16x16x32_bf16 v[88:91], v[136:139], v[84:87], v[88:91]
    s_waitcnt lgkmcnt(4)
    v_mfma_f32_16x16x32_bf16 v[92:95], v[140:143], v[84:87], v[92:95]
    s_waitcnt lgkmcnt(3)
    v_mfma_f32_16x16x32_bf16 v[96:99], v[144:147], v[84:87], v[96:99]
    s_waitcnt lgkmcnt(2)
    v_mfma_f32_16x16x32_bf16 v[100:103], v[148:151], v[84:87], v[100:103]
    s_waitcnt lgkmcnt(1)
    v_mfma_f32_16x16x32_bf16 v[104:107], v[152:155], v[84:87], v[104:107]
    s_waitcnt lgkmcnt(0)
    v_mfma_f32_16x16x32_bf16 v[108:111], v[156:159], v[84:87], v[108:111]
    s_waitcnt vmcnt(9)
    s_add_u32 s76, s75, 7077888
    s_add_u32 s77, s76, 4096
    v_cvt_pk_bf16_f32 v172, v88, v89
    v_cvt_pk_bf16_f32 v173, v90, v91
    v_cvt_pk_bf16_f32 v174, v92, v93
    v_cvt_pk_bf16_f32 v175, v94, v95
    v_lshlrev_b32 v88, 16, v172
    v_and_b32 v89, 0xffff0000, v172
    v_lshlrev_b32 v90, 16, v173
    v_and_b32 v91, 0xffff0000, v173
    v_lshlrev_b32 v92, 16, v174
    v_and_b32 v93, 0xffff0000, v174
    v_lshlrev_b32 v94, 16, v175
    v_and_b32 v95, 0xffff0000, v175
    v_lshlrev_b32 v176, 16, v160
    v_and_b32 v177, 0xffff0000, v160
    v_lshlrev_b32 v178, 16, v161
    v_and_b32 v179, 0xffff0000, v161
    v_lshlrev_b32 v180, 16, v162
    v_and_b32 v181, 0xffff0000, v162
    v_lshlrev_b32 v182, 16, v163
    v_and_b32 v183, 0xffff0000, v163
    v_add_f32 v88, v88, v176
    v_add_f32 v89, v89, v177
    v_add_f32 v90, v90, v178
    v_add_f32 v91, v91, v179
    v_add_f32 v92, v92, v180
    v_add_f32 v93, v93, v181
    v_add_f32 v94, v94, v182
    v_add_f32 v95, v95, v183
    v_cvt_pk_bf16_f32 v16, v88, v89
    v_cvt_pk_bf16_f32 v17, v90, v91
    v_cvt_pk_bf16_f32 v18, v92, v93
    v_cvt_pk_bf16_f32 v19, v94, v95
    buffer_store_dwordx4 v[16:19], v4, s[8:11], s76 offen offset:0 sc1
    v_lshlrev_b32 v88, 16, v16
    v_and_b32 v89, 0xffff0000, v16
    v_lshlrev_b32 v90, 16, v17
    v_and_b32 v91, 0xffff0000, v17
    v_lshlrev_b32 v92, 16, v18
    v_and_b32 v93, 0xffff0000, v18
    v_lshlrev_b32 v94, 16, v19
    v_and_b32 v95, 0xffff0000, v19
    v_cvt_pk_bf16_f32 v172, v96, v97
    v_cvt_pk_bf16_f32 v173, v98, v99
    v_cvt_pk_bf16_f32 v174, v100, v101
    v_cvt_pk_bf16_f32 v175, v102, v103
    v_lshlrev_b32 v96, 16, v172
    v_and_b32 v97, 0xffff0000, v172
    v_lshlrev_b32 v98, 16, v173
    v_and_b32 v99, 0xffff0000, v173
    v_lshlrev_b32 v100, 16, v174
    v_and_b32 v101, 0xffff0000, v174
    v_lshlrev_b32 v102, 16, v175
    v_and_b32 v103, 0xffff0000, v175
    v_lshlrev_b32 v176, 16, v164
    v_and_b32 v177, 0xffff0000, v164
    v_lshlrev_b32 v178, 16, v165
    v_and_b32 v179, 0xffff0000, v165
    v_lshlrev_b32 v180, 16, v166
    v_and_b32 v181, 0xffff0000, v166
    v_lshlrev_b32 v182, 16, v167
    v_and_b32 v183, 0xffff0000, v167
    v_add_f32 v96, v96, v176
    v_add_f32 v97, v97, v177
    v_add_f32 v98, v98, v178
    v_add_f32 v99, v99, v179
    v_add_f32 v100, v100, v180
    v_add_f32 v101, v101, v181
    v_add_f32 v102, v102, v182
    v_add_f32 v103, v103, v183
    v_cvt_pk_bf16_f32 v20, v96, v97
    v_cvt_pk_bf16_f32 v21, v98, v99
    v_cvt_pk_bf16_f32 v22, v100, v101
    v_cvt_pk_bf16_f32 v23, v102, v103
    buffer_store_dwordx4 v[20:23], v4, s[8:11], s76 offen offset:2048 sc1
    v_lshlrev_b32 v96, 16, v20
    v_and_b32 v97, 0xffff0000, v20
    v_lshlrev_b32 v98, 16, v21
    v_and_b32 v99, 0xffff0000, v21
    v_lshlrev_b32 v100, 16, v22
    v_and_b32 v101, 0xffff0000, v22
    v_lshlrev_b32 v102, 16, v23
    v_and_b32 v103, 0xffff0000, v23
    v_cvt_pk_bf16_f32 v172, v104, v105
    v_cvt_pk_bf16_f32 v173, v106, v107
    v_cvt_pk_bf16_f32 v174, v108, v109
    v_cvt_pk_bf16_f32 v175, v110, v111
    v_lshlrev_b32 v104, 16, v172
    v_and_b32 v105, 0xffff0000, v172
    v_lshlrev_b32 v106, 16, v173
    v_and_b32 v107, 0xffff0000, v173
    v_lshlrev_b32 v108, 16, v174
    v_and_b32 v109, 0xffff0000, v174
    v_lshlrev_b32 v110, 16, v175
    v_and_b32 v111, 0xffff0000, v175
    v_lshlrev_b32 v176, 16, v168
    v_and_b32 v177, 0xffff0000, v168
    v_lshlrev_b32 v178, 16, v169
    v_and_b32 v179, 0xffff0000, v169
    v_lshlrev_b32 v180, 16, v170
    v_and_b32 v181, 0xffff0000, v170
    v_lshlrev_b32 v182, 16, v171
    v_and_b32 v183, 0xffff0000, v171
    v_add_f32 v104, v104, v176
    v_add_f32 v105, v105, v177
    v_add_f32 v106, v106, v178
    v_add_f32 v107, v107, v179
    v_add_f32 v108, v108, v180
    v_add_f32 v109, v109, v181
    v_add_f32 v110, v110, v182
    v_add_f32 v111, v111, v183
    v_cvt_pk_bf16_f32 v24, v104, v105
    v_cvt_pk_bf16_f32 v25, v106, v107
    v_cvt_pk_bf16_f32 v26, v108, v109
    v_cvt_pk_bf16_f32 v27, v110, v111
    buffer_store_dwordx4 v[24:27], v4, s[8:11], s77 offen sc1
    v_lshlrev_b32 v104, 16, v24
    v_and_b32 v105, 0xffff0000, v24
    v_lshlrev_b32 v106, 16, v25
    v_and_b32 v107, 0xffff0000, v25
    v_lshlrev_b32 v108, 16, v26
    v_and_b32 v109, 0xffff0000, v26
    v_lshlrev_b32 v110, 16, v27
    v_and_b32 v111, 0xffff0000, v27
    v_add_f32 v172, v88, v89
    v_add_f32 v174, v90, v91
    v_add_f32 v172, v172, v92
    v_add_f32 v174, v174, v93
    v_add_f32 v172, v172, v94
    v_add_f32 v174, v174, v95
    v_add_f32 v172, v172, v96
    v_add_f32 v174, v174, v97
    v_add_f32 v172, v172, v98
    v_add_f32 v174, v174, v99
    v_add_f32 v172, v172, v100
    v_add_f32 v174, v174, v101
    v_add_f32 v172, v172, v102
    v_add_f32 v174, v174, v103
    v_add_f32 v172, v172, v104
    v_add_f32 v174, v174, v105
    v_add_f32 v172, v172, v106
    v_add_f32 v174, v174, v107
    v_add_f32 v172, v172, v108
    v_add_f32 v174, v174, v109
    v_add_f32 v172, v172, v110
    v_add_f32 v174, v174, v111
    v_add_f32 v172, v172, v174
    v_mov_b32 v174, v172
    s_nop 1
    v_permlane16_swap_b32 v172, v174
    v_add_f32 v172, v172, v174
    v_mov_b32 v174, v172
    s_nop 1
    v_permlane32_swap_b32 v172, v174
    v_add_f32 v172, v172, v174
    v_mul_f32 v175, 0x3c2aaaab, v172
    v_sub_f32 v88, v88, v175
    v_sub_f32 v89, v89, v175
    v_sub_f32 v90, v90, v175
    v_sub_f32 v91, v91, v175
    v_sub_f32 v92, v92, v175
    v_sub_f32 v93, v93, v175
    v_sub_f32 v94, v94, v175
    v_sub_f32 v95, v95, v175
    v_sub_f32 v96, v96, v175
    v_sub_f32 v97, v97, v175
    v_sub_f32 v98, v98, v175
    v_sub_f32 v99, v99, v175
    v_sub_f32 v100, v100, v175
    v_sub_f32 v101, v101, v175
    v_sub_f32 v102, v102, v175
    v_sub_f32 v103, v103, v175
    v_sub_f32 v104, v104, v175
    v_sub_f32 v105, v105, v175
    v_sub_f32 v106, v106, v175
    v_sub_f32 v107, v107, v175
    v_sub_f32 v108, v108, v175
    v_sub_f32 v109, v109, v175
    v_sub_f32 v110, v110, v175
    v_sub_f32 v111, v111, v175
    v_mul_f32 v173, v88, v88
    v_fmac_f32 v173, v89, v89
    v_fmac_f32 v173, v90, v90
    v_fmac_f32 v173, v91, v91
    v_fmac_f32 v173, v92, v92
    v_fmac_f32 v173, v93, v93
    v_fmac_f32 v173, v94, v94
    v_fmac_f32 v173, v95, v95
    v_fmac_f32 v173, v96, v96
    v_fmac_f32 v173, v97, v97
    v_fmac_f32 v173, v98, v98
    v_fmac_f32 v173, v99, v99
    v_fmac_f32 v173, v100, v100
    v_fmac_f32 v173, v101, v101
    v_fmac_f32 v173, v102, v102
    v_fmac_f32 v173, v103, v103
    v_fmac_f32 v173, v104, v104
    v_fmac_f32 v173, v105, v105
    v_fmac_f32 v173, v106, v106
    v_fmac_f32 v173, v107, v107
    v_fmac_f32 v173, v108, v108
    v_fmac_f32 v173, v109, v109
    v_fmac_f32 v173, v110, v110
    v_fmac_f32 v173, v111, v111
    v_mov_b32 v174, v173
    s_nop 1
    v_permlane16_swap_b32 v173, v174
    v_add_f32 v173, v173, v174
    v_mov_b32 v174, v173
    s_nop 1
    v_permlane32_swap_b32 v173, v174
    v_add_f32 v173, v173, v174
    v_mul_u32_u24 v9, 48, v6
    s_mul_i32 s76, s64, 768
    s_lshl_b32 s77, s65, 3
    s_add_u32 s76, s76, s77
    s_add_u32 s76, s76, 9437184
    s_mov_b64 exec, 0xffff
    buffer_store_dwordx2 v[172:173], v9, s[8:11], s76 offen sc1
    s_mov_b64 exec, -1
    s_lshr_b32 s76, s70, 1
    s_mul_i32 s76, s76, 4352
    s_and_b32 s77, s70, 1
    s_mul_i32 s77, s77, 6
    s_add_u32 s77, s77, s65
    s_lshl_b32 s77, s77, 2
    s_add_u32 s76, s76, s77
    s_add_u32 s76, s76, 9699456
    s_waitcnt vmcnt(0)
    s_barrier
    s_cmp_lg_u32 s3, 0
    s_cbranch_scc1 KM_nf1
    v_mov_b32 v2, 1
    v_mov_b32 v3, 0
    s_mov_b64 exec, 1
    buffer_store_dword v2, v3, s[8:11], s76 offen sc1
    s_mov_b64 exec, -1
KM_nf1:
    s_add_u32 m0, s18, 36864
    s_add_u32 s19, s17, 36864
    buffer_load_dwordx4 v1, s[12:15], s19 offen offset:0 lds
    buffer_load_dwordx4 v1, s[12:15], s19 offen offset:1024 lds
    buffer_load_dwordx4 v1, s[12:15], s19 offen offset:2048 lds
    buffer_load_dwordx4 v1, s[12:15], s19 offen offset:3072 lds
    s_add_u32 m0, s18, 40960
    s_add_u32 s19, s17, 40960
    buffer_load_dwordx4 v1, s[12:15], s19 offen offset:0 lds
    buffer_load_dwordx4 v1, s[12:15], s19 offen offset:1024 lds
    buffer_load_dwordx4 v1, s[12:15], s19 offen offset:2048 lds
    buffer_load_dwordx4 v1, s[12:15], s19 offen offset:3072 lds
    s_add_u32 m0, s18, 45056
    s_add_u32 s19, s17, 45056
    buffer_load_dwordx4 v1, s[12:15], s19 offen offset:0 lds
    s_add_u32 m0, s18, 73728
    s_add_u32 s19, s17, 73728
    buffer_load_dwordx4 v1, s[12:15], s19 offen offset:0 lds
    buffer_load_dwordx4 v1, s[12:15], s19 offen offset:1024 lds
    buffer_load_dwordx4 v1, s[12:15], s19 offen offset:2048 lds
    buffer_load_dwordx4 v1, s[12:15], s19 offen offset:3072 lds
    s_add_u32 m0, s18, 77824
    s_add_u32 s19, s17, 77824
    buffer_load_dwordx4 v1, s[12:15], s19 offen offset:0 lds
    buffer_load_dwordx4 v1, s[12:15], s19 offen offset:1024 lds
    buffer_load_dwordx4 v1, s[12:15], s19 offen offset:2048 lds
    buffer_load_dwordx4 v1, s[12:15], s19 offen offset:3072 lds
    s_add_u32 m0, s18, 81920
    s_add_u32 s19, s17, 81920
    buffer_load_dwordx4 v1, s[12:15], s19 offen offset:0 lds
    s_add_u32 m0, s18, 110592
    s_add_u32 s19, s17, 110592
    buffer_load_dwordx4 v1, s[12:15], s19 offen offset:0 lds
    buffer_load_dwordx4 v1, s[12:15], s19 offen offset:1024 lds
    buffer_load_dwordx4 v1, s[12:15], s19 offen offset:2048 lds
    buffer_load_dwordx4 v1, s[12:15], s19 offen offset:3072 lds
    s_add_u32 m0, s18, 114688
    s_add_u32 s19, s17, 114688
    buffer_load_dwordx4 v1, s[12:15], s19 offen offset:0 lds
    buffer_load_dwordx4 v1, s[12:15], s19 offen offset:1024 lds
    buffer_load_dwordx4 v1, s[12:15], s19 offen offset:2048 lds
    buffer_load_dwordx4 v1, s[12:15], s19 offen offset:3072 lds
    s_add_u32 m0, s18, 118784
    s_add_u32 s19, s17, 118784
    buffer_load_dwordx4 v1, s[12:15], s19 offen offset:0 lds
    s_branch KM_C
KM_Bskip:
    s_cmp_lg_u32 s60, 0
    s_cbranch_scc1 KM_Bs2
    s_and_b32 s76, s31, 7
    s_lshl_b32 s76, s76, 3
    s_lshr_b32 s77, s31, 3
    s_add_u32 s76, s76, s77
    s_mul_i32 s76, s76, 82944
    s_lshl_b32 s77, s3, 10
    s_add_u32 s76, s76, s77
    buffer_load_dwordx4 v[80:83], v1, s[36:39], s76 offen
    s_add_u32 s76, s76, 4096
    buffer_load_dwordx4 v[84:87], v1, s[36:39], s76 offen
    s_add_u32 s76, s76, 4096
    buffer_load_dwordx4 v[88:91], v1, s[36:39], s76 offen
    s_add_u32 s76, s76, 4096
    buffer_load_dwordx4 v[92:95], v1, s[36:39], s76 offen
    s_add_u32 s76, s76, 4096
    buffer_load_dwordx4 v[96:99], v1, s[36:39], s76 offen
    s_add_u32 s76, s76, 4096
    buffer_load_dwordx4 v[100:103], v1, s[36:39], s76 offen
    s_add_u32 s76, s76, 4096
    buffer_load_dwordx4 v[104:107], v1, s[36:39], s76 offen
    s_add_u32 s76, s76, 4096
    buffer_load_dwordx4 v[108:111], v1, s[36:39], s76 offen
    s_add_u32 s76, s76, 4096
    buffer_load_dwordx4 v[112:115], v1, s[36:39], s76 offen
    s_add_u32 s76, s76, 4096
    buffer_load_dwordx4 v[116:119], v1, s[36:39], s76 offen
    s_add_u32 s76, s76, 4096
    buffer_load_dwordx4 v[120:123], v1, s[36:39], s76 offen
    s_add_u32 s76, s76, 4096
    buffer_load_dwordx4 v[124:127], v1, s[36:39], s76 offen
    s_add_u32 s76, s76, 4096
    buffer_load_dwordx4 v[128:131], v1, s[36:39], s76 offen
    s_add_u32 s76, s76, 4096
    buffer_load_dwordx4 v[132:135], v1, s[36:39], s76 offen
    s_add_u32 s76, s76, 4096
    buffer_load_dwordx4 v[136:139], v1, s[36:39], s76 offen
    s_add_u32 s76, s76, 4096
    buffer_load_dwordx4 v[140:143], v1, s[36:39], s76 offen
    s_add_u32 s76, s76, 4096
    buffer_load_dwordx4 v[144:147], v1, s[36:39], s76 offen
    s_add_u32 s76, s76, 4096
    buffer_load_dwordx4 v[148:151], v1, s[36:39], s76 offen
    s_add_u32 s76, s76, 4096
    buffer_load_dwordx4 v[152:155], v1, s[36:39], s76 offen
    s_add_u32 s76, s76, 4096
    buffer_load_dwordx4 v[156:159], v1, s[36:39], s76 offen
    s_add_u32 s76, s76, 4096
    buffer_load_dwordx4 v[160:163], v1, s[36:39], s76 offen
    s_cmp_ge_u32 s31, 18
    s_cbranch_scc1 KM_Bs1
    s_lshl_b32 s76, s31, 2
    s_add_u32 s76, s76, s3
    v_lshlrev_b32 v3, 2, v0
    v_and_b32 v48, 3, v0
    v_bfe_u32 v49, v0, 3, 1
    v_lshl_add_u32 v48, v49, 2, v48
    v_bfe_u32 v49, v0, 2, 1
    v_lshl_add_u32 v48, v49, 3, v48
    v_and_b32 v49, 48, v0
    v_add_u32 v48, v48, v49
    v_lshlrev_b32 v48, 1, v48
    s_lshl_b32 s77, s76, 8
    s_add_u32 s77, s77, 116391936
    s_lshl_b32 s78, s76, 7
    s_mov_b32 s56, s34
    s_mov_b32 s57, s35
    s_mov_b32 s58, 9216
    s_mov_b32 s59, 0x00020000
    buffer_load_dword v56, v3, s[12:15], s77 offen sc1
    s_add_u32 s77, s77, 18432
    buffer_load_dword v57, v3, s[12:15], s77 offen sc1
    s_add_u32 s77, s77, 18432
    buffer_load_dword v58, v3, s[12:15], s77 offen sc1
    s_add_u32 s77, s77, 18432
    buffer_load_dword v59, v3, s[12:15], s77 offen sc1
    s_add_u32 s77, s77, 18432
    buffer_load_dword v60, v3, s[12:15], s77 offen sc1
    s_add_u32 s77, s77, 18432
    buffer_load_dword v61, v3, s[12:15], s77 offen sc1
    s_add_u32 s77, s77, 18432
    buffer_load_dword v62, v3, s[12:15], s77 offen sc1
    s_add_u32 s77, s77, 18432
    buffer_load_dword v63, v3, s[12:15], s77 offen sc1
    s_add_u32 s77, s77, 18432
    buffer_load_dword v64, v3, s[12:15], s77 offen sc1
    buffer_load_ushort v50, v48, s[56:59], s78 offen
    v_mov_b32 v68, 0
    v_mov_b32 v69, 0
    v_mov_b32 v70, 0
    v_mov_b32 v71, 0
    v_mov_b32 v72, 0
    v_mov_b32 v73, 0
    v_and_b32 v4, 31, v0
    v_lshlrev_b32 v4, 4, v4
    v_lshrrev_b32 v5, 5, v0
    v_lshl_add_u32 v4, v5, 10, v4
    s_lshl_b32 s77, s76, 11
    s_add_u32 s77, s77, 115343360
    s_waitcnt vmcnt(0)
    v_add_f32 v56, v56, v57
    v_add_f32 v56, v56, v58
    v_add_f32 v56, v56, v59
    v_add_f32 v56, v56, v60
    v_add_f32 v56, v56, v61
    v_add_f32 v56, v56, v62
    v_add_f32 v56, v56, v63
    v_add_f32 v56, v56, v64
    v_cvt_pk_bf16_f32 v57, v56, v56
    v_lshlrev_b32 v57, 16, v57
    v_sub_f32 v58, v56, v57
    v_cvt_pk_bf16_f32 v66, v57, v58
    v_and_b32 v59, 0xffff0000, v66
    v_sub_f32 v58, v58, v59
    v_cvt_pk_bf16_f32 v67, v58, v58
    v_and_b32 v67, 0xffff, v67
    v_lshl_or_b32 v67, v50, 16, v67
    buffer_store_dwordx4 v[66:69], v4, s[12:15], s77 offen sc1
    buffer_store_dwordx4 v[70:73], v4, s[12:15], s77 offen offset:512 sc1
    s_lshl_b32 s76, s76, 2
    s_add_u32 s76, s76, 116916224
    s_waitcnt vmcnt(0)
    v_mov_b32 v2, 1
    v_mov_b32 v3, 0
    s_mov_b64 exec, 1
    buffer_store_dword v2, v3, s[12:15], s76 offen sc1
    s_mov_b64 exec, -1
KM_nf2:
KM_Bs1:
KM_Bs2:
    s_add_u32 m0, s18, 0
    s_add_u32 s19, s17, 0
    buffer_load_dwordx4 v1, s[12:15], s19 offen offset:0 lds
    buffer_load_dwordx4 v1, s[12:15], s19 offen offset:1024 lds
    buffer_load_dwordx4 v1, s[12:15], s19 offen offset:2048 lds
    buffer_load_dwordx4 v1, s[12:15], s19 offen offset:3072 lds
    s_add_u32 m0, s18, 4096
    s_add_u32 s19, s17, 4096
    buffer_load_dwordx4 v1, s[12:15], s19 offen offset:0 lds
    buffer_load_dwordx4 v1, s[12:15], s19 offen offset:1024 lds
    buffer_load_dwordx4 v1, s[12:15], s19 offen offset:2048 lds
    buffer_load_dwordx4 v1, s[12:15], s19 offen offset:3072 lds
    s_add_u32 m0, s18, 8192
    s_add_u32 s19, s17, 8192
    buffer_load_dwordx4 v1, s[12:15], s19 offen offset:0 lds
    s_add_u32 m0, s18, 36864
    s_add_u32 s19, s17, 36864
    buffer_load_dwordx4 v1, s[12:15], s19 offen offset:0 lds
    buffer_load_dwordx4 v1, s[12:15], s19 offen offset:1024 lds
    buffer_load_dwordx4 v1, s[12:15], s19 offen offset:2048 lds
    buffer_load_dwordx4 v1, s[12:15], s19 offen offset:3072 lds
    s_add_u32 m0, s18, 40960
    s_add_u32 s19, s17, 40960
    buffer_load_dwordx4 v1, s[12:15], s19 offen offset:0 lds
    buffer_load_dwordx4 v1, s[12:15], s19 offen offset:1024 lds
    buffer_load_dwordx4 v1, s[12:15], s19 offen offset:2048 lds
    buffer_load_dwordx4 v1, s[12:15], s19 offen offset:3072 lds
    s_add_u32 m0, s18, 45056
    s_add_u32 s19, s17, 45056
    buffer_load_dwordx4 v1, s[12:15], s19 offen offset:0 lds
    s_add_u32 m0, s18, 73728
    s_add_u32 s19, s17, 73728
    buffer_load_dwordx4 v1, s[12:15], s19 offen offset:0 lds
    buffer_load_dwordx4 v1, s[12:15], s19 offen offset:1024 lds
    buffer_load_dwordx4 v1, s[12:15], s19 offen offset:2048 lds
    buffer_load_dwordx4 v1, s[12:15], s19 offen offset:3072 lds
    s_add_u32 m0, s18, 77824
    s_add_u32 s19, s17, 77824
    buffer_load_dwordx4 v1, s[12:15], s19 offen offset:0 lds
    buffer_load_dwordx4 v1, s[12:15], s19 offen offset:1024 lds
    buffer_load_dwordx4 v1, s[12:15], s19 offen offset:2048 lds
    buffer_load_dwordx4 v1, s[12:15], s19 offen offset:3072 lds
    s_add_u32 m0, s18, 81920
    s_add_u32 s19, s17, 81920
    buffer_load_dwordx4 v1, s[12:15], s19 offen offset:0 lds
    s_add_u32 m0, s18, 110592
    s_add_u32 s19, s17, 110592
    buffer_load_dwordx4 v1, s[12:15], s19 offen offset:0 lds
    buffer_load_dwordx4 v1, s[12:15], s19 offen offset:1024 lds
    buffer_load_dwordx4 v1, s[12:15], s19 offen offset:2048 lds
    buffer_load_dwordx4 v1, s[12:15], s19 offen offset:3072 lds
    s_add_u32 m0, s18, 114688
    s_add_u32 s19, s17, 114688
    buffer_load_dwordx4 v1, s[12:15], s19 offen offset:0 lds
    buffer_load_dwordx4 v1, s[12:15], s19 offen offset:1024 lds
    buffer_load_dwordx4 v1, s[12:15], s19 offen offset:2048 lds
    buffer_load_dwordx4 v1, s[12:15], s19 offen offset:3072 lds
    s_add_u32 m0, s18, 118784
    s_add_u32 s19, s17, 118784
    buffer_load_dwordx4 v1, s[12:15], s19 offen offset:0 lds
KM_C:
    s_mul_i32 s20, s16, 36864
    s_add_u32 s21, s20, 7077888
    s_mul_i32 s23, s16, 1536
    s_add_u32 s23, s23, 9437184
    s_mul_i32 s24, s6, 9216
    s_mul_i32 s25, s3, 2304
    s_add_u32 s24, s24, s25
    s_add_u32 s24, s24, 115343360
    s_add_u32 s25, s25, 147456
    v_add_u32 v2, 0, v1
    v_add_u32 v3, 36864, v1
    v_add_u32 v4, 73728, v1
    v_add_u32 v5, 110592, v1
    v_add_u32 v6, 147456, v1
    s_and_b32 s87, s6, 1
    s_mul_i32 s29, s87, 640
    s_mul_i32 s28, s6, 331776
    s_add_u32 s28, s28, s29
    s_xor_b32 s85, s6, 1
    s_mul_i32 s85, s85, 331776
    s_add_u32 s85, s85, s29
    s_and_b32 s27, s3, 1
    s_mul_i32 s27, s27, 82944
    s_add_u32 s27, s27, s28
    s_lshr_b32 s29, s3, 1
    s_lshl_b32 s29, s29, 7
    s_add_u32 s27, s27, s29
    s_sub_u32 s93, s27, s28
    s_add_u32 s93, s93, s85
    s_mul_i32 s29, s3, 82944
    s_add_u32 s28, s28, s29
    s_add_u32 s85, s85, s29
    s_lshr_b32 s86, s3, 1
    s_xor_b32 s86, s86, s6
    s_mul_i32 s86, s86, 331776
    s_and_b32 s29, s3, 1
    s_mul_i32 s29, s29, 165888
    s_add_u32 s86, s86, s29
    s_lshl_b32 s29, s87, 6
    s_add_u32 s86, s86, s29
    s_add_u32 s86, s86, 512
    s_lshl_b32 s88, s7, 4
    s_add_u32 s88, s88, s6
    s_lshl_b32 s88, s88, 2
    s_add_u32 s88, s88, s3
    s_xor_b32 s89, s88, 4
    s_mul_i32 s90, s88, 18432
    s_add_u32 s22, s90, 12582912
    s_add_u32 s90, s90, 31457280
    s_mul_i32 s91, s89, 18432
    s_add_u32 s91, s91, 31457280
    s_mul_i32 s29, s7, 4352
    s_add_u32 s29, s29, 9699968
    s_and_b32 s88, s88, 63
    s_lshl_b32 s88, s88, 2
    s_add_u32 s88, s88, s29
    s_and_b32 s89, s89, 63
    s_lshl_b32 s89, s89, 2
    s_add_u32 s89, s89, s29
    v_bfe_u32 v252, v0, 2, 3
    v_mul_u32_u24 v252, 1152, v252
    v_lshrrev_b32 v248, 5, v0
    v_lshl_add_u32 v252, v248, 6, v252
    v_and_b32 v249, 3, v0
    v_lshl_add_u32 v252, v249, 4, v252
    v_lshlrev_b32 v248, 10, v248
    v_bfe_u32 v249, v0, 2, 2
    v_lshl_add_u32 v248, v249, 6, v248
    v_bfe_u32 v249, v0, 4, 1
    v_lshl_add_u32 v248, v249, 5, v248
    v_and_b32 v249, 1, v0
    v_lshl_add_u32 v248, v249, 4, v248
    v_bfe_u32 v249, v0, 1, 1
    v_lshl_add_u32 v248, v249, 3, v248
    v_add_u32 v249, 36864, v248
    v_add_u32 v250, 73728, v248
    v_add_u32 v251, 110592, v248
    v_bfe_u32 v253, v0, 3, 2
    v_mul_u32_u24 v253, 4608, v253
    v_lshrrev_b32 v254, 5, v0
    v_lshl_add_u32 v253, v254, 7, v253
    v_and_b32 v254, 7, v0
    v_lshl_add_u32 v253, v254, 4, v253
    v_and_b32 v9, 15, v0
    v_and_b32 v10, 1, v0
    v_lshlrev_b32 v10, 4, v10
    v_mov_b32 v11, 0x3f80
    v_lshlrev_b32 v11, v10, v11
    v_lshrrev_b32 v9, 1, v9
    v_cmp_eq_u32 vcc, 0, v9
    s_nop 1
    v_cndmask_b32 v10, 0, v11, vcc
    v_accvgpr_write_b32 a240, v10
    v_cmp_eq_u32 vcc, 1, v9
    s_nop 1
    v_cndmask_b32 v10, 0, v11, vcc
    v_accvgpr_write_b32 a241, v10
    v_cmp_eq_u32 vcc, 2, v9
    s_nop 1
    v_cndmask_b32 v10, 0, v11, vcc
    v_accvgpr_write_b32 a242, v10
    v_cmp_eq_u32 vcc, 3, v9
    s_nop 1
    v_cndmask_b32 v10, 0, v11, vcc
    v_accvgpr_write_b32 a243, v10
    v_cmp_eq_u32 vcc, 4, v9
    s_nop 1
    v_cndmask_b32 v10, 0, v11, vcc
    v_accvgpr_write_b32 a244, v10
    v_cmp_eq_u32 vcc, 5, v9
    s_nop 1
    v_cndmask_b32 v10, 0, v11, vcc
    v_accvgpr_write_b32 a245, v10
    v_cmp_eq_u32 vcc, 6, v9
    s_nop 1
    v_cndmask_b32 v10, 0, v11, vcc
    v_accvgpr_write_b32 a246, v10
    v_cmp_eq_u32 vcc, 7, v9
    s_nop 1
    v_cndmask_b32 v10, 0, v11, vcc
    v_accvgpr_write_b32 a247, v10
    s_lshr_b32 s48, s6, 2
    s_lshl_b32 s49, s7, 2
    s_add_u32 s48, s48, s49
    s_mul_i32 s30, s7, 4352
    s_add_u32 s50, s30, 9699328
    s_lshl_b32 s49, s6, 2
    s_add_u32 s51, s50, s49
    s_mul_i32 s52, s48, 36864
    s_lshl_b32 s49, s3, 10
    s_add_u32 s52, s52, s49
    s_and_b32 s53, s6, 3
    s_lshl_b32 s53, s53, 3
    v_and_b32 v9, 7, v0
    v_add_u32 v9, s53, v9
    v_bfe_u32 v10, v0, 3, 1
    v_lshlrev_b32 v10, 9, v10
    v_lshl_add_u32 v10, v9, 4, v10
    v_lshrrev_b32 v11, 4, v0
    v_mul_u32_u24 v9, 147456, v11
    v_and_b32 v14, 15, v0
    v_lshl_add_u32 v9, v14, 4, v9
    s_lshl_b32 s40, s7, 6
    s_lshr_b32 s49, s6, 2
    s_add_u32 s40, s40, s49
    s_mul_i32 s40, s40, 18432
    s_mul_i32 s49, s53, 576
    s_add_u32 s40, s40, s49
    s_lshl_b32 s49, s3, 8
    s_add_u32 s40, s40, s49
    s_add_u32 s40, s40, 12582912
    s_cmp_lt_u32 s3, 2
    s_cselect_b32 s92, 0, 73216
    s_add_u32 s92, s92, s40
    v_lshrrev_b32 v14, 1, v11
    v_lshl_add_u32 v10, v14, 12, v10
    v_and_b32 v14, 1, v11
    v_lshl_add_u32 v10, v14, 3, v10
    v_and_b32 v11, 15, v0
    v_lshlrev_b32 v11, 2, v11
    v_and_b32 v12, 31, v0
    v_min_u32 v13, 11, v12
    s_add_u32 s30, s30, s60
    s_add_u32 s30, s30, 9699456
    v_lshlrev_b32 v13, 2, v13
    v_add_u32 v13, s30, v13
    v_min_u32 v12, 4, v12
    s_mul_i32 s30, s6, 9
    s_lshr_b32 s30, s30, 1
    s_lshl_b32 s30, s30, 2
    s_add_u32 s30, s30, 116916224
    v_lshlrev_b32 v12, 2, v12
    v_add_u32 v12, s30, v12
    v_cmp_gt_u32 vcc, 32, v0
    s_nop 1
    v_cndmask_b32 v12, v12, v13, vcc
    v_and_b32 v15, 31, v0
    v_mul_u32_u24 v15, 48, v15
    s_cmp_lg_u32 s3, 0
    s_cbranch_scc1 KM_go_x1
KM_spin_x1:
    buffer_load_dword v13, v12, s[12:15], 0 offen sc1
    s_add_u32 s55, s55, 1
    s_waitcnt vmcnt(0)
    v_cmp_eq_u32 vcc, 0, v13
    s_cbranch_vccz KM_go_x1
    s_sleep 6
    s_cmp_lt_u32 s55, 262144
    s_cbranch_scc1 KM_spin_x1
KM_go_x1:
    s_waitcnt vmcnt(0)
    s_barrier
    buffer_load_dwordx4 a[0:3], v1, s[8:11], s21 offen offset:0 sc1
    buffer_load_dwordx4 a[4:7], v1, s[8:11], s21 offen offset:1024 sc1
    buffer_load_dwordx4 a[8:11], v1, s[8:11], s21 offen offset:2048 sc1
    buffer_load_dwordx4 a[12:15], v1, s[8:11], s21 offen offset:3072 sc1
    s_add_u32 s21, s21, 4096
    buffer_load_dwordx4 a[16:19], v1, s[8:11], s21 offen offset:0 sc1
    buffer_load_dwordx4 a[20:23], v1, s[8:11], s21 offen offset:1024 sc1
    buffer_load_dwordx4 a[24:27], v1, s[8:11], s21 offen offset:2048 sc1
    buffer_load_dwordx4 a[28:31], v1, s[8:11], s21 offen offset:3072 sc1
    ds_read_b128 a[144:147], v2 offset:0
    ds_read_b128 a[148:151], v2 offset:1024
    ds_read_b128 a[152:155], v2 offset:2048
    ds_read_b128 a[156:159], v2 offset:3072
    ds_read_b128 a[160:163], v2 offset:4096
    ds_read_b128 a[164:167], v2 offset:5120
    ds_read_b128 a[168:171], v2 offset:6144
    s_waitcnt lgkmcnt(3)
    s_waitcnt vmcnt(7)
    v_mfma_f32_32x32x16_bf16 v[16:31], a[144:147], a[0:3], 0
    ds_read_b128 a[172:175], v2 offset:7168
    s_add_u32 s21, s21, 4096
    buffer_load_dwordx4 a[32:35], v1, s[8:11], s21 offen offset:0 sc1
    v_mfma_f32_32x32x16_bf16 v[32:47], a[148:151], a[0:3], 0
    ds_read_b128 a[176:179], v2 offset:8192
    v_mfma_f32_32x32x16_bf16 v[48:63], a[152:155], a[0:3], 0
    ds_read_b128 a[180:183], v2 offset:9216
    buffer_load_dwordx4 a[36:39], v1, s[8:11], s21 offen offset:1024 sc1
    s_waitcnt vmcnt(8)
    v_mfma_f32_32x32x16_bf16 v[16:31], a[156:159], a[4:7], v[16:31]
    ds_read_b128 a[184:187], v2 offset:10240
    s_waitcnt lgkmcnt(3)
    v_mfma_f32_32x32x16_bf16 v[32:47], a[160:163], a[4:7], v[32:47]
    ds_read_b128 a[188:191], v2 offset:11264
    buffer_load_dwordx4 a[40:43], v1, s[8:11], s21 offen offset:2048 sc1
    v_mfma_f32_32x32x16_bf16 v[48:63], a[164:167], a[4:7], v[48:63]
    ds_read_b128 a[144:147], v2 offset:12288
    s_waitcnt vmcnt(8)
    v_mfma_f32_32x32x16_bf16 v[16:31], a[168:171], a[8:11], v[16:31]
    ds_read_b128 a[148:151], v2 offset:13312
    buffer_load_dwordx4 a[44:47], v1, s[8:11], s21 offen offset:3072 sc1
    v_mfma_f32_32x32x16_bf16 v[32:47], a[172:175], a[8:11], v[32:47]
    ds_read_b128 a[152:155], v2 offset:14336
    s_waitcnt lgkmcnt(3)
    v_mfma_f32_32x32x16_bf16 v[48:63], a[176:179], a[8:11], v[48:63]
    ds_read_b128 a[156:159], v2 offset:15360
    s_add_u32 s21, s21, 4096
    buffer_load_dwordx4 a[48:51], v1, s[8:11], s21 offen offset:0 sc1
    s_waitcnt vmcnt(9)
    v_mfma_f32_32x32x16_bf16 v[16:31], a[180:183], a[12:15], v[16:31]
    ds_read_b128 a[160:163], v2 offset:16384
    v_mfma_f32_32x32x16_bf16 v[32:47], a[184:187], a[12:15], v[32:47]
    ds_read_b128 a[164:167], v2 offset:17408
    buffer_load_dwordx4 a[52:55], v1, s[8:11], s21 offen offset:1024 sc1
    v_mfma_f32_32x32x16_bf16 v[48:63], a[188:191], a[12:15], v[48:63]
    ds_read_b128 a[168:171], v2 offset:18432
    s_waitcnt lgkmcnt(3)
    s_waitcnt vmcnt(9)
    v_mfma_f32_32x32x16_bf16 v[16:31], a[144:147], a[16:19], v[16:31]
    ds_read_b128 a[172:175], v2 offset:19456
    buffer_load_dwordx4 a[56:59], v1, s[8:11], s21 offen offset:2048 sc1
    v_mfma_f32_32x32x16_bf16 v[32:47], a[148:151], a[16:19], v[32:47]
    ds_read_b128 a[176:179], v2 offset:20480
    v_mfma_f32_32x32x16_bf16 v[48:63], a[152:155], a[16:19], v[48:63]
    ds_read_b128 a[180:183], v2 offset:21504
    buffer_load_dwordx4 a[60:63], v1, s[8:11], s21 offen offset:3072 sc1
    s_waitcnt vmcnt(10)
    v_mfma_f32_32x32x16_bf16 v[16:31], a[156:159], a[20:23], v[16:31]
    ds_read_b128 a[184:187], v2 offset:22528
    s_waitcnt lgkmcnt(3)
    v_mfma_f32_32x32x16_bf16 v[32:47], a[160:163], a[20:23], v[32:47]
    ds_read_b128 a[188:191], v2 offset:23552
    s_add_u32 s21, s21, 4096
    buffer_load_dwordx4 a[64:67], v1, s[8:11], s21 offen offset:0 sc1
    v_mfma_f32_32x32x16_bf16 v[48:63], a[164:167], a[20:23], v[48:63]
    ds_read_b128 a[144:147], v2 offset:24576
    s_waitcnt vmcnt(10)
    v_mfma_f32_32x32x16_bf16 v[16:31], a[168:171], a[24:27], v[16:31]
    ds_read_b128 a[148:151], v2 offset:25600
    buffer_load_dwordx4 a[68:71], v1, s[8:11], s21 offen offset:1024 sc1
    v_mfma_f32_32x32x16_bf16 v[32:47], a[172:175], a[24:27], v[32:47]
    ds_read_b128 a[152:155], v2 offset:26624
    s_waitcnt lgkmcnt(3)
    v_mfma_f32_32x32x16_bf16 v[48:63], a[176:179], a[24:27], v[48:63]
    ds_read_b128 a[156:159], v2 offset:27648
    buffer_load_dwordx4 a[72:75], v1, s[8:11], s21 offen offset:2048 sc1
    s_waitcnt vmcnt(11)
    v_mfma_f32_32x32x16_bf16 v[16:31], a[180:183], a[28:31], v[16:31]
    ds_read_b128 a[160:163], v2 offset:28672
    v_mfma_f32_32x32x16_bf16 v[32:47], a[184:187], a[28:31], v[32:47]
    ds_read_b128 a[164:167], v2 offset:29696
    buffer_load_dwordx4 a[76:79], v1, s[8:11], s21 offen offset:3072 sc1
    v_mfma_f32_32x32x16_bf16 v[48:63], a[188:191], a[28:31], v[48:63]
    ds_read_b128 a[168:171], v2 offset:30720
    s_waitcnt lgkmcnt(3)
    s_waitcnt vmcnt(11)
    v_mfma_f32_32x32x16_bf16 v[16:31], a[144:147], a[32:35], v[16:31]
    ds_read_b128 a[172:175], v2 offset:31744
    s_add_u32 s21, s21, 4096
    buffer_load_dwordx4 a[80:83], v1, s[8:11], s21 offen offset:0 sc1
    v_mfma_f32_32x32x16_bf16 v[32:47], a[148:151], a[32:35], v[32:47]
    ds_read_b128 a[176:179], v2 offset:32768
    v_mfma_f32_32x32x16_bf16 v[48:63], a[152:155], a[32:35], v[48:63]
    ds_read_b128 a[180:183], v2 offset:33792
    buffer_load_dwordx4 a[84:87], v1, s[8:11], s21 offen offset:1024 sc1
    s_waitcnt vmcnt(12)
    v_mfma_f32_32x32x16_bf16 v[16:31], a[156:159], a[36:39], v[16:31]
    ds_read_b128 a[184:187], v2 offset:34816
    s_waitcnt lgkmcnt(3)
    v_mfma_f32_32x32x16_bf16 v[32:47], a[160:163], a[36:39], v[32:47]
    ds_read_b128 a[188:191], v2 offset:35840
    buffer_load_dwordx4 a[88:91], v1, s[8:11], s21 offen offset:2048 sc1
    v_mfma_f32_32x32x16_bf16 v[48:63], a[164:167], a[36:39], v[48:63]
    ds_read_b128 a[144:147], v3 offset:0
    s_waitcnt vmcnt(12)
    v_mfma_f32_32x32x16_bf16 v[16:31], a[168:171], a[40:43], v[16:31]
    ds_read_b128 a[148:151], v3 offset:1024
    buffer_load_dwordx4 a[92:95], v1, s[8:11], s21 offen offset:3072 sc1
    v_mfma_f32_32x32x16_bf16 v[32:47], a[172:175], a[40:43], v[32:47]
    ds_read_b128 a[152:155], v3 offset:2048
    s_waitcnt lgkmcnt(3)
    v_mfma_f32_32x32x16_bf16 v[48:63], a[176:179], a[40:43], v[48:63]
    ds_read_b128 a[156:159], v3 offset:3072
    s_add_u32 s21, s21, 4096
    buffer_load_dwordx4 a[96:99], v1, s[8:11], s21 offen offset:0 sc1
    s_waitcnt vmcnt(13)
    v_mfma_f32_32x32x16_bf16 v[16:31], a[180:183], a[44:47], v[16:31]
    ds_read_b128 a[160:163], v3 offset:4096
    v_mfma_f32_32x32x16_bf16 v[32:47], a[184:187], a[44:47], v[32:47]
    ds_read_b128 a[164:167], v3 offset:5120
    buffer_load_dwordx4 a[100:103], v1, s[8:11], s21 offen offset:1024 sc1
    v_mfma_f32_32x32x16_bf16 v[48:63], a[188:191], a[44:47], v[48:63]
    ds_read_b128 a[168:171], v3 offset:6144
    s_waitcnt lgkmcnt(3)
    s_waitcnt vmcnt(13)
    v_mfma_f32_32x32x16_bf16 v[16:31], a[144:147], a[48:51], v[16:31]
    ds_read_b128 a[172:175], v3 offset:7168
    buffer_load_dwordx4 v[232:235], v15, s[8:11], s23 offen offset:0 sc1
    buffer_load_dwordx4 v[236:239], v15, s[8:11], s23 offen offset:16 sc1
    buffer_load_dwordx4 v[240:243], v15, s[8:11], s23 offen offset:32 sc1
    v_mfma_f32_32x32x16_bf16 v[32:47], a[148:151], a[48:51], v[32:47]
    ds_read_b128 a[176:179], v3 offset:8192
    v_mfma_f32_32x32x16_bf16 v[48:63], a[152:155], a[48:51], v[48:63]
    ds_read_b128 a[180:183], v3 offset:9216
    s_mov_b32 m0, s25
    s_waitcnt vmcnt(15)
    v_mfma_f32_32x32x16_bf16 v[16:31], a[156:159], a[52:55], v[16:31]
    ds_read_b128 a[184:187], v3 offset:10240
    s_waitcnt lgkmcnt(3)
    v_mfma_f32_32x32x16_bf16 v[32:47], a[160:163], a[52:55], v[32:47]
    ds_read_b128 a[188:191], v3 offset:11264
    buffer_load_dwordx4 v1, s[12:15], s24 offen offset:0 sc1 lds
    v_mfma_f32_32x32x16_bf16 v[48:63], a[164:167], a[52:55], v[48:63]
    ds_read_b128 a[144:147], v3 offset:12288
    s_waitcnt vmcnt(15)
    v_mfma_f32_32x32x16_bf16 v[16:31], a[168:171], a[56:59], v[16:31]
    ds_read_b128 a[148:151], v3 offset:13312
    buffer_load_dwordx4 v1, s[12:15], s24 offen offset:1024 sc1 lds
    v_mfma_f32_32x32x16_bf16 v[32:47], a[172:175], a[56:59], v[32:47]
    ds_read_b128 a[152:155], v3 offset:14336
    s_waitcnt lgkmcnt(3)
    v_mfma_f32_32x32x16_bf16 v[48:63], a[176:179], a[56:59], v[48:63]
    ds_read_b128 a[156:159], v3 offset:15360
    buffer_load_dwordx4 v1, s[12:15], s24 offen offset:1280 sc1 lds
    s_waitcnt vmcnt(16)
    v_mfma_f32_32x32x16_bf16 v[16:31], a[180:183], a[60:63], v[16:31]
    ds_read_b128 a[160:163], v3 offset:16384
    v_mfma_f32_32x32x16_bf16 v[32:47], a[184:187], a[60:63], v[32:47]
    ds_read_b128 a[164:167], v3 offset:17408
    buffer_load_dwordx4 a[104:107], v1, s[8:11], s21 offen offset:2048 sc1
    v_mfma_f32_32x32x16_bf16 v[48:63], a[188:191], a[60:63], v[48:63]
    ds_read_b128 a[168:171], v3 offset:18432
    s_waitcnt lgkmcnt(3)
    s_waitcnt vmcnt(16)
    v_mfma_f32_32x32x16_bf16 v[16:31], a[144:147], a[64:67], v[16:31]
    ds_read_b128 a[172:175], v3 offset:19456
    buffer_load_dwordx4 a[108:111], v1, s[8:11], s21 offen offset:3072 sc1
    v_mfma_f32_32x32x16_bf16 v[32:47], a[148:151], a[64:67], v[32:47]
    ds_read_b128 a[176:179], v3 offset:20480
    v_mfma_f32_32x32x16_bf16 v[48:63], a[152:155], a[64:67], v[48:63]
    ds_read_b128 a[180:183], v3 offset:21504
    s_add_u32 s21, s21, 4096
    buffer_load_dwordx4 a[112:115], v1, s[8:11], s21 offen offset:0 sc1
    s_waitcnt vmcnt(17)
    v_mfma_f32_32x32x16_bf16 v[16:31], a[156:159], a[68:71], v[16:31]
    ds_read_b128 a[184:187], v3 offset:22528
    s_waitcnt lgkmcnt(3)
    v_mfma_f32_32x32x16_bf16 v[32:47], a[160:163], a[68:71], v[32:47]
    ds_read_b128 a[188:191], v3 offset:23552
    buffer_load_dwordx4 a[116:119], v1, s[8:11], s21 offen offset:1024 sc1
    v_mfma_f32_32x32x16_bf16 v[48:63], a[164:167], a[68:71], v[48:63]
    ds_read_b128 a[144:147], v3 offset:24576
    s_waitcnt vmcnt(17)
    v_mfma_f32_32x32x16_bf16 v[16:31], a[168:171], a[72:75], v[16:31]
    ds_read_b128 a[148:151], v3 offset:25600
    buffer_load_dwordx4 a[120:123], v1, s[8:11], s21 offen offset:2048 sc1
    v_mfma_f32_32x32x16_bf16 v[32:47], a[172:175], a[72:75], v[32:47]
    ds_read_b128 a[152:155], v3 offset:26624
    s_waitcnt lgkmcnt(3)
    v_mfma_f32_32x32x16_bf16 v[48:63], a[176:179], a[72:75], v[48:63]
    ds_read_b128 a[156:159], v3 offset:27648
    buffer_load_dwordx4 a[124:127], v1, s[8:11], s21 offen offset:3072 sc1
    s_waitcnt vmcnt(18)
    v_mfma_f32_32x32x16_bf16 v[16:31], a[180:183], a[76:79], v[16:31]
    ds_read_b128 a[160:163], v3 offset:28672
    v_mfma_f32_32x32x16_bf16 v[32:47], a[184:187], a[76:79], v[32:47]
    ds_read_b128 a[164:167], v3 offset:29696
    s_add_u32 s21, s21, 4096
    buffer_load_dwordx4 a[128:131], v1, s[8:11], s21 offen offset:0 sc1
    v_mfma_f32_32x32x16_bf16 v[48:63], a[188:191], a[76:79], v[48:63]
    ds_read_b128 a[168:171], v3 offset:30720
    s_waitcnt lgkmcnt(3)
    s_waitcnt vmcnt(18)
    v_mfma_f32_32x32x16_bf16 v[16:31], a[144:147], a[80:83], v[16:31]
    ds_read_b128 a[172:175], v3 offset:31744
    buffer_load_dwordx4 a[132:135], v1, s[8:11], s21 offen offset:1024 sc1
    v_mfma_f32_32x32x16_bf16 v[32:47], a[148:151], a[80:83], v[32:47]
    ds_read_b128 a[176:179], v3 offset:32768
    v_mfma_f32_32x32x16_bf16 v[48:63], a[152:155], a[80:83], v[48:63]
    ds_read_b128 a[180:183], v3 offset:33792
    buffer_load_dwordx4 a[136:139], v1, s[8:11], s21 offen offset:2048 sc1
    s_waitcnt vmcnt(19)
    v_mfma_f32_32x32x16_bf16 v[16:31], a[156:159], a[84:87], v[16:31]
    ds_read_b128 a[184:187], v3 offset:34816
    s_barrier
    s_waitcnt lgkmcnt(3)
    v_mfma_f32_32x32x16_bf16 v[32:47], a[160:163], a[84:87], v[32:47]
    ds_read_b128 a[188:191], v3 offset:35840
    buffer_load_dwordx4 a[140:143], v1, s[8:11], s21 offen offset:3072 sc1
    v_mfma_f32_32x32x16_bf16 v[48:63], a[164:167], a[84:87], v[48:63]
    ds_read_b128 a[144:147], v4 offset:0
    s_waitcnt vmcnt(19)
    v_mfma_f32_32x32x16_bf16 v[16:31], a[168:171], a[88:91], v[16:31]
    ds_read_b128 a[148:151], v4 offset:1024
    s_add_u32 m0, s18, 0
    s_add_u32 s19, s17, 147456
    v_mfma_f32_32x32x16_bf16 v[32:47], a[172:175], a[88:91], v[32:47]
    ds_read_b128 a[152:155], v4 offset:2048
    s_waitcnt lgkmcnt(3)
    v_mfma_f32_32x32x16_bf16 v[48:63], a[176:179], a[88:91], v[48:63]
    ds_read_b128 a[156:159], v4 offset:3072
    buffer_load_dwordx4 v1, s[12:15], s19 offen offset:0 lds
    s_waitcnt vmcnt(19)
    v_mfma_f32_32x32x16_bf16 v[16:31], a[180:183], a[92:95], v[16:31]
    ds_read_b128 a[160:163], v4 offset:4096
    v_mfma_f32_32x32x16_bf16 v[32:47], a[184:187], a[92:95], v[32:47]
    ds_read_b128 a[164:167], v4 offset:5120
    buffer_load_dwordx4 v1, s[12:15], s19 offen offset:1024 lds
    v_mfma_f32_32x32x16_bf16 v[48:63], a[188:191], a[92:95], v[48:63]
    ds_read_b128 a[168:171], v4 offset:6144
    s_waitcnt lgkmcnt(3)
    s_waitcnt vmcnt(19)
    v_mfma_f32_32x32x16_bf16 v[16:31], a[144:147], a[96:99], v[16:31]
    ds_read_b128 a[172:175], v4 offset:7168
    buffer_load_dwordx4 v1, s[12:15], s19 offen offset:2048 lds
    s_waitcnt vmcnt(16)
    v_mfma_f32_32x32x16_bf16 v[32:47], a[148:151], a[96:99], v[32:47]
    ds_read_b128 a[176:179], v4 offset:8192
    v_add_f32 v12, v232, v234
    v_add_f32 v12, v12, v236
    v_mfma_f32_32x32x16_bf16 v[48:63], a[152:155], a[96:99], v[48:63]
    ds_read_b128 a[180:183], v4 offset:9216
    buffer_load_dwordx4 v1, s[12:15], s19 offen offset:3072 lds
    v_add_f32 v12, v12, v238
    v_add_f32 v12, v12, v240
    v_mfma_f32_32x32x16_bf16 v[16:31], a[156:159], a[100:103], v[16:31]
    ds_read_b128 a[184:187], v4 offset:10240
    v_add_f32 v12, v12, v242
    v_mul_f32 v12, 0x3ae38e39, v12
    s_waitcnt lgkmcnt(3)
    v_mfma_f32_32x32x16_bf16 v[32:47], a[160:163], a[100:103], v[32:47]
    ds_read_b128 a[188:191], v4 offset:11264
    s_add_u32 m0, s18, 4096
    s_add_u32 s19, s17, 151552
    v_add_f32 v13, v233, v235
    v_mfma_f32_32x32x16_bf16 v[48:63], a[164:167], a[100:103], v[48:63]
    ds_read_b128 a[144:147], v4 offset:12288
    v_add_f32 v13, v13, v237
    v_add_f32 v13, v13, v239
    s_waitcnt vmcnt(13)
    v_mfma_f32_32x32x16_bf16 v[16:31], a[168:171], a[104:107], v[16:31]
    ds_read_b128 a[148:151], v4 offset:13312
    buffer_load_dwordx4 v1, s[12:15], s19 offen offset:0 lds
    v_add_f32 v13, v13, v241
    v_add_f32 v13, v13, v243
    v_mfma_f32_32x32x16_bf16 v[32:47], a[172:175], a[104:107], v[32:47]
    ds_read_b128 a[152:155], v4 offset:14336
    s_mov_b32 s41, 0x3c2aaaab
    v_fma_f32 v232, v232, s41, -v12
    s_waitcnt lgkmcnt(3)
    v_mfma_f32_32x32x16_bf16 v[48:63], a[176:179], a[104:107], v[48:63]
    ds_read_b128 a[156:159], v4 offset:15360
    buffer_load_dwordx4 v1, s[12:15], s19 offen offset:1024 lds
    v_fma_f32 v234, v234, s41, -v12
    v_fma_f32 v236, v236, s41, -v12
    s_waitcnt vmcnt(14)
    v_mfma_f32_32x32x16_bf16 v[16:31], a[180:183], a[108:111], v[16:31]
    ds_read_b128 a[160:163], v4 offset:16384
    v_fma_f32 v238, v238, s41, -v12
    v_fma_f32 v240, v240, s41, -v12
    v_mfma_f32_32x32x16_bf16 v[32:47], a[184:187], a[108:111], v[32:47]
    ds_read_b128 a[164:167], v4 offset:17408
    buffer_load_dwordx4 v1, s[12:15], s19 offen offset:2048 lds
    v_fma_f32 v242, v242, s41, -v12
    v_mfma_f32_32x32x16_bf16 v[48:63], a[188:191], a[108:111], v[48:63]
    ds_read_b128 a[168:171], v4 offset:18432
    v_mul_f32 v14, v232, v232
    v_fmac_f32 v14, v234, v234
    s_waitcnt lgkmcnt(3)
    s_waitcnt vmcnt(14)
    v_mfma_f32_32x32x16_bf16 v[16:31], a[144:147], a[112:115], v[16:31]
    ds_read_b128 a[172:175], v4 offset:19456
    buffer_load_dwordx4 v1, s[12:15], s19 offen offset:3072 lds
    v_fmac_f32 v14, v236, v236
    v_fmac_f32 v14, v238, v238
    v_mfma_f32_32x32x16_bf16 v[32:47], a[148:151], a[112:115], v[32:47]
    ds_read_b128 a[176:179], v4 offset:20480
    v_fmac_f32 v14, v240, v240
    v_fmac_f32 v14, v242, v242
    v_mfma_f32_32x32x16_bf16 v[48:63], a[152:155], a[112:115], v[48:63]
    ds_read_b128 a[180:183], v4 offset:21504
    s_add_u32 m0, s18, 8192
    s_add_u32 s19, s17, 155648
    v_fmac_f32 v13, 0x42c00000, v14
    v_mul_f32 v13, 0x3ae38e39, v13
    s_waitcnt vmcnt(14)
    v_mfma_f32_32x32x16_bf16 v[16:31], a[156:159], a[116:119], v[16:31]
    ds_read_b128 a[184:187], v4 offset:22528
    v_cvt_pk_bf16_f32 v14, v13, v13
    s_waitcnt lgkmcnt(3)
    v_mfma_f32_32x32x16_bf16 v[32:47], a[160:163], a[116:119], v[32:47]
    ds_read_b128 a[188:191], v4 offset:23552
    buffer_load_dwordx4 v1, s[12:15], s19 offen offset:0 lds
    v_lshlrev_b32 v13, 16, v14
    v_add_f32 v13, 0x3727c5ac, v13
    v_mfma_f32_32x32x16_bf16 v[48:63], a[164:167], a[116:119], v[48:63]
    ds_read_b128 a[144:147], v4 offset:24576
    v_cvt_pk_bf16_f32 v14, v13, v13
    v_lshlrev_b32 v13, 16, v14
    s_waitcnt vmcnt(14)
    v_mfma_f32_32x32x16_bf16 v[16:31], a[168:171], a[120:123], v[16:31]
    ds_read_b128 a[148:151], v4 offset:25600
    v_sqrt_f32 v13, v13
    s_nop 0
    v_cvt_pk_bf16_f32 v14, v13, v13
    v_mfma_f32_32x32x16_bf16 v[32:47], a[172:175], a[120:123], v[32:47]
    ds_read_b128 a[152:155], v4 offset:26624
    v_lshlrev_b32 v13, 16, v14
    v_cvt_pk_bf16_f32 v14, v12, v12
    s_waitcnt lgkmcnt(3)
    v_mfma_f32_32x32x16_bf16 v[48:63], a[176:179], a[120:123], v[48:63]
    ds_read_b128 a[156:159], v4 offset:27648
    v_lshlrev_b32 v12, 16, v14
    s_waitcnt vmcnt(13)
    v_mfma_f32_32x32x16_bf16 v[16:31], a[180:183], a[124:127], v[16:31]
    ds_read_b128 a[160:163], v4 offset:28672
    v_rcp_f32 v14, v13
    v_cmp_gt_u32 vcc, 32, v0
    v_mfma_f32_32x32x16_bf16 v[32:47], a[184:187], a[124:127], v[32:47]
    ds_read_b128 a[164:167], v4 offset:29696
    v_sub_f32 v12, 0, v12
    v_mul_f32 v7, 0xc0135761, v14
    v_mfma_f32_32x32x16_bf16 v[48:63], a[188:191], a[124:127], v[48:63]
    ds_read_b128 a[168:171], v4 offset:30720
    v_mul_f32 v8, v14, v14
    v_mul_f32 v8, v8, v14
    s_waitcnt lgkmcnt(3)
    s_waitcnt vmcnt(12)
    v_mfma_f32_32x32x16_bf16 v[16:31], a[144:147], a[128:131], v[16:31]
    ds_read_b128 a[172:175], v4 offset:31744
    v_mul_f32 v8, 0xbdd2d3e8, v8
    v_cvt_pk_bf16_f32 v13, v12, v13
    v_mfma_f32_32x32x16_bf16 v[32:47], a[148:151], a[128:131], v[32:47]
    ds_read_b128 a[176:179], v4 offset:32768
    v_cvt_pk_bf16_f32 v12, v12, v12
    v_mfma_f32_32x32x16_bf16 v[48:63], a[152:155], a[128:131], v[48:63]
    ds_read_b128 a[180:183], v4 offset:33792
    v_cndmask_b32 v12, 0, v12, vcc
    v_cndmask_b32 v13, 0, v13, vcc
    s_waitcnt vmcnt(11)
    v_mfma_f32_32x32x16_bf16 v[16:31], a[156:159], a[132:135], v[16:31]
    ds_read_b128 a[184:187], v4 offset:34816
    v_mov_b32 v14, 0
    v_mov_b32 v15, 0
    s_barrier
    s_waitcnt lgkmcnt(3)
    v_mfma_f32_32x32x16_bf16 v[32:47], a[160:163], a[132:135], v[32:47]
    ds_read_b128 a[188:191], v4 offset:35840
    s_add_u32 m0, s18, 36864
    s_add_u32 s19, s17, 184320
    v_mfma_f32_32x32x16_bf16 v[48:63], a[164:167], a[132:135], v[48:63]
    ds_read_b128 a[144:147], v6 offset:0
    s_waitcnt vmcnt(10)
    v_mfma_f32_32x32x16_bf16 v[16:31], a[168:171], a[136:139], v[16:31]
    ds_read_b128 a[148:151], v6 offset:1024
    buffer_load_dwordx4 v1, s[12:15], s19 offen offset:0 lds
    v_mfma_f32_32x32x16_bf16 v[32:47], a[172:175], a[136:139], v[32:47]
    ds_read_b128 a[152:155], v6 offset:2048
    s_waitcnt lgkmcnt(3)
    v_mfma_f32_32x32x16_bf16 v[48:63], a[176:179], a[136:139], v[48:63]
    ds_read_b128 a[156:159], v5 offset:0
    buffer_load_dwordx4 v1, s[12:15], s19 offen offset:1024 lds
    s_waitcnt vmcnt(11)
    v_mfma_f32_32x32x16_bf16 v[16:31], a[180:183], a[140:143], v[16:31]
    ds_read_b128 a[160:163], v5 offset:1024
    v_mfma_f32_32x32x16_bf16 v[32:47], a[184:187], a[140:143], v[32:47]
    ds_read_b128 a[164:167], v5 offset:2048
    buffer_load_dwordx4 v1, s[12:15], s19 offen offset:2048 lds
    v_mfma_f32_32x32x16_bf16 v[48:63], a[188:191], a[140:143], v[48:63]
    ds_read_b128 a[168:171], v5 offset:3072
    s_waitcnt lgkmcnt(3)
    v_mfma_f32_32x32x16_bf16 v[16:31], a[144:147], v[12:15], v[16:31]
    ds_read_b128 a[172:175], v5 offset:4096
    buffer_load_dwordx4 v1, s[12:15], s19 offen offset:3072 lds
    v_mfma_f32_32x32x16_bf16 v[32:47], a[148:151], v[12:15], v[32:47]
    ds_read_b128 a[176:179], v5 offset:5120
    v_mfma_f32_32x32x16_bf16 v[48:63], a[152:155], v[12:15], v[48:63]
    ds_read_b128 a[180:183], v5 offset:6144
    s_add_u32 m0, s18, 40960
    s_add_u32 s19, s17, 188416
    s_nop 3
    v_mul_f32 v232, v16, v16
    v_mul_f32 v233, v17, v17
    v_mul_f32 v234, v18, v18
    v_mul_f32 v235, v19, v19
    v_mfma_f32_32x32x16_bf16 v[64:79], a[156:159], a[0:3], 0
    ds_read_b128 a[184:187], v5 offset:7168
    v_fma_f32 v232, v232, v8, v7
    v_fma_f32 v233, v233, v8, v7
    v_fma_f32 v234, v234, v8, v7
    v_fma_f32 v235, v235, v8, v7
    v_mul_f32 v232, v232, v16
    s_waitcnt lgkmcnt(3)
    v_mfma_f32_32x32x16_bf16 v[64:79], a[160:163], a[4:7], v[64:79]
    ds_read_b128 a[188:191], v5 offset:8192
    buffer_load_dwordx4 v1, s[12:15], s19 offen offset:0 lds
    v_mul_f32 v233, v233, v17
    v_mul_f32 v234, v234, v18
    v_mul_f32 v235, v235, v19
    v_exp_f32 v232, v232
    v_mfma_f32_32x32x16_bf16 v[64:79], a[164:167], a[8:11], v[64:79]
    ds_read_b128 a[144:147], v5 offset:9216
    v_exp_f32 v233, v233
    v_exp_f32 v234, v234
    v_mfma_f32_32x32x16_bf16 v[64:79], a[168:171], a[12:15], v[64:79]
    ds_read_b128 a[148:151], v5 offset:10240
    buffer_load_dwordx4 v1, s[12:15], s19 offen offset:1024 lds
    v_exp_f32 v235, v235
    v_add_f32 v232, 1.0, v232
    v_add_f32 v233, 1.0, v233
    v_add_f32 v234, 1.0, v234
    v_add_f32 v235, 1.0, v235
    v_mfma_f32_32x32x16_bf16 v[64:79], a[172:175], a[16:19], v[64:79]
    ds_read_b128 a[152:155], v5 offset:11264
    v_rcp_f32 v232, v232
    v_rcp_f32 v233, v233
    s_waitcnt lgkmcnt(3)
    v_mfma_f32_32x32x16_bf16 v[64:79], a[176:179], a[20:23], v[64:79]
    ds_read_b128 a[156:159], v5 offset:12288
    buffer_load_dwordx4 v1, s[12:15], s19 offen offset:2048 lds
    v_rcp_f32 v234, v234
    v_rcp_f32 v235, v235
    v_mul_f32 v232, v16, v232
    v_mfma_f32_32x32x16_bf16 v[64:79], a[180:183], a[24:27], v[64:79]
    ds_read_b128 a[160:163], v5 offset:13312
    v_mul_f32 v233, v17, v233
    v_mul_f32 v234, v18, v234
    v_mul_f32 v235, v19, v235
    v_cvt_pk_bf16_f32 v160, v232, v233
    v_cvt_pk_bf16_f32 v161, v234, v235
    v_mfma_f32_32x32x16_bf16 v[64:79], a[184:187], a[28:31], v[64:79]
    ds_read_b128 a[164:167], v5 offset:14336
    buffer_load_dwordx4 v1, s[12:15], s19 offen offset:3072 lds
    v_mul_f32 v236, v20, v20
    v_mul_f32 v237, v21, v21
    v_mul_f32 v238, v22, v22
    v_mul_f32 v239, v23, v23
    v_fma_f32 v236, v236, v8, v7
    v_mfma_f32_32x32x16_bf16 v[64:79], a[188:191], a[32:35], v[64:79]
    ds_read_b128 a[168:171], v5 offset:15360
    v_fma_f32 v237, v237, v8, v7
    v_fma_f32 v238, v238, v8, v7
    v_fma_f32 v239, v239, v8, v7
    v_mul_f32 v236, v236, v20
    v_mul_f32 v237, v237, v21
    s_waitcnt lgkmcnt(3)
    v_mfma_f32_32x32x16_bf16 v[64:79], a[144:147], a[36:39], v[64:79]
    ds_read_b128 a[172:175], v5 offset:16384
    s_add_u32 m0, s18, 45056
    s_add_u32 s19, s17, 192512
    v_mul_f32 v238, v238, v22
    v_mul_f32 v239, v239, v23
    v_exp_f32 v236, v236
    v_mfma_f32_32x32x16_bf16 v[64:79], a[148:151], a[40:43], v[64:79]
    ds_read_b128 a[176:179], v5 offset:17408
    v_exp_f32 v237, v237
    v_exp_f32 v238, v238
    v_exp_f32 v239, v239
    v_mfma_f32_32x32x16_bf16 v[64:79], a[152:155], a[44:47], v[64:79]
    ds_read_b128 a[180:183], v5 offset:18432
    buffer_load_dwordx4 v1, s[12:15], s19 offen offset:0 lds
    v_add_f32 v236, 1.0, v236
    v_add_f32 v237, 1.0, v237
    v_add_f32 v238, 1.0, v238
    v_add_f32 v239, 1.0, v239
    v_mfma_f32_32x32x16_bf16 v[64:79], a[156:159], a[48:51], v[64:79]
    ds_read_b128 a[184:187], v5 offset:19456
    v_rcp_f32 v236, v236
    v_rcp_f32 v237, v237
    s_waitcnt lgkmcnt(3)
    v_mfma_f32_32x32x16_bf16 v[64:79], a[160:163], a[52:55], v[64:79]
    ds_read_b128 a[188:191], v5 offset:20480
    v_rcp_f32 v238, v238
    v_rcp_f32 v239, v239
    v_mul_f32 v236, v20, v236
    v_mul_f32 v237, v21, v237
    v_mfma_f32_32x32x16_bf16 v[64:79], a[164:167], a[56:59], v[64:79]
    ds_read_b128 a[144:147], v5 offset:21504
    v_mul_f32 v238, v22, v238
    v_mul_f32 v239, v23, v239
    v_cvt_pk_bf16_f32 v162, v236, v237
    v_cvt_pk_bf16_f32 v163, v238, v239
    v_mfma_f32_32x32x16_bf16 v[64:79], a[168:171], a[60:63], v[64:79]
    ds_read_b128 a[148:151], v5 offset:22528
    s_add_u32 s26, s90, 0
    buffer_store_dwordx4 v[160:163], v1, s[8:11], s26 offen offset:0 sc1
    v_mul_f32 v240, v24, v24
    v_mul_f32 v241, v25, v25
    v_mul_f32 v242, v26, v26
    v_mul_f32 v243, v27, v27
    v_mfma_f32_32x32x16_bf16 v[64:79], a[172:175], a[64:67], v[64:79]
    ds_read_b128 a[152:155], v5 offset:23552
    v_fma_f32 v240, v240, v8, v7
    v_fma_f32 v241, v241, v8, v7
    v_fma_f32 v242, v242, v8, v7
    v_fma_f32 v243, v243, v8, v7
    v_mul_f32 v240, v240, v24
    s_waitcnt lgkmcnt(3)
    v_mfma_f32_32x32x16_bf16 v[64:79], a[176:179], a[68:71], v[64:79]
    ds_read_b128 a[156:159], v5 offset:24576
    v_mul_f32 v241, v241, v25
    v_mul_f32 v242, v242, v26
    v_mul_f32 v243, v243, v27
    v_exp_f32 v240, v240
    v_mfma_f32_32x32x16_bf16 v[64:79], a[180:183], a[72:75], v[64:79]
    ds_read_b128 a[160:163], v5 offset:25600
    v_exp_f32 v241, v241
    v_exp_f32 v242, v242
    v_mfma_f32_32x32x16_bf16 v[64:79], a[184:187], a[76:79], v[64:79]
    ds_read_b128 a[164:167], v5 offset:26624
    v_exp_f32 v243, v243
    v_add_f32 v240, 1.0, v240
    v_add_f32 v241, 1.0, v241
    v_add_f32 v242, 1.0, v242
    v_mfma_f32_32x32x16_bf16 v[64:79], a[188:191], a[80:83], v[64:79]
    ds_read_b128 a[168:171], v5 offset:27648
    v_add_f32 v243, 1.0, v243
    v_rcp_f32 v240, v240
    v_rcp_f32 v241, v241
    s_waitcnt lgkmcnt(3)
    v_mfma_f32_32x32x16_bf16 v[64:79], a[144:147], a[84:87], v[64:79]
    ds_read_b128 a[172:175], v5 offset:28672
    v_rcp_f32 v242, v242
    v_rcp_f32 v243, v243
    v_mul_f32 v240, v24, v240
    v_mfma_f32_32x32x16_bf16 v[64:79], a[148:151], a[88:91], v[64:79]
    ds_read_b128 a[176:179], v5 offset:29696
    v_mul_f32 v241, v25, v241
    v_mul_f32 v242, v26, v242
    v_mul_f32 v243, v27, v243
    v_cvt_pk_bf16_f32 v164, v240, v241
    v_cvt_pk_bf16_f32 v165, v242, v243
    v_mfma_f32_32x32x16_bf16 v[64:79], a[152:155], a[92:95], v[64:79]
    ds_read_b128 a[180:183], v5 offset:30720
    v_mul_f32 v244, v28, v28
    v_mul_f32 v245, v29, v29
    v_mul_f32 v246, v30, v30
    v_mul_f32 v247, v31, v31
    v_fma_f32 v244, v244, v8, v7
    v_mfma_f32_32x32x16_bf16 v[64:79], a[156:159], a[96:99], v[64:79]
    ds_read_b128 a[184:187], v5 offset:31744
    v_fma_f32 v245, v245, v8, v7
    v_fma_f32 v246, v246, v8, v7
    v_fma_f32 v247, v247, v8, v7
    v_mul_f32 v244, v244, v28
    s_waitcnt lgkmcnt(3)
    v_mfma_f32_32x32x16_bf16 v[64:79], a[160:163], a[100:103], v[64:79]
    ds_read_b128 a[188:191], v5 offset:32768
    v_mul_f32 v245, v245, v29
    v_mul_f32 v246, v246, v30
    v_mul_f32 v247, v247, v31
    v_exp_f32 v244, v244
    v_mfma_f32_32x32x16_bf16 v[64:79], a[164:167], a[104:107], v[64:79]
    ds_read_b128 a[144:147], v5 offset:33792
    v_exp_f32 v245, v245
    v_exp_f32 v246, v246
    v_mfma_f32_32x32x16_bf16 v[64:79], a[168:171], a[108:111], v[64:79]
    ds_read_b128 a[148:151], v5 offset:34816
    v_exp_f32 v247, v247
    v_add_f32 v244, 1.0, v244
    v_add_f32 v245, 1.0, v245
    v_add_f32 v246, 1.0, v246
    v_add_f32 v247, 1.0, v247
    v_mfma_f32_32x32x16_bf16 v[64:79], a[172:175], a[112:115], v[64:79]
    ds_read_b128 a[152:155], v5 offset:35840
    v_rcp_f32 v244, v244
    v_rcp_f32 v245, v245
    s_waitcnt vmcnt(10)
    s_barrier
    s_waitcnt lgkmcnt(3)
    v_mfma_f32_32x32x16_bf16 v[64:79], a[176:179], a[116:119], v[64:79]
    ds_read_b128 a[156:159], v6 offset:3072
    s_add_u32 m0, s18, 73728
    s_add_u32 s19, s17, 221184
    v_rcp_f32 v246, v246
    v_rcp_f32 v247, v247
    v_mul_f32 v244, v28, v244
    v_mul_f32 v245, v29, v245
    v_mfma_f32_32x32x16_bf16 v[64:79], a[180:183], a[120:123], v[64:79]
    ds_read_b128 a[160:163], v2 offset:0
    v_mul_f32 v246, v30, v246
    v_mul_f32 v247, v31, v247
    v_cvt_pk_bf16_f32 v166, v244, v245
    v_cvt_pk_bf16_f32 v167, v246, v247
    v_mfma_f32_32x32x16_bf16 v[64:79], a[184:187], a[124:127], v[64:79]
    ds_read_b128 a[164:167], v2 offset:1024
    buffer_load_dwordx4 v1, s[12:15], s19 offen offset:0 lds
    s_add_u32 s26, s90, 0
    buffer_store_dwordx4 v[164:167], v1, s[8:11], s26 offen offset:1024 sc1
    v_mul_f32 v232, v32, v32
    v_mul_f32 v233, v33, v33
    v_mul_f32 v234, v34, v34
    v_mfma_f32_32x32x16_bf16 v[64:79], a[188:191], a[128:131], v[64:79]
    ds_read_b128 a[168:171], v2 offset:2048
    v_mul_f32 v235, v35, v35
    v_fma_f32 v232, v232, v8, v7
    v_fma_f32 v233, v233, v8, v7
    v_fma_f32 v234, v234, v8, v7
    v_fma_f32 v235, v235, v8, v7
    s_waitcnt lgkmcnt(3)
    v_mfma_f32_32x32x16_bf16 v[64:79], a[144:147], a[132:135], v[64:79]
    ds_read_b128 a[172:175], v2 offset:3072
    buffer_load_dwordx4 v1, s[12:15], s19 offen offset:1024 lds
    v_mul_f32 v232, v232, v32
    v_mul_f32 v233, v233, v33
    v_mul_f32 v234, v234, v34
    v_mul_f32 v235, v235, v35
    v_mfma_f32_32x32x16_bf16 v[64:79], a[148:151], a[136:139], v[64:79]
    ds_read_b128 a[176:179], v2 offset:4096
    v_exp_f32 v232, v232
    v_exp_f32 v233, v233
    v_exp_f32 v234, v234
    v_mfma_f32_32x32x16_bf16 v[64:79], a[152:155], a[140:143], v[64:79]
    ds_read_b128 a[180:183], v2 offset:5120
    buffer_load_dwordx4 v1, s[12:15], s19 offen offset:2048 lds
    v_exp_f32 v235, v235
    v_add_f32 v232, 1.0, v232
    v_add_f32 v233, 1.0, v233
    v_add_f32 v234, 1.0, v234
    v_mfma_f32_32x32x16_bf16 v[64:79], a[156:159], v[12:15], v[64:79]
    ds_read_b128 a[184:187], v2 offset:6144
    v_add_f32 v235, 1.0, v235
    v_rcp_f32 v232, v232
    v_rcp_f32 v233, v233
    s_waitcnt lgkmcnt(3)
    v_mfma_f32_32x32x16_bf16 v[80:95], a[160:163], a[0:3], 0
    ds_read_b128 a[188:191], v2 offset:7168
    buffer_load_dwordx4 v1, s[12:15], s19 offen offset:3072 lds
    v_rcp_f32 v234, v234
    v_rcp_f32 v235, v235
    v_mfma_f32_32x32x16_bf16 v[80:95], a[164:167], a[4:7], v[80:95]
    ds_read_b128 a[144:147], v2 offset:8192
    v_mul_f32 v232, v32, v232
    v_mul_f32 v233, v33, v233
    v_mul_f32 v234, v34, v234
    v_mul_f32 v235, v35, v235
    v_cvt_pk_bf16_f32 v168, v232, v233
    v_mfma_f32_32x32x16_bf16 v[80:95], a[168:171], a[8:11], v[80:95]
    ds_read_b128 a[148:151], v2 offset:9216
    s_add_u32 m0, s18, 77824
    s_add_u32 s19, s17, 225280
    v_cvt_pk_bf16_f32 v169, v234, v235
    v_mul_f32 v236, v36, v36
    v_mul_f32 v237, v37, v37
    v_mul_f32 v238, v38, v38
    v_mul_f32 v239, v39, v39
    v_mfma_f32_32x32x16_bf16 v[80:95], a[172:175], a[12:15], v[80:95]
    ds_read_b128 a[152:155], v2 offset:10240
    v_fma_f32 v236, v236, v8, v7
    v_fma_f32 v237, v237, v8, v7
    v_fma_f32 v238, v238, v8, v7
    v_fma_f32 v239, v239, v8, v7
    v_mul_f32 v236, v236, v36
    s_waitcnt lgkmcnt(3)
    v_mfma_f32_32x32x16_bf16 v[80:95], a[176:179], a[16:19], v[80:95]
    ds_read_b128 a[156:159], v2 offset:11264
    buffer_load_dwordx4 v1, s[12:15], s19 offen offset:0 lds
    v_mul_f32 v237, v237, v37
    v_mul_f32 v238, v238, v38
    v_mul_f32 v239, v239, v39
    v_exp_f32 v236, v236
    v_mfma_f32_32x32x16_bf16 v[80:95], a[180:183], a[20:23], v[80:95]
    ds_read_b128 a[160:163], v2 offset:12288
    v_exp_f32 v237, v237
    v_exp_f32 v238, v238
    v_mfma_f32_32x32x16_bf16 v[80:95], a[184:187], a[24:27], v[80:95]
    ds_read_b128 a[164:167], v2 offset:13312
    buffer_load_dwordx4 v1, s[12:15], s19 offen offset:1024 lds
    v_exp_f32 v239, v239
    v_add_f32 v236, 1.0, v236
    v_add_f32 v237, 1.0, v237
    v_add_f32 v238, 1.0, v238
    v_mfma_f32_32x32x16_bf16 v[80:95], a[188:191], a[28:31], v[80:95]
    ds_read_b128 a[168:171], v2 offset:14336
    v_add_f32 v239, 1.0, v239
    v_rcp_f32 v236, v236
    v_rcp_f32 v237, v237
    s_waitcnt lgkmcnt(3)
    v_mfma_f32_32x32x16_bf16 v[80:95], a[144:147], a[32:35], v[80:95]
    ds_read_b128 a[172:175], v2 offset:15360
    buffer_load_dwordx4 v1, s[12:15], s19 offen offset:2048 lds
    v_rcp_f32 v238, v238
    v_rcp_f32 v239, v239
    v_mul_f32 v236, v36, v236
    v_mfma_f32_32x32x16_bf16 v[80:95], a[148:151], a[36:39], v[80:95]
    ds_read_b128 a[176:179], v2 offset:16384
    v_mul_f32 v237, v37, v237
    v_mul_f32 v238, v38, v238
    v_mul_f32 v239, v39, v239
    v_cvt_pk_bf16_f32 v170, v236, v237
    v_cvt_pk_bf16_f32 v171, v238, v239
    v_mfma_f32_32x32x16_bf16 v[80:95], a[152:155], a[40:43], v[80:95]
    ds_read_b128 a[180:183], v2 offset:17408
    buffer_load_dwordx4 v1, s[12:15], s19 offen offset:3072 lds
    s_add_u32 s26, s90, 0
    buffer_store_dwordx4 v[168:171], v1, s[8:11], s26 offen offset:2048 sc1
    v_mul_f32 v240, v40, v40
    v_mul_f32 v241, v41, v41
    v_mul_f32 v242, v42, v42
    v_mfma_f32_32x32x16_bf16 v[80:95], a[156:159], a[44:47], v[80:95]
    ds_read_b128 a[184:187], v2 offset:18432
    v_mul_f32 v243, v43, v43
    v_fma_f32 v240, v240, v8, v7
    v_fma_f32 v241, v241, v8, v7
    v_fma_f32 v242, v242, v8, v7
    v_fma_f32 v243, v243, v8, v7
    s_waitcnt lgkmcnt(3)
    v_mfma_f32_32x32x16_bf16 v[80:95], a[160:163], a[48:51], v[80:95]
    ds_read_b128 a[188:191], v2 offset:19456
    s_add_u32 m0, s18, 81920
    s_add_u32 s19, s17, 229376
    v_mul_f32 v240, v240, v40
    v_mul_f32 v241, v241, v41
    v_mul_f32 v242, v242, v42
    v_mul_f32 v243, v243, v43
    v_mfma_f32_32x32x16_bf16 v[80:95], a[164:167], a[52:55], v[80:95]
    ds_read_b128 a[144:147], v2 offset:20480
    v_exp_f32 v240, v240
    v_exp_f32 v241, v241
    v_mfma_f32_32x32x16_bf16 v[80:95], a[168:171], a[56:59], v[80:95]
    ds_read_b128 a[148:151], v2 offset:21504
    buffer_load_dwordx4 v1, s[12:15], s19 offen offset:0 lds
    v_exp_f32 v242, v242
    v_exp_f32 v243, v243
    v_add_f32 v240, 1.0, v240
    v_add_f32 v241, 1.0, v241
    v_mfma_f32_32x32x16_bf16 v[80:95], a[172:175], a[60:63], v[80:95]
    ds_read_b128 a[152:155], v2 offset:22528
    v_add_f32 v242, 1.0, v242
    v_add_f32 v243, 1.0, v243
    v_rcp_f32 v240, v240
    s_waitcnt lgkmcnt(3)
    v_mfma_f32_32x32x16_bf16 v[80:95], a[176:179], a[64:67], v[80:95]
    ds_read_b128 a[156:159], v2 offset:23552
    v_rcp_f32 v241, v241
    v_rcp_f32 v242, v242
    v_rcp_f32 v243, v243
    v_mfma_f32_32x32x16_bf16 v[80:95], a[180:183], a[68:71], v[80:95]
    ds_read_b128 a[160:163], v2 offset:24576
    v_mul_f32 v240, v40, v240
    v_mul_f32 v241, v41, v241
    v_mul_f32 v242, v42, v242
    v_mul_f32 v243, v43, v243
    v_cvt_pk_bf16_f32 v172, v240, v241
    v_mfma_f32_32x32x16_bf16 v[80:95], a[184:187], a[72:75], v[80:95]
    ds_read_b128 a[164:167], v2 offset:25600
    v_cvt_pk_bf16_f32 v173, v242, v243
    v_mul_f32 v244, v44, v44
    v_mul_f32 v245, v45, v45
    v_mul_f32 v246, v46, v46
    v_mul_f32 v247, v47, v47
    v_mfma_f32_32x32x16_bf16 v[80:95], a[188:191], a[76:79], v[80:95]
    ds_read_b128 a[168:171], v2 offset:26624
    v_fma_f32 v244, v244, v8, v7
    v_fma_f32 v245, v245, v8, v7
    v_fma_f32 v246, v246, v8, v7
    v_fma_f32 v247, v247, v8, v7
    s_waitcnt lgkmcnt(3)
    v_mfma_f32_32x32x16_bf16 v[80:95], a[144:147], a[80:83], v[80:95]
    ds_read_b128 a[172:175], v2 offset:27648
    v_mul_f32 v244, v244, v44
    v_mul_f32 v245, v245, v45
    v_mul_f32 v246, v246, v46
    v_mul_f32 v247, v247, v47
    v_mfma_f32_32x32x16_bf16 v[80:95], a[148:151], a[84:87], v[80:95]
    ds_read_b128 a[176:179], v2 offset:28672
    v_exp_f32 v244, v244
    v_exp_f32 v245, v245
    v_exp_f32 v246, v246
    v_mfma_f32_32x32x16_bf16 v[80:95], a[152:155], a[88:91], v[80:95]
    ds_read_b128 a[180:183], v2 offset:29696
    v_exp_f32 v247, v247
    v_add_f32 v244, 1.0, v244
    v_add_f32 v245, 1.0, v245
    v_add_f32 v246, 1.0, v246
    v_mfma_f32_32x32x16_bf16 v[80:95], a[156:159], a[92:95], v[80:95]
    ds_read_b128 a[184:187], v2 offset:30720
    v_add_f32 v247, 1.0, v247
    v_rcp_f32 v244, v244
    v_rcp_f32 v245, v245
    s_waitcnt lgkmcnt(3)
    v_mfma_f32_32x32x16_bf16 v[80:95], a[160:163], a[96:99], v[80:95]
    ds_read_b128 a[188:191], v2 offset:31744
    v_rcp_f32 v246, v246
    v_rcp_f32 v247, v247
    v_mul_f32 v244, v44, v244
    v_mfma_f32_32x32x16_bf16 v[80:95], a[164:167], a[100:103], v[80:95]
    ds_read_b128 a[144:147], v2 offset:32768
    v_mul_f32 v245, v45, v245
    v_mul_f32 v246, v46, v246
    v_mul_f32 v247, v47, v247
    v_cvt_pk_bf16_f32 v174, v244, v245
    v_cvt_pk_bf16_f32 v175, v246, v247
    v_mfma_f32_32x32x16_bf16 v[80:95], a[168:171], a[104:107], v[80:95]
    ds_read_b128 a[148:151], v2 offset:33792
    s_add_u32 s26, s90, 0
    buffer_store_dwordx4 v[172:175], v1, s[8:11], s26 offen offset:3072 sc1
    v_mul_f32 v232, v48, v48
    v_mul_f32 v233, v49, v49
    v_mfma_f32_32x32x16_bf16 v[80:95], a[172:175], a[108:111], v[80:95]
    ds_read_b128 a[152:155], v2 offset:34816
    v_mul_f32 v234, v50, v50
    v_mul_f32 v235, v51, v51
    v_fma_f32 v232, v232, v8, v7
    v_fma_f32 v233, v233, v8, v7
    v_fma_f32 v234, v234, v8, v7
    s_waitcnt lgkmcnt(3)
    v_mfma_f32_32x32x16_bf16 v[80:95], a[176:179], a[112:115], v[80:95]
    ds_read_b128 a[156:159], v2 offset:35840
    v_fma_f32 v235, v235, v8, v7
    v_mul_f32 v232, v232, v48
    v_mul_f32 v233, v233, v49
    v_mul_f32 v234, v234, v50
    v_mul_f32 v235, v235, v51
    s_waitcnt vmcnt(13)
    s_barrier
    v_mfma_f32_32x32x16_bf16 v[80:95], a[180:183], a[116:119], v[80:95]
    ds_read_b128 a[160:163], v6 offset:4096
    v_exp_f32 v232, v232
    v_exp_f32 v233, v233
    v_mfma_f32_32x32x16_bf16 v[80:95], a[184:187], a[120:123], v[80:95]
    ds_read_b128 a[164:167], v3 offset:0
    s_add_u32 m0, s18, 110592
    s_add_u32 s19, s17, 258048
    v_exp_f32 v234, v234
    v_exp_f32 v235, v235
    v_add_f32 v232, 1.0, v232
    v_add_f32 v233, 1.0, v233
    v_mfma_f32_32x32x16_bf16 v[80:95], a[188:191], a[124:127], v[80:95]
    ds_read_b128 a[168:171], v3 offset:1024
    v_add_f32 v234, 1.0, v234
    v_add_f32 v235, 1.0, v235
    v_rcp_f32 v232, v232
    s_waitcnt lgkmcnt(3)
    v_mfma_f32_32x32x16_bf16 v[80:95], a[144:147], a[128:131], v[80:95]
    ds_read_b128 a[172:175], v3 offset:2048
    buffer_load_dwordx4 v1, s[12:15], s19 offen offset:0 lds
    v_rcp_f32 v233, v233
    v_rcp_f32 v234, v234
    v_mfma_f32_32x32x16_bf16 v[80:95], a[148:151], a[132:135], v[80:95]
    ds_read_b128 a[176:179], v3 offset:3072
    v_rcp_f32 v235, v235
    v_mul_f32 v232, v48, v232
    v_mul_f32 v233, v49, v233
    v_mul_f32 v234, v50, v234
    v_mul_f32 v235, v51, v235
    v_mfma_f32_32x32x16_bf16 v[80:95], a[152:155], a[136:139], v[80:95]
    ds_read_b128 a[180:183], v3 offset:4096
    buffer_load_dwordx4 v1, s[12:15], s19 offen offset:1024 lds
    v_cvt_pk_bf16_f32 v176, v232, v233
    v_cvt_pk_bf16_f32 v177, v234, v235
    v_mul_f32 v236, v52, v52
    v_mul_f32 v237, v53, v53
    v_mul_f32 v238, v54, v54
    v_mfma_f32_32x32x16_bf16 v[80:95], a[156:159], a[140:143], v[80:95]
    ds_read_b128 a[184:187], v3 offset:5120
    v_mul_f32 v239, v55, v55
    v_fma_f32 v236, v236, v8, v7
    v_fma_f32 v237, v237, v8, v7
    v_fma_f32 v238, v238, v8, v7
    v_fma_f32 v239, v239, v8, v7
    s_waitcnt lgkmcnt(3)
    v_mfma_f32_32x32x16_bf16 v[80:95], a[160:163], v[12:15], v[80:95]
    ds_read_b128 a[188:191], v3 offset:6144
    buffer_load_dwordx4 v1, s[12:15], s19 offen offset:2048 lds
    v_mul_f32 v236, v236, v52
    v_mul_f32 v237, v237, v53
    v_mul_f32 v238, v238, v54
    v_mul_f32 v239, v239, v55
    v_mfma_f32_32x32x16_bf16 v[96:111], a[164:167], a[0:3], 0
    ds_read_b128 a[144:147], v3 offset:7168
    v_exp_f32 v236, v236
    v_exp_f32 v237, v237
    v_exp_f32 v238, v238
    v_mfma_f32_32x32x16_bf16 v[96:111], a[168:171], a[4:7], v[96:111]
    ds_read_b128 a[148:151], v3 offset:8192
    buffer_load_dwordx4 v1, s[12:15], s19 offen offset:3072 lds
    v_exp_f32 v239, v239
    v_add_f32 v236, 1.0, v236
    v_add_f32 v237, 1.0, v237
    v_mfma_f32_32x32x16_bf16 v[96:111], a[172:175], a[8:11], v[96:111]
    ds_read_b128 a[152:155], v3 offset:9216
    v_add_f32 v238, 1.0, v238
    v_add_f32 v239, 1.0, v239
    v_rcp_f32 v236, v236
    s_waitcnt lgkmcnt(3)
    v_mfma_f32_32x32x16_bf16 v[96:111], a[176:179], a[12:15], v[96:111]
    ds_read_b128 a[156:159], v3 offset:10240
    s_add_u32 m0, s18, 114688
    s_add_u32 s19, s17, 262144
    v_rcp_f32 v237, v237
    v_rcp_f32 v238, v238
    v_rcp_f32 v239, v239
    v_mfma_f32_32x32x16_bf16 v[96:111], a[180:183], a[16:19], v[96:111]
    ds_read_b128 a[160:163], v3 offset:11264
    v_mul_f32 v236, v52, v236
    v_mul_f32 v237, v53, v237
    v_mul_f32 v238, v54, v238
    v_mul_f32 v239, v55, v239
    v_cvt_pk_bf16_f32 v178, v236, v237
    v_mfma_f32_32x32x16_bf16 v[96:111], a[184:187], a[20:23], v[96:111]
    ds_read_b128 a[164:167], v3 offset:12288
    buffer_load_dwordx4 v1, s[12:15], s19 offen offset:0 lds
    v_cvt_pk_bf16_f32 v179, v238, v239
    s_add_u32 s26, s90, 4096
    buffer_store_dwordx4 v[176:179], v1, s[8:11], s26 offen offset:0 sc1
    v_mul_f32 v240, v56, v56
    v_mul_f32 v241, v57, v57
    v_mfma_f32_32x32x16_bf16 v[96:111], a[188:191], a[24:27], v[96:111]
    ds_read_b128 a[168:171], v3 offset:13312
    v_mul_f32 v242, v58, v58
    v_mul_f32 v243, v59, v59
    v_fma_f32 v240, v240, v8, v7
    v_fma_f32 v241, v241, v8, v7
    v_fma_f32 v242, v242, v8, v7
    s_waitcnt lgkmcnt(3)
    v_mfma_f32_32x32x16_bf16 v[96:111], a[144:147], a[28:31], v[96:111]
    ds_read_b128 a[172:175], v3 offset:14336
    buffer_load_dwordx4 v1, s[12:15], s19 offen offset:1024 lds
    v_fma_f32 v243, v243, v8, v7
    v_mul_f32 v240, v240, v56
    v_mul_f32 v241, v241, v57
    v_mul_f32 v242, v242, v58
    v_mul_f32 v243, v243, v59
    v_mfma_f32_32x32x16_bf16 v[96:111], a[148:151], a[32:35], v[96:111]
    ds_read_b128 a[176:179], v3 offset:15360
    v_exp_f32 v240, v240
    v_exp_f32 v241, v241
    v_mfma_f32_32x32x16_bf16 v[96:111], a[152:155], a[36:39], v[96:111]
    ds_read_b128 a[180:183], v3 offset:16384
    buffer_load_dwordx4 v1, s[12:15], s19 offen offset:2048 lds
    v_exp_f32 v242, v242
    v_exp_f32 v243, v243
    v_add_f32 v240, 1.0, v240
    v_mfma_f32_32x32x16_bf16 v[96:111], a[156:159], a[40:43], v[96:111]
    ds_read_b128 a[184:187], v3 offset:17408
    v_add_f32 v241, 1.0, v241
    v_add_f32 v242, 1.0, v242
    v_add_f32 v243, 1.0, v243
    v_rcp_f32 v240, v240
    s_waitcnt lgkmcnt(3)
    v_mfma_f32_32x32x16_bf16 v[96:111], a[160:163], a[44:47], v[96:111]
    ds_read_b128 a[188:191], v3 offset:18432
    buffer_load_dwordx4 v1, s[12:15], s19 offen offset:3072 lds
    v_rcp_f32 v241, v241
    v_rcp_f32 v242, v242
    v_mfma_f32_32x32x16_bf16 v[96:111], a[164:167], a[48:51], v[96:111]
    ds_read_b128 a[144:147], v3 offset:19456
    v_rcp_f32 v243, v243
    v_mul_f32 v240, v56, v240
    v_mul_f32 v241, v57, v241
    v_mul_f32 v242, v58, v242
    v_mul_f32 v243, v59, v243
    v_mfma_f32_32x32x16_bf16 v[96:111], a[168:171], a[52:55], v[96:111]
    ds_read_b128 a[148:151], v3 offset:20480
    s_add_u32 m0, s18, 118784
    s_add_u32 s19, s17, 266240
    v_cvt_pk_bf16_f32 v180, v240, v241
    v_cvt_pk_bf16_f32 v181, v242, v243
    v_mul_f32 v244, v60, v60
    v_mul_f32 v245, v61, v61
    v_mul_f32 v246, v62, v62
    v_mfma_f32_32x32x16_bf16 v[96:111], a[172:175], a[56:59], v[96:111]
    ds_read_b128 a[152:155], v3 offset:21504
    v_mul_f32 v247, v63, v63
    v_fma_f32 v244, v244, v8, v7
    v_fma_f32 v245, v245, v8, v7
    v_fma_f32 v246, v246, v8, v7
    s_waitcnt lgkmcnt(3)
    v_mfma_f32_32x32x16_bf16 v[96:111], a[176:179], a[60:63], v[96:111]
    ds_read_b128 a[156:159], v3 offset:22528
    buffer_load_dwordx4 v1, s[12:15], s19 offen offset:0 lds
    v_fma_f32 v247, v247, v8, v7
    v_mul_f32 v244, v244, v60
    v_mul_f32 v245, v245, v61
    v_mul_f32 v246, v246, v62
    v_mul_f32 v247, v247, v63
    v_mfma_f32_32x32x16_bf16 v[96:111], a[180:183], a[64:67], v[96:111]
    ds_read_b128 a[160:163], v3 offset:23552
    v_exp_f32 v244, v244
    v_exp_f32 v245, v245
    v_mfma_f32_32x32x16_bf16 v[96:111], a[184:187], a[68:71], v[96:111]
    ds_read_b128 a[164:167], v3 offset:24576
    v_exp_f32 v246, v246
    v_exp_f32 v247, v247
    v_add_f32 v244, 1.0, v244
    v_add_f32 v245, 1.0, v245
    v_mfma_f32_32x32x16_bf16 v[96:111], a[188:191], a[72:75], v[96:111]
    ds_read_b128 a[168:171], v3 offset:25600
    v_add_f32 v246, 1.0, v246
    v_add_f32 v247, 1.0, v247
    v_rcp_f32 v244, v244
    s_waitcnt lgkmcnt(3)
    v_mfma_f32_32x32x16_bf16 v[96:111], a[144:147], a[76:79], v[96:111]
    ds_read_b128 a[172:175], v3 offset:26624
    v_rcp_f32 v245, v245
    v_rcp_f32 v246, v246
    v_rcp_f32 v247, v247
    v_mfma_f32_32x32x16_bf16 v[96:111], a[148:151], a[80:83], v[96:111]
    ds_read_b128 a[176:179], v3 offset:27648
    v_mul_f32 v244, v60, v244
    v_mul_f32 v245, v61, v245
    v_mul_f32 v246, v62, v246
    v_mul_f32 v247, v63, v247
    v_cvt_pk_bf16_f32 v182, v244, v245
    v_mfma_f32_32x32x16_bf16 v[96:111], a[152:155], a[84:87], v[96:111]
    ds_read_b128 a[180:183], v3 offset:28672
    v_cvt_pk_bf16_f32 v183, v246, v247
    s_add_u32 s26, s90, 4096
    buffer_store_dwordx4 v[180:183], v1, s[8:11], s26 offen offset:1024 sc1
    v_mul_f32 v232, v64, v64
    v_mfma_f32_32x32x16_bf16 v[96:111], a[156:159], a[88:91], v[96:111]
    ds_read_b128 a[184:187], v3 offset:29696
    v_mul_f32 v233, v65, v65
    v_mul_f32 v234, v66, v66
    v_mul_f32 v235, v67, v67
    v_fma_f32 v232, v232, v8, v7
    v_fma_f32 v233, v233, v8, v7
    s_waitcnt lgkmcnt(3)
    v_mfma_f32_32x32x16_bf16 v[96:111], a[160:163], a[92:95], v[96:111]
    ds_read_b128 a[188:191], v3 offset:30720
    v_fma_f32 v234, v234, v8, v7
    v_fma_f32 v235, v235, v8, v7
    v_mul_f32 v232, v232, v64
    v_mul_f32 v233, v233, v65
    v_mul_f32 v234, v234, v66
    v_mfma_f32_32x32x16_bf16 v[96:111], a[164:167], a[96:99], v[96:111]
    ds_read_b128 a[144:147], v3 offset:31744
    v_mul_f32 v235, v235, v67
    v_exp_f32 v232, v232
    v_exp_f32 v233, v233
    v_mfma_f32_32x32x16_bf16 v[96:111], a[168:171], a[100:103], v[96:111]
    ds_read_b128 a[148:151], v3 offset:32768
    v_exp_f32 v234, v234
    v_exp_f32 v235, v235
    v_add_f32 v232, 1.0, v232
    v_mfma_f32_32x32x16_bf16 v[96:111], a[172:175], a[104:107], v[96:111]
    ds_read_b128 a[152:155], v3 offset:33792
    v_add_f32 v233, 1.0, v233
    v_add_f32 v234, 1.0, v234
    v_add_f32 v235, 1.0, v235
    v_rcp_f32 v232, v232
    s_waitcnt lgkmcnt(3)
    v_mfma_f32_32x32x16_bf16 v[96:111], a[176:179], a[108:111], v[96:111]
    ds_read_b128 a[156:159], v3 offset:34816
    v_rcp_f32 v233, v233
    v_rcp_f32 v234, v234
    v_mfma_f32_32x32x16_bf16 v[96:111], a[180:183], a[112:115], v[96:111]
    ds_read_b128 a[160:163], v3 offset:35840
    v_rcp_f32 v235, v235
    v_mul_f32 v232, v64, v232
    v_mul_f32 v233, v65, v233
    v_mul_f32 v234, v66, v234
    s_waitcnt vmcnt(12)
    s_barrier
    v_mfma_f32_32x32x16_bf16 v[96:111], a[184:187], a[116:119], v[96:111]
    ds_read_b128 a[164:167], v6 offset:5120
    s_add_u32 m0, s18, 0
    s_add_u32 s19, s17, 294912
    v_mul_f32 v235, v67, v235
    v_cvt_pk_bf16_f32 v184, v232, v233
    v_cvt_pk_bf16_f32 v185, v234, v235
    v_mul_f32 v236, v68, v68
    v_mul_f32 v237, v69, v69
    v_mfma_f32_32x32x16_bf16 v[96:111], a[188:191], a[120:123], v[96:111]
    ds_read_b128 a[168:171], v4 offset:0
    v_mul_f32 v238, v70, v70
    v_mul_f32 v239, v71, v71
    v_fma_f32 v236, v236, v8, v7
    v_fma_f32 v237, v237, v8, v7
    v_fma_f32 v238, v238, v8, v7
    s_waitcnt lgkmcnt(3)
    v_mfma_f32_32x32x16_bf16 v[96:111], a[144:147], a[124:127], v[96:111]
    ds_read_b128 a[172:175], v4 offset:1024
    buffer_load_dwordx4 v1, s[12:15], s19 offen offset:0 lds
    v_fma_f32 v239, v239, v8, v7
    v_mul_f32 v236, v236, v68
    v_mul_f32 v237, v237, v69
    v_mul_f32 v238, v238, v70
    v_mul_f32 v239, v239, v71
    v_mfma_f32_32x32x16_bf16 v[96:111], a[148:151], a[128:131], v[96:111]
    ds_read_b128 a[176:179], v4 offset:2048
    v_exp_f32 v236, v236
    v_exp_f32 v237, v237
    v_mfma_f32_32x32x16_bf16 v[96:111], a[152:155], a[132:135], v[96:111]
    ds_read_b128 a[180:183], v4 offset:3072
    buffer_load_dwordx4 v1, s[12:15], s19 offen offset:1024 lds
    v_exp_f32 v238, v238
    v_exp_f32 v239, v239
    v_add_f32 v236, 1.0, v236
    v_mfma_f32_32x32x16_bf16 v[96:111], a[156:159], a[136:139], v[96:111]
    ds_read_b128 a[184:187], v4 offset:4096
    v_add_f32 v237, 1.0, v237
    v_add_f32 v238, 1.0, v238
    v_add_f32 v239, 1.0, v239
    v_rcp_f32 v236, v236
    s_waitcnt lgkmcnt(3)
    v_mfma_f32_32x32x16_bf16 v[96:111], a[160:163], a[140:143], v[96:111]
    ds_read_b128 a[188:191], v4 offset:5120
    buffer_load_dwordx4 v1, s[12:15], s19 offen offset:2048 lds
    v_rcp_f32 v237, v237
    v_rcp_f32 v238, v238
    v_mfma_f32_32x32x16_bf16 v[96:111], a[164:167], v[12:15], v[96:111]
    ds_read_b128 a[144:147], v4 offset:6144
    v_rcp_f32 v239, v239
    v_mul_f32 v236, v68, v236
    v_mul_f32 v237, v69, v237
    v_mul_f32 v238, v70, v238
    v_mul_f32 v239, v71, v239
    v_mfma_f32_32x32x16_bf16 v[112:127], a[168:171], a[0:3], 0
    ds_read_b128 a[148:151], v4 offset:7168
    buffer_load_dwordx4 v1, s[12:15], s19 offen offset:3072 lds
    v_cvt_pk_bf16_f32 v186, v236, v237
    v_cvt_pk_bf16_f32 v187, v238, v239
    s_add_u32 s26, s90, 4096
    buffer_store_dwordx4 v[184:187], v1, s[8:11], s26 offen offset:2048 sc1
    v_mul_f32 v240, v72, v72
    v_mfma_f32_32x32x16_bf16 v[112:127], a[172:175], a[4:7], v[112:127]
    ds_read_b128 a[152:155], v4 offset:8192
    v_mul_f32 v241, v73, v73
    v_mul_f32 v242, v74, v74
    v_mul_f32 v243, v75, v75
    v_fma_f32 v240, v240, v8, v7
    v_fma_f32 v241, v241, v8, v7
    s_waitcnt lgkmcnt(3)
    v_mfma_f32_32x32x16_bf16 v[112:127], a[176:179], a[8:11], v[112:127]
    ds_read_b128 a[156:159], v4 offset:9216
    s_add_u32 m0, s18, 4096
    s_add_u32 s19, s17, 299008
    v_fma_f32 v242, v242, v8, v7
    v_fma_f32 v243, v243, v8, v7
    v_mul_f32 v240, v240, v72
    v_mul_f32 v241, v241, v73
    v_mul_f32 v242, v242, v74
    v_mfma_f32_32x32x16_bf16 v[112:127], a[180:183], a[12:15], v[112:127]
    ds_read_b128 a[160:163], v4 offset:10240
    v_mul_f32 v243, v243, v75
    v_exp_f32 v240, v240
    v_mfma_f32_32x32x16_bf16 v[112:127], a[184:187], a[16:19], v[112:127]
    ds_read_b128 a[164:167], v4 offset:11264
    buffer_load_dwordx4 v1, s[12:15], s19 offen offset:0 lds
    v_exp_f32 v241, v241
    v_exp_f32 v242, v242
    v_exp_f32 v243, v243
    v_mfma_f32_32x32x16_bf16 v[112:127], a[188:191], a[20:23], v[112:127]
    ds_read_b128 a[168:171], v4 offset:12288
    v_add_f32 v240, 1.0, v240
    v_add_f32 v241, 1.0, v241
    v_add_f32 v242, 1.0, v242
    v_add_f32 v243, 1.0, v243
    s_waitcnt lgkmcnt(3)
    v_mfma_f32_32x32x16_bf16 v[112:127], a[144:147], a[24:27], v[112:127]
    ds_read_b128 a[172:175], v4 offset:13312
    buffer_load_dwordx4 v1, s[12:15], s19 offen offset:1024 lds
    v_rcp_f32 v240, v240
    v_rcp_f32 v241, v241
    v_rcp_f32 v242, v242
    v_mfma_f32_32x32x16_bf16 v[112:127], a[148:151], a[28:31], v[112:127]
    ds_read_b128 a[176:179], v4 offset:14336
    v_rcp_f32 v243, v243
    v_mul_f32 v240, v72, v240
    v_mul_f32 v241, v73, v241
    v_mul_f32 v242, v74, v242
    v_mfma_f32_32x32x16_bf16 v[112:127], a[152:155], a[32:35], v[112:127]
    ds_read_b128 a[180:183], v4 offset:15360
    buffer_load_dwordx4 v1, s[12:15], s19 offen offset:2048 lds
    v_mul_f32 v243, v75, v243
    v_cvt_pk_bf16_f32 v188, v240, v241
    v_cvt_pk_bf16_f32 v189, v242, v243
    v_mul_f32 v244, v76, v76
    v_mul_f32 v245, v77, v77
    v_mfma_f32_32x32x16_bf16 v[112:127], a[156:159], a[36:39], v[112:127]
    ds_read_b128 a[184:187], v4 offset:16384
    v_mul_f32 v246, v78, v78
    v_mul_f32 v247, v79, v79
    v_fma_f32 v244, v244, v8, v7
    v_fma_f32 v245, v245, v8, v7
    s_waitcnt lgkmcnt(3)
    v_mfma_f32_32x32x16_bf16 v[112:127], a[160:163], a[40:43], v[112:127]
    ds_read_b128 a[188:191], v4 offset:17408
    buffer_load_dwordx4 v1, s[12:15], s19 offen offset:3072 lds
    v_fma_f32 v246, v246, v8, v7
    v_fma_f32 v247, v247, v8, v7
    v_mul_f32 v244, v244, v76
    v_mul_f32 v245, v245, v77
    v_mul_f32 v246, v246, v78
    v_mfma_f32_32x32x16_bf16 v[112:127], a[164:167], a[44:47], v[112:127]
    ds_read_b128 a[144:147], v4 offset:18432
    v_mul_f32 v247, v247, v79
    v_exp_f32 v244, v244
    v_exp_f32 v245, v245
    v_mfma_f32_32x32x16_bf16 v[112:127], a[168:171], a[48:51], v[112:127]
    ds_read_b128 a[148:151], v4 offset:19456
    s_add_u32 m0, s18, 8192
    s_add_u32 s19, s17, 303104
    v_exp_f32 v246, v246
    v_exp_f32 v247, v247
    v_add_f32 v244, 1.0, v244
    v_mfma_f32_32x32x16_bf16 v[112:127], a[172:175], a[52:55], v[112:127]
    ds_read_b128 a[152:155], v4 offset:20480
    v_add_f32 v245, 1.0, v245
    v_add_f32 v246, 1.0, v246
    v_add_f32 v247, 1.0, v247
    v_rcp_f32 v244, v244
    s_waitcnt lgkmcnt(3)
    v_mfma_f32_32x32x16_bf16 v[112:127], a[176:179], a[56:59], v[112:127]
    ds_read_b128 a[156:159], v4 offset:21504
    buffer_load_dwordx4 v1, s[12:15], s19 offen offset:0 lds
    v_rcp_f32 v245, v245
    v_rcp_f32 v246, v246
    v_mfma_f32_32x32x16_bf16 v[112:127], a[180:183], a[60:63], v[112:127]
    ds_read_b128 a[160:163], v4 offset:22528
    v_rcp_f32 v247, v247
    v_mul_f32 v244, v76, v244
    v_mul_f32 v245, v77, v245
    v_mul_f32 v246, v78, v246
    v_mul_f32 v247, v79, v247
    v_mfma_f32_32x32x16_bf16 v[112:127], a[184:187], a[64:67], v[112:127]
    ds_read_b128 a[164:167], v4 offset:23552
    v_cvt_pk_bf16_f32 v190, v244, v245
    v_cvt_pk_bf16_f32 v191, v246, v247
    s_add_u32 s26, s90, 4096
    buffer_store_dwordx4 v[188:191], v1, s[8:11], s26 offen offset:3072 sc1
    v_mfma_f32_32x32x16_bf16 v[112:127], a[188:191], a[68:71], v[112:127]
    ds_read_b128 a[168:171], v4 offset:24576
    v_mul_f32 v232, v80, v80
    v_mul_f32 v233, v81, v81
    v_mul_f32 v234, v82, v82
    v_mul_f32 v235, v83, v83
    v_fma_f32 v232, v232, v8, v7
    s_waitcnt lgkmcnt(3)
    v_mfma_f32_32x32x16_bf16 v[112:127], a[144:147], a[72:75], v[112:127]
    ds_read_b128 a[172:175], v4 offset:25600
    v_fma_f32 v233, v233, v8, v7
    v_fma_f32 v234, v234, v8, v7
    v_fma_f32 v235, v235, v8, v7
    v_mul_f32 v232, v232, v80
    v_mul_f32 v233, v233, v81
    v_mfma_f32_32x32x16_bf16 v[112:127], a[148:151], a[76:79], v[112:127]
    ds_read_b128 a[176:179], v4 offset:26624
    v_mul_f32 v234, v234, v82
    v_mul_f32 v235, v235, v83
    v_exp_f32 v232, v232
    v_mfma_f32_32x32x16_bf16 v[112:127], a[152:155], a[80:83], v[112:127]
    ds_read_b128 a[180:183], v4 offset:27648
    v_exp_f32 v233, v233
    v_exp_f32 v234, v234
    v_exp_f32 v235, v235
    v_mfma_f32_32x32x16_bf16 v[112:127], a[156:159], a[84:87], v[112:127]
    ds_read_b128 a[184:187], v4 offset:28672
    v_add_f32 v232, 1.0, v232
    v_add_f32 v233, 1.0, v233
    v_add_f32 v234, 1.0, v234
    v_add_f32 v235, 1.0, v235
    s_waitcnt lgkmcnt(3)
    v_mfma_f32_32x32x16_bf16 v[112:127], a[160:163], a[88:91], v[112:127]
    ds_read_b128 a[188:191], v4 offset:29696
    v_rcp_f32 v232, v232
    v_rcp_f32 v233, v233
    v_mfma_f32_32x32x16_bf16 v[112:127], a[164:167], a[92:95], v[112:127]
    ds_read_b128 a[144:147], v4 offset:30720
    v_rcp_f32 v234, v234
    v_rcp_f32 v235, v235
    v_mul_f32 v232, v80, v232
    v_mul_f32 v233, v81, v233
    v_mfma_f32_32x32x16_bf16 v[112:127], a[168:171], a[96:99], v[112:127]
    ds_read_b128 a[148:151], v4 offset:31744
    v_mul_f32 v234, v82, v234
    v_mul_f32 v235, v83, v235
    v_cvt_pk_bf16_f32 v192, v232, v233
    v_cvt_pk_bf16_f32 v193, v234, v235
    v_mul_f32 v236, v84, v84
    v_mfma_f32_32x32x16_bf16 v[112:127], a[172:175], a[100:103], v[112:127]
    ds_read_b128 a[152:155], v4 offset:32768
    v_mul_f32 v237, v85, v85
    v_mul_f32 v238, v86, v86
    v_mul_f32 v239, v87, v87
    v_fma_f32 v236, v236, v8, v7
    v_fma_f32 v237, v237, v8, v7
    s_waitcnt lgkmcnt(3)
    v_mfma_f32_32x32x16_bf16 v[112:127], a[176:179], a[104:107], v[112:127]
    ds_read_b128 a[156:159], v4 offset:33792
    v_fma_f32 v238, v238, v8, v7
    v_fma_f32 v239, v239, v8, v7
    v_mul_f32 v236, v236, v84
    v_mul_f32 v237, v237, v85
    v_mul_f32 v238, v238, v86
    v_mfma_f32_32x32x16_bf16 v[112:127], a[180:183], a[108:111], v[112:127]
    ds_read_b128 a[160:163], v4 offset:34816
    v_mul_f32 v239, v239, v87
    v_exp_f32 v236, v236
    v_exp_f32 v237, v237
    v_mfma_f32_32x32x16_bf16 v[112:127], a[184:187], a[112:115], v[112:127]
    ds_read_b128 a[164:167], v4 offset:35840
    v_exp_f32 v238, v238
    v_exp_f32 v239, v239
    s_waitcnt vmcnt(12)
    s_barrier
    v_mfma_f32_32x32x16_bf16 v[112:127], a[188:191], a[116:119], v[112:127]
    ds_read_b128 a[168:171], v6 offset:6144
    v_add_f32 v236, 1.0, v236
    v_add_f32 v237, 1.0, v237
    v_add_f32 v238, 1.0, v238
    v_add_f32 v239, 1.0, v239
    s_waitcnt lgkmcnt(3)
    v_mfma_f32_32x32x16_bf16 v[112:127], a[144:147], a[120:123], v[112:127]
    ds_read_b128 a[172:175], v5 offset:0
    s_add_u32 m0, s18, 36864
    s_add_u32 s29, s27, 0
    buffer_load_dwordx4 v252, s[36:39], s29 offen offset:0 lds
    v_rcp_f32 v236, v236
    v_rcp_f32 v237, v237
    v_rcp_f32 v238, v238
    v_mfma_f32_32x32x16_bf16 v[112:127], a[148:151], a[124:127], v[112:127]
    ds_read_b128 a[176:179], v5 offset:1024
    v_rcp_f32 v239, v239
    v_mul_f32 v236, v84, v236
    v_mul_f32 v237, v85, v237
    v_mul_f32 v238, v86, v238
    v_mfma_f32_32x32x16_bf16 v[112:127], a[152:155], a[128:131], v[112:127]
    ds_read_b128 a[180:183], v5 offset:2048
    s_add_u32 s29, s27, 8192
    buffer_load_dwordx4 v252, s[36:39], s29 offen offset:1024 lds
    v_mul_f32 v239, v87, v239
    v_cvt_pk_bf16_f32 v194, v236, v237
    v_cvt_pk_bf16_f32 v195, v238, v239
    s_add_u32 s26, s90, 8192
    buffer_store_dwordx4 v[192:195], v1, s[8:11], s26 offen offset:0 sc1
    v_mfma_f32_32x32x16_bf16 v[112:127], a[156:159], a[132:135], v[112:127]
    ds_read_b128 a[184:187], v5 offset:3072
    v_mul_f32 v240, v88, v88
    v_mul_f32 v241, v89, v89
    v_mul_f32 v242, v90, v90
    v_mul_f32 v243, v91, v91
    v_fma_f32 v240, v240, v8, v7
    s_waitcnt lgkmcnt(3)
    v_mfma_f32_32x32x16_bf16 v[112:127], a[160:163], a[136:139], v[112:127]
    ds_read_b128 a[188:191], v5 offset:4096
    s_add_u32 s29, s27, 16384
    buffer_load_dwordx4 v252, s[36:39], s29 offen offset:2048 lds
    v_fma_f32 v241, v241, v8, v7
    v_fma_f32 v242, v242, v8, v7
    v_fma_f32 v243, v243, v8, v7
    v_mul_f32 v240, v240, v88
    v_mul_f32 v241, v241, v89
    v_mfma_f32_32x32x16_bf16 v[112:127], a[164:167], a[140:143], v[112:127]
    ds_read_b128 a[144:147], v5 offset:5120
    v_mul_f32 v242, v242, v90
    v_mul_f32 v243, v243, v91
    v_exp_f32 v240, v240
    v_mfma_f32_32x32x16_bf16 v[112:127], a[168:171], v[12:15], v[112:127]
    ds_read_b128 a[148:151], v5 offset:6144
    s_add_u32 s29, s27, 24576
    buffer_load_dwordx4 v252, s[36:39], s29 offen offset:3072 lds
    v_exp_f32 v241, v241
    v_exp_f32 v242, v242
    v_mfma_f32_32x32x16_bf16 v[128:143], a[172:175], a[0:3], 0
    ds_read_b128 a[152:155], v5 offset:7168
    v_exp_f32 v243, v243
    v_add_f32 v240, 1.0, v240
    v_add_f32 v241, 1.0, v241
    v_add_f32 v242, 1.0, v242
    v_add_f32 v243, 1.0, v243
    s_waitcnt lgkmcnt(3)
    v_mfma_f32_32x32x16_bf16 v[128:143], a[176:179], a[4:7], v[128:143]
    ds_read_b128 a[156:159], v5 offset:8192
    s_add_u32 m0, s18, 40960
    s_add_u32 s29, s27, 36864
    buffer_load_dwordx4 v252, s[36:39], s29 offen offset:0 lds
    v_rcp_f32 v240, v240
    v_rcp_f32 v241, v241
    v_mfma_f32_32x32x16_bf16 v[128:143], a[180:183], a[8:11], v[128:143]
    ds_read_b128 a[160:163], v5 offset:9216
    v_rcp_f32 v242, v242
    v_rcp_f32 v243, v243
    v_mul_f32 v240, v88, v240
    v_mul_f32 v241, v89, v241
    v_mfma_f32_32x32x16_bf16 v[128:143], a[184:187], a[12:15], v[128:143]
    ds_read_b128 a[164:167], v5 offset:10240
    s_add_u32 s29, s27, 45056
    buffer_load_dwordx4 v252, s[36:39], s29 offen offset:1024 lds
    v_mul_f32 v242, v90, v242
    v_mul_f32 v243, v91, v243
    v_cvt_pk_bf16_f32 v196, v240, v241
    v_cvt_pk_bf16_f32 v197, v242, v243
    v_mul_f32 v244, v92, v92
    v_mfma_f32_32x32x16_bf16 v[128:143], a[188:191], a[16:19], v[128:143]
    ds_read_b128 a[168:171], v5 offset:11264
    v_mul_f32 v245, v93, v93
    v_mul_f32 v246, v94, v94
    v_mul_f32 v247, v95, v95
    v_fma_f32 v244, v244, v8, v7
    s_waitcnt lgkmcnt(3)
    v_mfma_f32_32x32x16_bf16 v[128:143], a[144:147], a[20:23], v[128:143]
    ds_read_b128 a[172:175], v5 offset:12288
    s_add_u32 s29, s27, 53248
    buffer_load_dwordx4 v252, s[36:39], s29 offen offset:2048 lds
    v_fma_f32 v245, v245, v8, v7
    v_fma_f32 v246, v246, v8, v7
    v_fma_f32 v247, v247, v8, v7
    v_mul_f32 v244, v244, v92
    v_mul_f32 v245, v245, v93
    v_mfma_f32_32x32x16_bf16 v[128:143], a[148:151], a[24:27], v[128:143]
    ds_read_b128 a[176:179], v5 offset:13312
    v_mul_f32 v246, v246, v94
    v_mul_f32 v247, v247, v95
    v_exp_f32 v244, v244
    v_mfma_f32_32x32x16_bf16 v[128:143], a[152:155], a[28:31], v[128:143]
    ds_read_b128 a[180:183], v5 offset:14336
    s_add_u32 s29, s27, 61440
    buffer_load_dwordx4 v252, s[36:39], s29 offen offset:3072 lds
    v_exp_f32 v245, v245
    v_exp_f32 v246, v246
    v_exp_f32 v247, v247
    v_mfma_f32_32x32x16_bf16 v[128:143], a[156:159], a[32:35], v[128:143]
    ds_read_b128 a[184:187], v5 offset:15360
    v_add_f32 v244, 1.0, v244
    v_add_f32 v245, 1.0, v245
    v_add_f32 v246, 1.0, v246
    v_add_f32 v247, 1.0, v247
    s_waitcnt lgkmcnt(3)
    v_mfma_f32_32x32x16_bf16 v[128:143], a[160:163], a[36:39], v[128:143]
    ds_read_b128 a[188:191], v5 offset:16384
    s_add_u32 m0, s18, 45056
    s_add_u32 s29, s27, 73728
    buffer_load_dwordx4 v252, s[36:39], s29 offen offset:0 lds
    v_rcp_f32 v244, v244
    v_rcp_f32 v245, v245
    v_rcp_f32 v246, v246
    v_mfma_f32_32x32x16_bf16 v[128:143], a[164:167], a[40:43], v[128:143]
    ds_read_b128 a[144:147], v5 offset:17408
    v_rcp_f32 v247, v247
    v_mul_f32 v244, v92, v244
    v_mul_f32 v245, v93, v245
    v_mul_f32 v246, v94, v246
    v_mfma_f32_32x32x16_bf16 v[128:143], a[168:171], a[44:47], v[128:143]
    ds_read_b128 a[148:151], v5 offset:18432
    v_mul_f32 v247, v95, v247
    v_cvt_pk_bf16_f32 v198, v244, v245
    v_cvt_pk_bf16_f32 v199, v246, v247
    v_mfma_f32_32x32x16_bf16 v[128:143], a[172:175], a[48:51], v[128:143]
    ds_read_b128 a[152:155], v5 offset:19456
    s_add_u32 s26, s90, 8192
    buffer_store_dwordx4 v[196:199], v1, s[8:11], s26 offen offset:1024 sc1
    v_mul_f32 v232, v96, v96
    v_mul_f32 v233, v97, v97
    v_mul_f32 v234, v98, v98
    v_mul_f32 v235, v99, v99
    s_waitcnt lgkmcnt(3)
    v_mfma_f32_32x32x16_bf16 v[128:143], a[176:179], a[52:55], v[128:143]
    ds_read_b128 a[156:159], v5 offset:20480
    v_fma_f32 v232, v232, v8, v7
    v_fma_f32 v233, v233, v8, v7
    v_fma_f32 v234, v234, v8, v7
    v_fma_f32 v235, v235, v8, v7
    v_mul_f32 v232, v232, v96
    v_mfma_f32_32x32x16_bf16 v[128:143], a[180:183], a[56:59], v[128:143]
    ds_read_b128 a[160:163], v5 offset:21504
    v_mul_f32 v233, v233, v97
    v_mul_f32 v234, v234, v98
    v_mul_f32 v235, v235, v99
    v_exp_f32 v232, v232
    v_mfma_f32_32x32x16_bf16 v[128:143], a[184:187], a[60:63], v[128:143]
    ds_read_b128 a[164:167], v5 offset:22528
    v_exp_f32 v233, v233
    v_exp_f32 v234, v234
    v_mfma_f32_32x32x16_bf16 v[128:143], a[188:191], a[64:67], v[128:143]
    ds_read_b128 a[168:171], v5 offset:23552
    v_exp_f32 v235, v235
    v_add_f32 v232, 1.0, v232
    v_add_f32 v233, 1.0, v233
    v_add_f32 v234, 1.0, v234
    v_add_f32 v235, 1.0, v235
    s_waitcnt lgkmcnt(3)
    v_mfma_f32_32x32x16_bf16 v[128:143], a[144:147], a[68:71], v[128:143]
    ds_read_b128 a[172:175], v5 offset:24576
    v_rcp_f32 v232, v232
    v_rcp_f32 v233, v233
    v_mfma_f32_32x32x16_bf16 v[128:143], a[148:151], a[72:75], v[128:143]
    ds_read_b128 a[176:179], v5 offset:25600
    v_rcp_f32 v234, v234
    v_rcp_f32 v235, v235
    v_mul_f32 v232, v96, v232
    v_mfma_f32_32x32x16_bf16 v[128:143], a[152:155], a[76:79], v[128:143]
    ds_read_b128 a[180:183], v5 offset:26624
    v_mul_f32 v233, v97, v233
    v_mul_f32 v234, v98, v234
    v_mul_f32 v235, v99, v235
    v_cvt_pk_bf16_f32 v200, v232, v233
    v_cvt_pk_bf16_f32 v201, v234, v235
    v_mfma_f32_32x32x16_bf16 v[128:143], a[156:159], a[80:83], v[128:143]
    ds_read_b128 a[184:187], v5 offset:27648
    v_mul_f32 v236, v100, v100
    v_mul_f32 v237, v101, v101
    v_mul_f32 v238, v102, v102
    v_mul_f32 v239, v103, v103
    v_fma_f32 v236, v236, v8, v7
    s_waitcnt lgkmcnt(3)
    v_mfma_f32_32x32x16_bf16 v[128:143], a[160:163], a[84:87], v[128:143]
    ds_read_b128 a[188:191], v5 offset:28672
    v_fma_f32 v237, v237, v8, v7
    v_fma_f32 v238, v238, v8, v7
    v_fma_f32 v239, v239, v8, v7
    v_mul_f32 v236, v236, v100
    v_mul_f32 v237, v237, v101
    v_mfma_f32_32x32x16_bf16 v[128:143], a[164:167], a[88:91], v[128:143]
    ds_read_b128 a[144:147], v5 offset:29696
    v_mul_f32 v238, v238, v102
    v_mul_f32 v239, v239, v103
    v_exp_f32 v236, v236
    v_mfma_f32_32x32x16_bf16 v[128:143], a[168:171], a[92:95], v[128:143]
    ds_read_b128 a[148:151], v5 offset:30720
    v_exp_f32 v237, v237
    v_exp_f32 v238, v238
    v_mfma_f32_32x32x16_bf16 v[128:143], a[172:175], a[96:99], v[128:143]
    ds_read_b128 a[152:155], v5 offset:31744
    v_exp_f32 v239, v239
    v_add_f32 v236, 1.0, v236
    v_add_f32 v237, 1.0, v237
    v_add_f32 v238, 1.0, v238
    v_add_f32 v239, 1.0, v239
    s_waitcnt lgkmcnt(3)
    v_mfma_f32_32x32x16_bf16 v[128:143], a[176:179], a[100:103], v[128:143]
    ds_read_b128 a[156:159], v5 offset:32768
    v_rcp_f32 v236, v236
    v_rcp_f32 v237, v237
    v_mfma_f32_32x32x16_bf16 v[128:143], a[180:183], a[104:107], v[128:143]
    ds_read_b128 a[160:163], v5 offset:33792
    v_rcp_f32 v238, v238
    v_rcp_f32 v239, v239
    v_mul_f32 v236, v100, v236
    v_mul_f32 v237, v101, v237
    v_mfma_f32_32x32x16_bf16 v[128:143], a[184:187], a[108:111], v[128:143]
    ds_read_b128 a[164:167], v5 offset:34816
    v_mul_f32 v238, v102, v238
    v_mul_f32 v239, v103, v239
    v_cvt_pk_bf16_f32 v202, v236, v237
    v_cvt_pk_bf16_f32 v203, v238, v239
    v_mfma_f32_32x32x16_bf16 v[128:143], a[188:191], a[112:115], v[128:143]
    ds_read_b128 a[168:171], v5 offset:35840
    s_add_u32 s26, s90, 8192
    buffer_store_dwordx4 v[200:203], v1, s[8:11], s26 offen offset:2048 sc1
    v_mul_f32 v240, v104, v104
    v_mul_f32 v241, v105, v105
    v_mul_f32 v242, v106, v106
    v_mul_f32 v243, v107, v107
    s_waitcnt vmcnt(13)
    s_barrier
    s_waitcnt lgkmcnt(3)
    v_mfma_f32_32x32x16_bf16 v[128:143], a[144:147], a[116:119], v[128:143]
    ds_read_b128 a[172:175], v6 offset:7168
    s_add_u32 m0, s18, 73728
    s_add_u32 s29, s27, 165888
    buffer_load_dwordx4 v252, s[36:39], s29 offen offset:0 lds
    v_fma_f32 v240, v240, v8, v7
    v_fma_f32 v241, v241, v8, v7
    v_fma_f32 v242, v242, v8, v7
    v_fma_f32 v243, v243, v8, v7
    v_mul_f32 v240, v240, v104
    v_mfma_f32_32x32x16_bf16 v[128:143], a[148:151], a[120:123], v[128:143]
    ds_read_b128 a[176:179], v2 offset:0
    v_mul_f32 v241, v241, v105
    v_mul_f32 v242, v242, v106
    v_mul_f32 v243, v243, v107
    v_mfma_f32_32x32x16_bf16 v[128:143], a[152:155], a[124:127], v[128:143]
    ds_read_b128 a[180:183], v2 offset:1024
    s_add_u32 s29, s27, 174080
    buffer_load_dwordx4 v252, s[36:39], s29 offen offset:1024 lds
    v_exp_f32 v240, v240
    v_exp_f32 v241, v241
    v_exp_f32 v242, v242
    v_mfma_f32_32x32x16_bf16 v[128:143], a[156:159], a[128:131], v[128:143]
    ds_read_b128 a[184:187], v2 offset:2048
    v_exp_f32 v243, v243
    v_add_f32 v240, 1.0, v240
    v_add_f32 v241, 1.0, v241
    v_add_f32 v242, 1.0, v242
    s_waitcnt lgkmcnt(3)
    v_mfma_f32_32x32x16_bf16 v[128:143], a[160:163], a[132:135], v[128:143]
    ds_read_b128 a[188:191], v2 offset:3072
    s_add_u32 s29, s27, 182272
    buffer_load_dwordx4 v252, s[36:39], s29 offen offset:2048 lds
    v_add_f32 v243, 1.0, v243
    v_rcp_f32 v240, v240
    v_rcp_f32 v241, v241
    v_mfma_f32_32x32x16_bf16 v[128:143], a[164:167], a[136:139], v[128:143]
    ds_read_b128 a[144:147], v2 offset:4096
    v_rcp_f32 v242, v242
    v_rcp_f32 v243, v243
    v_mul_f32 v240, v104, v240
    v_mfma_f32_32x32x16_bf16 v[128:143], a[168:171], a[140:143], v[128:143]
    ds_read_b128 a[148:151], v2 offset:5120
    s_add_u32 s29, s27, 190464
    buffer_load_dwordx4 v252, s[36:39], s29 offen offset:3072 lds
    v_mul_f32 v241, v105, v241
    v_mul_f32 v242, v106, v242
    v_mul_f32 v243, v107, v243
    v_cvt_pk_bf16_f32 v204, v240, v241
    v_cvt_pk_bf16_f32 v205, v242, v243
    v_mfma_f32_32x32x16_bf16 v[128:143], a[172:175], v[12:15], v[128:143]
    ds_read_b128 a[152:155], v2 offset:6144
    v_mul_f32 v244, v108, v108
    v_mul_f32 v245, v109, v109
    v_mul_f32 v246, v110, v110
    v_mul_f32 v247, v111, v111
    s_waitcnt lgkmcnt(3)
    v_mfma_f32_32x32x16_bf16 v[144:159], a[176:179], a[0:3], 0
    ds_read_b128 a[156:159], v2 offset:7168
    s_add_u32 m0, s18, 77824
    s_add_u32 s29, s27, 202752
    buffer_load_dwordx4 v252, s[36:39], s29 offen offset:0 lds
    v_fma_f32 v244, v244, v8, v7
    v_fma_f32 v245, v245, v8, v7
    v_fma_f32 v246, v246, v8, v7
    v_fma_f32 v247, v247, v8, v7
    v_mul_f32 v244, v244, v108
    v_mfma_f32_32x32x16_bf16 v[144:159], a[180:183], a[4:7], v[144:159]
    ds_read_b128 a[160:163], v2 offset:8192
    v_mul_f32 v245, v245, v109
    v_mul_f32 v246, v246, v110
    v_mul_f32 v247, v247, v111
    v_exp_f32 v244, v244
    v_mfma_f32_32x32x16_bf16 v[144:159], a[184:187], a[8:11], v[144:159]
    ds_read_b128 a[164:167], v2 offset:9216
    s_add_u32 s29, s27, 210944
    buffer_load_dwordx4 v252, s[36:39], s29 offen offset:1024 lds
    v_exp_f32 v245, v245
    v_exp_f32 v246, v246
    v_mfma_f32_32x32x16_bf16 v[144:159], a[188:191], a[12:15], v[144:159]
    ds_read_b128 a[168:171], v2 offset:10240
    v_exp_f32 v247, v247
    v_add_f32 v244, 1.0, v244
    v_add_f32 v245, 1.0, v245
    v_add_f32 v246, 1.0, v246
    v_add_f32 v247, 1.0, v247
    s_waitcnt lgkmcnt(3)
    v_mfma_f32_32x32x16_bf16 v[144:159], a[144:147], a[16:19], v[144:159]
    ds_read_b128 a[172:175], v2 offset:11264
    s_add_u32 s29, s27, 219136
    buffer_load_dwordx4 v252, s[36:39], s29 offen offset:2048 lds
    v_rcp_f32 v244, v244
    v_rcp_f32 v245, v245
    v_mfma_f32_32x32x16_bf16 v[144:159], a[148:151], a[20:23], v[144:159]
    ds_read_b128 a[176:179], v2 offset:12288
    v_rcp_f32 v246, v246
    v_rcp_f32 v247, v247
    v_mul_f32 v244, v108, v244
    v_mul_f32 v245, v109, v245
    v_mfma_f32_32x32x16_bf16 v[144:159], a[152:155], a[24:27], v[144:159]
    ds_read_b128 a[180:183], v2 offset:13312
    s_add_u32 s29, s27, 227328
    buffer_load_dwordx4 v252, s[36:39], s29 offen offset:3072 lds
    v_mul_f32 v246, v110, v246
    v_mul_f32 v247, v111, v247
    v_cvt_pk_bf16_f32 v206, v244, v245
    v_cvt_pk_bf16_f32 v207, v246, v247
    v_mfma_f32_32x32x16_bf16 v[144:159], a[156:159], a[28:31], v[144:159]
    ds_read_b128 a[184:187], v2 offset:14336
    s_add_u32 s26, s90, 8192
    buffer_store_dwordx4 v[204:207], v1, s[8:11], s26 offen offset:3072 sc1
    v_mul_f32 v232, v112, v112
    v_mul_f32 v233, v113, v113
    v_mul_f32 v234, v114, v114
    s_waitcnt lgkmcnt(3)
    v_mfma_f32_32x32x16_bf16 v[144:159], a[160:163], a[32:35], v[144:159]
    ds_read_b128 a[188:191], v2 offset:15360
    s_add_u32 m0, s18, 81920
    s_add_u32 s29, s27, 239616
    buffer_load_dwordx4 v252, s[36:39], s29 offen offset:0 lds
    v_mul_f32 v235, v115, v115
    v_fma_f32 v232, v232, v8, v7
    v_fma_f32 v233, v233, v8, v7
    v_fma_f32 v234, v234, v8, v7
    v_fma_f32 v235, v235, v8, v7
    v_mfma_f32_32x32x16_bf16 v[144:159], a[164:167], a[36:39], v[144:159]
    ds_read_b128 a[144:147], v2 offset:16384
    v_mul_f32 v232, v232, v112
    v_mul_f32 v233, v233, v113
    v_mul_f32 v234, v234, v114
    v_mul_f32 v235, v235, v115
    v_mfma_f32_32x32x16_bf16 v[144:159], a[168:171], a[40:43], v[144:159]
    ds_read_b128 a[148:151], v2 offset:17408
    v_exp_f32 v232, v232
    v_exp_f32 v233, v233
    v_exp_f32 v234, v234
    v_mfma_f32_32x32x16_bf16 v[144:159], a[172:175], a[44:47], v[144:159]
    ds_read_b128 a[152:155], v2 offset:18432
    v_exp_f32 v235, v235
    v_add_f32 v232, 1.0, v232
    v_add_f32 v233, 1.0, v233
    v_add_f32 v234, 1.0, v234
    s_waitcnt lgkmcnt(3)
    v_mfma_f32_32x32x16_bf16 v[144:159], a[176:179], a[48:51], v[144:159]
    ds_read_b128 a[156:159], v2 offset:19456
    v_add_f32 v235, 1.0, v235
    v_rcp_f32 v232, v232
    v_mfma_f32_32x32x16_bf16 v[144:159], a[180:183], a[52:55], v[144:159]
    ds_read_b128 a[160:163], v2 offset:20480
    v_rcp_f32 v233, v233
    v_rcp_f32 v234, v234
    v_rcp_f32 v235, v235
    v_mfma_f32_32x32x16_bf16 v[144:159], a[184:187], a[56:59], v[144:159]
    ds_read_b128 a[164:167], v2 offset:21504
    v_mul_f32 v232, v112, v232
    v_mul_f32 v233, v113, v233
    v_mul_f32 v234, v114, v234
    v_mul_f32 v235, v115, v235
    v_cvt_pk_bf16_f32 v208, v232, v233
    v_mfma_f32_32x32x16_bf16 v[144:159], a[188:191], a[60:63], v[144:159]
    ds_read_b128 a[168:171], v2 offset:22528
    v_cvt_pk_bf16_f32 v209, v234, v235
    v_mul_f32 v236, v116, v116
    v_mul_f32 v237, v117, v117
    v_mul_f32 v238, v118, v118
    v_mul_f32 v239, v119, v119
    s_waitcnt lgkmcnt(3)
    v_mfma_f32_32x32x16_bf16 v[144:159], a[144:147], a[64:67], v[144:159]
    ds_read_b128 a[172:175], v2 offset:23552
    v_fma_f32 v236, v236, v8, v7
    v_fma_f32 v237, v237, v8, v7
    v_fma_f32 v238, v238, v8, v7
    v_fma_f32 v239, v239, v8, v7
    v_mul_f32 v236, v236, v116
    v_mfma_f32_32x32x16_bf16 v[144:159], a[148:151], a[68:71], v[144:159]
    ds_read_b128 a[176:179], v2 offset:24576
    v_mul_f32 v237, v237, v117
    v_mul_f32 v238, v238, v118
    v_mul_f32 v239, v239, v119
    v_exp_f32 v236, v236
    v_mfma_f32_32x32x16_bf16 v[144:159], a[152:155], a[72:75], v[144:159]
    ds_read_b128 a[180:183], v2 offset:25600
    v_exp_f32 v237, v237
    v_exp_f32 v238, v238
    v_mfma_f32_32x32x16_bf16 v[144:159], a[156:159], a[76:79], v[144:159]
    ds_read_b128 a[184:187], v2 offset:26624
    v_exp_f32 v239, v239
    v_add_f32 v236, 1.0, v236
    v_add_f32 v237, 1.0, v237
    v_add_f32 v238, 1.0, v238
    s_waitcnt lgkmcnt(3)
    v_mfma_f32_32x32x16_bf16 v[144:159], a[160:163], a[80:83], v[144:159]
    ds_read_b128 a[188:191], v2 offset:27648
    v_add_f32 v239, 1.0, v239
    v_rcp_f32 v236, v236
    v_rcp_f32 v237, v237
    v_mfma_f32_32x32x16_bf16 v[144:159], a[164:167], a[84:87], v[144:159]
    ds_read_b128 a[144:147], v2 offset:28672
    v_rcp_f32 v238, v238
    v_rcp_f32 v239, v239
    v_mul_f32 v236, v116, v236
    v_mfma_f32_32x32x16_bf16 v[144:159], a[168:171], a[88:91], v[144:159]
    ds_read_b128 a[148:151], v2 offset:29696
    v_mul_f32 v237, v117, v237
    v_mul_f32 v238, v118, v238
    v_mul_f32 v239, v119, v239
    v_cvt_pk_bf16_f32 v210, v236, v237
    v_cvt_pk_bf16_f32 v211, v238, v239
    v_mfma_f32_32x32x16_bf16 v[144:159], a[172:175], a[92:95], v[144:159]
    ds_read_b128 a[152:155], v2 offset:30720
    s_add_u32 s26, s90, 12288
    buffer_store_dwordx4 v[208:211], v1, s[8:11], s26 offen offset:0 sc1
    v_mul_f32 v240, v120, v120
    v_mul_f32 v241, v121, v121
    v_mul_f32 v242, v122, v122
    s_waitcnt lgkmcnt(3)
    v_mfma_f32_32x32x16_bf16 v[144:159], a[176:179], a[96:99], v[144:159]
    ds_read_b128 a[156:159], v2 offset:31744
    v_mul_f32 v243, v123, v123
    v_fma_f32 v240, v240, v8, v7
    v_fma_f32 v241, v241, v8, v7
    v_fma_f32 v242, v242, v8, v7
    v_fma_f32 v243, v243, v8, v7
    v_mfma_f32_32x32x16_bf16 v[144:159], a[180:183], a[100:103], v[144:159]
    ds_read_b128 a[160:163], v2 offset:32768
    v_mul_f32 v240, v240, v120
    v_mul_f32 v241, v241, v121
    v_mul_f32 v242, v242, v122
    v_mul_f32 v243, v243, v123
    v_mfma_f32_32x32x16_bf16 v[144:159], a[184:187], a[104:107], v[144:159]
    ds_read_b128 a[164:167], v2 offset:33792
    v_exp_f32 v240, v240
    v_exp_f32 v241, v241
    v_mfma_f32_32x32x16_bf16 v[144:159], a[188:191], a[108:111], v[144:159]
    ds_read_b128 a[168:171], v2 offset:34816
    s_waitcnt vmcnt(11)
    v_mov_b32 v5, 1
    s_mov_b64 exec, 1
    buffer_store_dword v5, v14, s[8:11], s88 offen sc1
    s_mov_b64 exec, -1
    v_exp_f32 v242, v242
    v_exp_f32 v243, v243
    v_add_f32 v240, 1.0, v240
    v_add_f32 v241, 1.0, v241
    s_waitcnt lgkmcnt(3)
    v_mfma_f32_32x32x16_bf16 v[144:159], a[144:147], a[112:115], v[144:159]
    ds_read_b128 a[172:175], v2 offset:35840
    v_add_f32 v242, 1.0, v242
    v_add_f32 v243, 1.0, v243
    v_rcp_f32 v240, v240
    s_barrier
    v_mfma_f32_32x32x16_bf16 v[144:159], a[148:151], a[116:119], v[144:159]
    ds_read_b128 a[176:179], v6 offset:8192
    v_rcp_f32 v241, v241
    v_rcp_f32 v242, v242
    v_rcp_f32 v243, v243
    v_mfma_f32_32x32x16_bf16 v[144:159], a[152:155], a[120:123], v[144:159]
    ds_read_b64_tr_b16 a[180:181], v249 offset:0
    ds_read_b64_tr_b16 a[182:183], v249 offset:256
    s_add_u32 m0, s18, 110592
    s_add_u32 s29, s28, 256
    buffer_load_dwordx4 v252, s[36:39], s29 offen offset:0 lds
    v_mul_f32 v240, v120, v240
    v_mul_f32 v241, v121, v241
    v_mul_f32 v242, v122, v242
    v_mul_f32 v243, v123, v243
    v_cvt_pk_bf16_f32 v212, v240, v241
    v_mfma_f32_32x32x16_bf16 v[144:159], a[156:159], a[124:127], v[144:159]
    ds_read_b64_tr_b16 a[184:185], v249 offset:512
    ds_read_b64_tr_b16 a[186:187], v249 offset:768
    v_cvt_pk_bf16_f32 v213, v242, v243
    v_mul_f32 v244, v124, v124
    v_mul_f32 v245, v125, v125
    v_mul_f32 v246, v126, v126
    s_waitcnt lgkmcnt(7)
    v_mfma_f32_32x32x16_bf16 v[144:159], a[160:163], a[128:131], v[144:159]
    ds_read_b64_tr_b16 a[188:189], v249 offset:18432
    ds_read_b64_tr_b16 a[190:191], v249 offset:18688
    s_add_u32 s29, s28, 8448
    buffer_load_dwordx4 v252, s[36:39], s29 offen offset:1024 lds
    v_mul_f32 v247, v127, v127
    v_fma_f32 v244, v244, v8, v7
    v_fma_f32 v245, v245, v8, v7
    v_fma_f32 v246, v246, v8, v7
    v_fma_f32 v247, v247, v8, v7
    v_mfma_f32_32x32x16_bf16 v[144:159], a[164:167], a[132:135], v[144:159]
    ds_read_b64_tr_b16 a[144:145], v249 offset:18944
    ds_read_b64_tr_b16 a[146:147], v249 offset:19200
    v_mul_f32 v244, v244, v124
    v_mul_f32 v245, v245, v125
    v_mul_f32 v246, v246, v126
    v_mul_f32 v247, v247, v127
    s_waitcnt lgkmcnt(9)
    v_mfma_f32_32x32x16_bf16 v[144:159], a[168:171], a[136:139], v[144:159]
    ds_read_b64_tr_b16 a[148:149], v249 offset:2048
    ds_read_b64_tr_b16 a[150:151], v249 offset:2304
    s_add_u32 s29, s28, 16640
    buffer_load_dwordx4 v252, s[36:39], s29 offen offset:2048 lds
    v_exp_f32 v244, v244
    v_exp_f32 v245, v245
    v_exp_f32 v246, v246
    v_mfma_f32_32x32x16_bf16 v[144:159], a[172:175], a[140:143], v[144:159]
    ds_read_b64_tr_b16 a[152:153], v249 offset:2560
    ds_read_b64_tr_b16 a[154:155], v249 offset:2816
    v_exp_f32 v247, v247
    v_add_f32 v244, 1.0, v244
    v_add_f32 v245, 1.0, v245
    v_add_f32 v246, 1.0, v246
    s_waitcnt lgkmcnt(10)
    v_mfma_f32_32x32x16_bf16 v[144:159], a[176:179], v[12:15], v[144:159]
    ds_read_b64_tr_b16 a[156:157], v249 offset:20480
    ds_read_b64_tr_b16 a[158:159], v249 offset:20736
    s_add_u32 s29, s28, 24832
    buffer_load_dwordx4 v252, s[36:39], s29 offen offset:3072 lds
    v_add_f32 v247, 1.0, v247
    v_rcp_f32 v244, v244
    v_rcp_f32 v245, v245
    v_mfma_f32_32x32x16_bf16 a[0:15], a[180:183], v[160:163], 0
    ds_read_b64_tr_b16 a[160:161], v249 offset:20992
    ds_read_b64_tr_b16 a[162:163], v249 offset:21248
    v_rcp_f32 v246, v246
    v_rcp_f32 v247, v247
    v_mul_f32 v244, v124, v244
    s_waitcnt lgkmcnt(10)
    v_mfma_f32_32x32x16_bf16 a[16:31], a[184:187], v[160:163], 0
    ds_read_b64_tr_b16 a[164:165], v249 offset:4096
    ds_read_b64_tr_b16 a[166:167], v249 offset:4352
    s_add_u32 m0, s18, 114688
    s_add_u32 s29, s28, 37120
    buffer_load_dwordx4 v252, s[36:39], s29 offen offset:0 lds
    v_mul_f32 v245, v125, v245
    v_mul_f32 v246, v126, v246
    v_mul_f32 v247, v127, v247
    v_cvt_pk_bf16_f32 v214, v244, v245
    v_mfma_f32_32x32x16_bf16 a[32:47], a[188:191], v[160:163], 0
    ds_read_b64_tr_b16 a[168:169], v249 offset:4608
    ds_read_b64_tr_b16 a[170:171], v249 offset:4864
    v_cvt_pk_bf16_f32 v215, v246, v247
    s_add_u32 s26, s90, 12288
    buffer_store_dwordx4 v[212:215], v1, s[8:11], s26 offen offset:1024 sc1
    v_mul_f32 v232, v128, v128
    v_mul_f32 v233, v129, v129
    s_waitcnt lgkmcnt(10)
    v_mfma_f32_32x32x16_bf16 a[48:63], a[144:147], v[160:163], 0
    ds_read_b64_tr_b16 a[172:173], v249 offset:22528
    ds_read_b64_tr_b16 a[174:175], v249 offset:22784
    s_add_u32 s29, s28, 45312
    buffer_load_dwordx4 v252, s[36:39], s29 offen offset:1024 lds
    v_mul_f32 v234, v130, v130
    v_mul_f32 v235, v131, v131
    v_fma_f32 v232, v232, v8, v7
    v_fma_f32 v233, v233, v8, v7
    v_fma_f32 v234, v234, v8, v7
    v_mfma_f32_32x32x16_bf16 a[0:15], a[148:151], v[164:167], a[0:15]
    ds_read_b64_tr_b16 a[176:177], v249 offset:23040
    ds_read_b64_tr_b16 a[178:179], v249 offset:23296
    v_fma_f32 v235, v235, v8, v7
    v_mul_f32 v232, v232, v128
    v_mul_f32 v233, v233, v129
    v_mul_f32 v234, v234, v130
    v_mul_f32 v235, v235, v131
    s_waitcnt lgkmcnt(10)
    v_mfma_f32_32x32x16_bf16 a[16:31], a[152:155], v[164:167], a[16:31]
    ds_read_b64_tr_b16 a[180:181], v249 offset:6144
    ds_read_b64_tr_b16 a[182:183], v249 offset:6400
    s_add_u32 s29, s28, 53504
    buffer_load_dwordx4 v252, s[36:39], s29 offen offset:2048 lds
    v_exp_f32 v232, v232
    v_exp_f32 v233, v233
    v_mfma_f32_32x32x16_bf16 a[32:47], a[156:159], v[164:167], a[32:47]
    ds_read_b64_tr_b16 a[184:185], v249 offset:6656
    ds_read_b64_tr_b16 a[186:187], v249 offset:6912
    v_exp_f32 v234, v234
    v_exp_f32 v235, v235
    v_add_f32 v232, 1.0, v232
    v_add_f32 v233, 1.0, v233
    s_waitcnt lgkmcnt(10)
    v_mfma_f32_32x32x16_bf16 a[48:63], a[160:163], v[164:167], a[48:63]
    ds_read_b64_tr_b16 a[188:189], v249 offset:24576
    ds_read_b64_tr_b16 a[190:191], v249 offset:24832
    s_add_u32 s29, s28, 61696
    buffer_load_dwordx4 v252, s[36:39], s29 offen offset:3072 lds
    v_add_f32 v234, 1.0, v234
    v_add_f32 v235, 1.0, v235
    v_rcp_f32 v232, v232
    v_mfma_f32_32x32x16_bf16 a[0:15], a[164:167], v[168:171], a[0:15]
    ds_read_b64_tr_b16 a[144:145], v249 offset:25088
    ds_read_b64_tr_b16 a[146:147], v249 offset:25344
    v_rcp_f32 v233, v233
    v_rcp_f32 v234, v234
    s_waitcnt lgkmcnt(10)
    v_mfma_f32_32x32x16_bf16 a[16:31], a[168:171], v[168:171], a[16:31]
    ds_read_b64_tr_b16 a[148:149], v249 offset:8192
    ds_read_b64_tr_b16 a[150:151], v249 offset:8448
    s_add_u32 m0, s18, 118784
    s_add_u32 s29, s28, 73984
    buffer_load_dwordx4 v252, s[36:39], s29 offen offset:0 lds
    v_rcp_f32 v235, v235
    v_mul_f32 v232, v128, v232
    v_mul_f32 v233, v129, v233
    v_mul_f32 v234, v130, v234
    v_mul_f32 v235, v131, v235
    v_mfma_f32_32x32x16_bf16 a[32:47], a[172:175], v[168:171], a[32:47]
    ds_read_b64_tr_b16 a[152:153], v249 offset:8704
    ds_read_b64_tr_b16 a[154:155], v249 offset:8960
    v_cvt_pk_bf16_f32 v216, v232, v233
    v_cvt_pk_bf16_f32 v217, v234, v235
    v_mul_f32 v236, v132, v132
    v_mul_f32 v237, v133, v133
    v_mul_f32 v238, v134, v134
    s_waitcnt lgkmcnt(10)
    v_mfma_f32_32x32x16_bf16 a[48:63], a[176:179], v[168:171], a[48:63]
    ds_read_b64_tr_b16 a[156:157], v249 offset:26624
    ds_read_b64_tr_b16 a[158:159], v249 offset:26880
    v_mul_f32 v239, v135, v135
    v_fma_f32 v236, v236, v8, v7
    v_fma_f32 v237, v237, v8, v7
    v_fma_f32 v238, v238, v8, v7
    v_fma_f32 v239, v239, v8, v7
    v_mfma_f32_32x32x16_bf16 a[0:15], a[180:183], v[172:175], a[0:15]
    ds_read_b64_tr_b16 a[160:161], v249 offset:27136
    ds_read_b64_tr_b16 a[162:163], v249 offset:27392
    v_mul_f32 v236, v236, v132
    v_mul_f32 v237, v237, v133
    v_mul_f32 v238, v238, v134
    v_mul_f32 v239, v239, v135
    s_waitcnt lgkmcnt(10)
    v_mfma_f32_32x32x16_bf16 a[16:31], a[184:187], v[172:175], a[16:31]
    ds_read_b64_tr_b16 a[164:165], v249 offset:10240
    ds_read_b64_tr_b16 a[166:167], v249 offset:10496
    v_exp_f32 v236, v236
    v_exp_f32 v237, v237
    v_mfma_f32_32x32x16_bf16 a[32:47], a[188:191], v[172:175], a[32:47]
    ds_read_b64_tr_b16 a[168:169], v249 offset:10752
    ds_read_b64_tr_b16 a[170:171], v249 offset:11008
    buffer_load_dword v254, v14, s[8:11], s89 offen sc1
    v_exp_f32 v238, v238
    v_exp_f32 v239, v239
    v_add_f32 v236, 1.0, v236
    v_add_f32 v237, 1.0, v237
    s_waitcnt lgkmcnt(10)
    v_mfma_f32_32x32x16_bf16 a[48:63], a[144:147], v[172:175], a[48:63]
    ds_read_b64_tr_b16 a[172:173], v249 offset:28672
    ds_read_b64_tr_b16 a[174:175], v249 offset:28928
    v_add_f32 v238, 1.0, v238
    v_add_f32 v239, 1.0, v239
    v_rcp_f32 v236, v236
    v_mfma_f32_32x32x16_bf16 a[0:15], a[148:151], v[176:179], a[0:15]
    ds_read_b64_tr_b16 a[176:177], v249 offset:29184
    ds_read_b64_tr_b16 a[178:179], v249 offset:29440
    v_rcp_f32 v237, v237
    v_rcp_f32 v238, v238
    v_rcp_f32 v239, v239
    s_waitcnt lgkmcnt(10)
    v_mfma_f32_32x32x16_bf16 a[16:31], a[152:155], v[176:179], a[16:31]
    ds_read_b64_tr_b16 a[180:181], v249 offset:12288
    ds_read_b64_tr_b16 a[182:183], v249 offset:12544
    v_mul_f32 v236, v132, v236
    v_mul_f32 v237, v133, v237
    v_mul_f32 v238, v134, v238
    v_mul_f32 v239, v135, v239
    v_cvt_pk_bf16_f32 v218, v236, v237
    v_mfma_f32_32x32x16_bf16 a[32:47], a[156:159], v[176:179], a[32:47]
    ds_read_b64_tr_b16 a[184:185], v249 offset:12800
    ds_read_b64_tr_b16 a[186:187], v249 offset:13056
    v_cvt_pk_bf16_f32 v219, v238, v239
    s_add_u32 s26, s90, 12288
    buffer_store_dwordx4 v[216:219], v1, s[8:11], s26 offen offset:2048 sc1
    v_mul_f32 v240, v136, v136
    v_mul_f32 v241, v137, v137
    s_waitcnt lgkmcnt(10)
    v_mfma_f32_32x32x16_bf16 a[48:63], a[160:163], v[176:179], a[48:63]
    ds_read_b64_tr_b16 a[188:189], v249 offset:30720
    ds_read_b64_tr_b16 a[190:191], v249 offset:30976
    v_mul_f32 v242, v138, v138
    v_mul_f32 v243, v139, v139
    v_fma_f32 v240, v240, v8, v7
    v_fma_f32 v241, v241, v8, v7
    v_fma_f32 v242, v242, v8, v7
    v_mfma_f32_32x32x16_bf16 a[0:15], a[164:167], v[180:183], a[0:15]
    ds_read_b64_tr_b16 a[144:145], v249 offset:31232
    ds_read_b64_tr_b16 a[146:147], v249 offset:31488
    v_fma_f32 v243, v243, v8, v7
    v_mul_f32 v240, v240, v136
    v_mul_f32 v241, v241, v137
    v_mul_f32 v242, v242, v138
    s_waitcnt lgkmcnt(10)
    v_mfma_f32_32x32x16_bf16 a[16:31], a[168:171], v[180:183], a[16:31]
    ds_read_b64_tr_b16 a[148:149], v249 offset:14336
    ds_read_b64_tr_b16 a[150:151], v249 offset:14592
    v_mul_f32 v243, v243, v139
    v_exp_f32 v240, v240
    v_exp_f32 v241, v241
    v_mfma_f32_32x32x16_bf16 a[32:47], a[172:175], v[180:183], a[32:47]
    ds_read_b64_tr_b16 a[152:153], v249 offset:14848
    ds_read_b64_tr_b16 a[154:155], v249 offset:15104
    v_exp_f32 v242, v242
    v_exp_f32 v243, v243
    v_add_f32 v240, 1.0, v240
    s_waitcnt lgkmcnt(10)
    v_mfma_f32_32x32x16_bf16 a[48:63], a[176:179], v[180:183], a[48:63]
    ds_read_b64_tr_b16 a[156:157], v249 offset:32768
    ds_read_b64_tr_b16 a[158:159], v249 offset:33024
    v_add_f32 v241, 1.0, v241
    v_add_f32 v242, 1.0, v242
    v_add_f32 v243, 1.0, v243
    v_rcp_f32 v240, v240
    v_mfma_f32_32x32x16_bf16 a[0:15], a[180:183], v[184:187], a[0:15]
    ds_read_b64_tr_b16 a[160:161], v249 offset:33280
    ds_read_b64_tr_b16 a[162:163], v249 offset:33536
    v_rcp_f32 v241, v241
    v_rcp_f32 v242, v242
    s_waitcnt lgkmcnt(10)
    v_mfma_f32_32x32x16_bf16 a[16:31], a[184:187], v[184:187], a[16:31]
    ds_read_b64_tr_b16 a[164:165], v249 offset:16384
    ds_read_b64_tr_b16 a[166:167], v249 offset:16640
    v_rcp_f32 v243, v243
    v_mul_f32 v240, v136, v240
    v_mul_f32 v241, v137, v241
    v_mul_f32 v242, v138, v242
    v_mul_f32 v243, v139, v243
    v_mfma_f32_32x32x16_bf16 a[32:47], a[188:191], v[184:187], a[32:47]
    ds_read_b64_tr_b16 a[168:169], v249 offset:16896
    ds_read_b64_tr_b16 a[170:171], v249 offset:17152
    v_cvt_pk_bf16_f32 v220, v240, v241
    v_cvt_pk_bf16_f32 v221, v242, v243
    v_mul_f32 v244, v140, v140
    v_mul_f32 v245, v141, v141
    s_waitcnt lgkmcnt(10)
    v_mfma_f32_32x32x16_bf16 a[48:63], a[144:147], v[184:187], a[48:63]
    ds_read_b64_tr_b16 a[172:173], v249 offset:34816
    ds_read_b64_tr_b16 a[174:175], v249 offset:35072
    v_mul_f32 v246, v142, v142
    v_mul_f32 v247, v143, v143
    v_fma_f32 v244, v244, v8, v7
    v_fma_f32 v245, v245, v8, v7
    v_fma_f32 v246, v246, v8, v7
    s_waitcnt vmcnt(14)
    s_barrier
    v_mfma_f32_32x32x16_bf16 a[0:15], a[148:151], v[188:191], a[0:15]
    ds_read_b64_tr_b16 a[176:177], v249 offset:35328
    ds_read_b64_tr_b16 a[178:179], v249 offset:35584
    v_fma_f32 v247, v247, v8, v7
    v_mul_f32 v244, v244, v140
    v_mul_f32 v245, v245, v141
    v_mul_f32 v246, v246, v142
    v_mul_f32 v247, v247, v143
    s_waitcnt lgkmcnt(10)
    v_mfma_f32_32x32x16_bf16 a[16:31], a[152:155], v[188:191], a[16:31]
    ds_read_b64_tr_b16 a[180:181], v250 offset:0
    ds_read_b64_tr_b16 a[182:183], v250 offset:256
    s_add_u32 m0, s18, 0
    s_add_u32 s29, s28, 384
    buffer_load_dwordx4 v252, s[36:39], s29 offen offset:0 lds
    v_exp_f32 v244, v244
    v_exp_f32 v245, v245
    v_mfma_f32_32x32x16_bf16 a[32:47], a[156:159], v[188:191], a[32:47]
    ds_read_b64_tr_b16 a[184:185], v250 offset:512
    ds_read_b64_tr_b16 a[186:187], v250 offset:768
    v_exp_f32 v246, v246
    v_exp_f32 v247, v247
    v_add_f32 v244, 1.0, v244
    v_add_f32 v245, 1.0, v245
    s_waitcnt lgkmcnt(10)
    v_mfma_f32_32x32x16_bf16 a[48:63], a[160:163], v[188:191], a[48:63]
    ds_read_b64_tr_b16 a[188:189], v250 offset:18432
    ds_read_b64_tr_b16 a[190:191], v250 offset:18688
    s_add_u32 s29, s28, 8576
    buffer_load_dwordx4 v252, s[36:39], s29 offen offset:1024 lds
    v_add_f32 v246, 1.0, v246
    v_add_f32 v247, 1.0, v247
    v_rcp_f32 v244, v244
    v_mfma_f32_32x32x16_bf16 a[0:15], a[164:167], v[192:195], a[0:15]
    ds_read_b64_tr_b16 a[144:145], v250 offset:18944
    ds_read_b64_tr_b16 a[146:147], v250 offset:19200
    v_rcp_f32 v245, v245
    v_rcp_f32 v246, v246
    v_rcp_f32 v247, v247
    s_waitcnt lgkmcnt(10)
    v_mfma_f32_32x32x16_bf16 a[16:31], a[168:171], v[192:195], a[16:31]
    ds_read_b64_tr_b16 a[148:149], v250 offset:2048
    ds_read_b64_tr_b16 a[150:151], v250 offset:2304
    s_add_u32 s29, s28, 16768
    buffer_load_dwordx4 v252, s[36:39], s29 offen offset:2048 lds
    v_mul_f32 v244, v140, v244
    v_mul_f32 v245, v141, v245
    v_mul_f32 v246, v142, v246
    v_mul_f32 v247, v143, v247
    v_mfma_f32_32x32x16_bf16 a[32:47], a[172:175], v[192:195], a[32:47]
    ds_read_b64_tr_b16 a[152:153], v250 offset:2560
    ds_read_b64_tr_b16 a[154:155], v250 offset:2816
    v_cvt_pk_bf16_f32 v222, v244, v245
    v_cvt_pk_bf16_f32 v223, v246, v247
    s_add_u32 s26, s90, 12288
    buffer_store_dwordx4 v[220:223], v1, s[8:11], s26 offen offset:3072 sc1
    v_mul_f32 v232, v144, v144
    s_waitcnt lgkmcnt(10)
    v_mfma_f32_32x32x16_bf16 a[48:63], a[176:179], v[192:195], a[48:63]
    ds_read_b64_tr_b16 a[156:157], v250 offset:20480
    ds_read_b64_tr_b16 a[158:159], v250 offset:20736
    s_add_u32 s29, s28, 24960
    buffer_load_dwordx4 v252, s[36:39], s29 offen offset:3072 lds
    v_mul_f32 v233, v145, v145
    v_mul_f32 v234, v146, v146
    v_mul_f32 v235, v147, v147
    v_fma_f32 v232, v232, v8, v7
    v_fma_f32 v233, v233, v8, v7
    v_mfma_f32_32x32x16_bf16 a[0:15], a[180:183], v[196:199], a[0:15]
    ds_read_b64_tr_b16 a[160:161], v250 offset:20992
    ds_read_b64_tr_b16 a[162:163], v250 offset:21248
    v_fma_f32 v234, v234, v8, v7
    v_fma_f32 v235, v235, v8, v7
    v_mul_f32 v232, v232, v144
    v_mul_f32 v233, v233, v145
    v_mul_f32 v234, v234, v146
    s_waitcnt lgkmcnt(10)
    v_mfma_f32_32x32x16_bf16 a[16:31], a[184:187], v[196:199], a[16:31]
    ds_read_b64_tr_b16 a[164:165], v250 offset:4096
    ds_read_b64_tr_b16 a[166:167], v250 offset:4352
    s_add_u32 m0, s18, 4096
    s_add_u32 s29, s28, 37248
    buffer_load_dwordx4 v252, s[36:39], s29 offen offset:0 lds
    v_mul_f32 v235, v235, v147
    v_exp_f32 v232, v232
    v_exp_f32 v233, v233
    v_mfma_f32_32x32x16_bf16 a[32:47], a[188:191], v[196:199], a[32:47]
    ds_read_b64_tr_b16 a[168:169], v250 offset:4608
    ds_read_b64_tr_b16 a[170:171], v250 offset:4864
    s_waitcnt vmcnt(7)
    v_cmp_gt_u32 vcc, 1, v254
    s_cbranch_vccnz KM_slowH1
KM_backH1:
    v_exp_f32 v234, v234
    v_exp_f32 v235, v235
    v_add_f32 v232, 1.0, v232
    s_waitcnt lgkmcnt(10)
    v_mfma_f32_32x32x16_bf16 a[48:63], a[144:147], v[196:199], a[48:63]
    ds_read_b64_tr_b16 a[172:173], v250 offset:22528
    ds_read_b64_tr_b16 a[174:175], v250 offset:22784
    s_add_u32 s26, s91, 0
    buffer_load_dwordx4 a[64:67], v1, s[8:11], s26 offen offset:0 sc1
    s_add_u32 s29, s28, 45440
    buffer_load_dwordx4 v252, s[36:39], s29 offen offset:1024 lds
    v_add_f32 v233, 1.0, v233
    v_add_f32 v234, 1.0, v234
    v_add_f32 v235, 1.0, v235
    v_mfma_f32_32x32x16_bf16 a[0:15], a[148:151], v[200:203], a[0:15]
    ds_read_b64_tr_b16 a[176:177], v250 offset:23040
    ds_read_b64_tr_b16 a[178:179], v250 offset:23296
    v_rcp_f32 v232, v232
    v_rcp_f32 v233, v233
    v_rcp_f32 v234, v234
    s_waitcnt lgkmcnt(10)
    v_mfma_f32_32x32x16_bf16 a[16:31], a[152:155], v[200:203], a[16:31]
    ds_read_b64_tr_b16 a[180:181], v250 offset:6144
    ds_read_b64_tr_b16 a[182:183], v250 offset:6400
    s_add_u32 s29, s28, 53632
    buffer_load_dwordx4 v252, s[36:39], s29 offen offset:2048 lds
    v_rcp_f32 v235, v235
    v_mul_f32 v232, v144, v232
    v_mul_f32 v233, v145, v233
    v_mul_f32 v234, v146, v234
    v_mfma_f32_32x32x16_bf16 a[32:47], a[156:159], v[200:203], a[32:47]
    ds_read_b64_tr_b16 a[184:185], v250 offset:6656
    ds_read_b64_tr_b16 a[186:187], v250 offset:6912
    v_mul_f32 v235, v147, v235
    v_cvt_pk_bf16_f32 v224, v232, v233
    v_cvt_pk_bf16_f32 v225, v234, v235
    v_mul_f32 v236, v148, v148
    v_mul_f32 v237, v149, v149
    s_waitcnt lgkmcnt(10)
    v_mfma_f32_32x32x16_bf16 a[48:63], a[160:163], v[200:203], a[48:63]
    ds_read_b64_tr_b16 a[188:189], v250 offset:24576
    ds_read_b64_tr_b16 a[190:191], v250 offset:24832
    s_add_u32 s29, s28, 61824
    buffer_load_dwordx4 v252, s[36:39], s29 offen offset:3072 lds
    v_mul_f32 v238, v150, v150
    v_mul_f32 v239, v151, v151
    v_fma_f32 v236, v236, v8, v7
    v_fma_f32 v237, v237, v8, v7
    v_fma_f32 v238, v238, v8, v7
    v_mfma_f32_32x32x16_bf16 a[0:15], a[164:167], v[204:207], a[0:15]
    ds_read_b64_tr_b16 a[144:145], v250 offset:25088
    ds_read_b64_tr_b16 a[146:147], v250 offset:25344
    v_fma_f32 v239, v239, v8, v7
    v_mul_f32 v236, v236, v148
    v_mul_f32 v237, v237, v149
    v_mul_f32 v238, v238, v150
    v_mul_f32 v239, v239, v151
    s_waitcnt lgkmcnt(10)
    v_mfma_f32_32x32x16_bf16 a[16:31], a[168:171], v[204:207], a[16:31]
    ds_read_b64_tr_b16 a[148:149], v250 offset:8192
    ds_read_b64_tr_b16 a[150:151], v250 offset:8448
    s_add_u32 m0, s18, 8192
    s_add_u32 s29, s28, 74112
    buffer_load_dwordx4 v252, s[36:39], s29 offen offset:0 lds
    v_exp_f32 v236, v236
    v_exp_f32 v237, v237
    v_mfma_f32_32x32x16_bf16 a[32:47], a[172:175], v[204:207], a[32:47]
    ds_read_b64_tr_b16 a[152:153], v250 offset:8704
    ds_read_b64_tr_b16 a[154:155], v250 offset:8960
    v_exp_f32 v238, v238
    v_exp_f32 v239, v239
    v_add_f32 v236, 1.0, v236
    s_waitcnt lgkmcnt(10)
    v_mfma_f32_32x32x16_bf16 a[48:63], a[176:179], v[204:207], a[48:63]
    ds_read_b64_tr_b16 a[156:157], v250 offset:26624
    ds_read_b64_tr_b16 a[158:159], v250 offset:26880
    s_add_u32 s26, s91, 0
    buffer_load_dwordx4 a[68:71], v1, s[8:11], s26 offen offset:1024 sc1
    v_add_f32 v237, 1.0, v237
    v_add_f32 v238, 1.0, v238
    v_add_f32 v239, 1.0, v239
    v_rcp_f32 v236, v236
    v_mfma_f32_32x32x16_bf16 a[0:15], a[180:183], v[208:211], a[0:15]
    ds_read_b64_tr_b16 a[160:161], v250 offset:27136
    ds_read_b64_tr_b16 a[162:163], v250 offset:27392
    v_rcp_f32 v237, v237
    v_rcp_f32 v238, v238
    s_waitcnt lgkmcnt(10)
    v_mfma_f32_32x32x16_bf16 a[16:31], a[184:187], v[208:211], a[16:31]
    ds_read_b64_tr_b16 a[164:165], v250 offset:10240
    ds_read_b64_tr_b16 a[166:167], v250 offset:10496
    v_rcp_f32 v239, v239
    v_mul_f32 v236, v148, v236
    v_mul_f32 v237, v149, v237
    v_mul_f32 v238, v150, v238
    v_mul_f32 v239, v151, v239
    v_mfma_f32_32x32x16_bf16 a[32:47], a[188:191], v[208:211], a[32:47]
    ds_read_b64_tr_b16 a[168:169], v250 offset:10752
    ds_read_b64_tr_b16 a[170:171], v250 offset:11008
    v_cvt_pk_bf16_f32 v226, v236, v237
    v_cvt_pk_bf16_f32 v227, v238, v239
    s_add_u32 s26, s90, 16384
    buffer_store_dwordx4 v[224:227], v1, s[8:11], s26 offen offset:0 sc1
    v_mul_f32 v240, v152, v152
    s_waitcnt lgkmcnt(10)
    v_mfma_f32_32x32x16_bf16 a[48:63], a[144:147], v[208:211], a[48:63]
    ds_read_b64_tr_b16 a[172:173], v250 offset:28672
    ds_read_b64_tr_b16 a[174:175], v250 offset:28928
    v_mul_f32 v241, v153, v153
    v_mul_f32 v242, v154, v154
    v_mul_f32 v243, v155, v155
    v_fma_f32 v240, v240, v8, v7
    v_fma_f32 v241, v241, v8, v7
    v_mfma_f32_32x32x16_bf16 a[0:15], a[148:151], v[212:215], a[0:15]
    ds_read_b64_tr_b16 a[176:177], v250 offset:29184
    ds_read_b64_tr_b16 a[178:179], v250 offset:29440
    v_fma_f32 v242, v242, v8, v7
    v_fma_f32 v243, v243, v8, v7
    v_mul_f32 v240, v240, v152
    v_mul_f32 v241, v241, v153
    s_waitcnt lgkmcnt(10)
    v_mfma_f32_32x32x16_bf16 a[16:31], a[152:155], v[212:215], a[16:31]
    ds_read_b64_tr_b16 a[180:181], v250 offset:12288
    ds_read_b64_tr_b16 a[182:183], v250 offset:12544
    v_mul_f32 v242, v242, v154
    v_mul_f32 v243, v243, v155
    v_exp_f32 v240, v240
    v_mfma_f32_32x32x16_bf16 a[32:47], a[156:159], v[212:215], a[32:47]
    ds_read_b64_tr_b16 a[184:185], v250 offset:12800
    ds_read_b64_tr_b16 a[186:187], v250 offset:13056
    v_exp_f32 v241, v241
    v_exp_f32 v242, v242
    v_exp_f32 v243, v243
    s_waitcnt lgkmcnt(10)
    v_mfma_f32_32x32x16_bf16 a[48:63], a[160:163], v[212:215], a[48:63]
    ds_read_b64_tr_b16 a[188:189], v250 offset:30720
    ds_read_b64_tr_b16 a[190:191], v250 offset:30976
    s_add_u32 s26, s91, 0
    buffer_load_dwordx4 a[72:75], v1, s[8:11], s26 offen offset:2048 sc1
    v_add_f32 v240, 1.0, v240
    v_add_f32 v241, 1.0, v241
    v_add_f32 v242, 1.0, v242
    v_add_f32 v243, 1.0, v243
    v_mfma_f32_32x32x16_bf16 a[0:15], a[164:167], v[216:219], a[0:15]
    ds_read_b64_tr_b16 a[144:145], v250 offset:31232
    ds_read_b64_tr_b16 a[146:147], v250 offset:31488
    v_rcp_f32 v240, v240
    v_rcp_f32 v241, v241
    v_rcp_f32 v242, v242
    s_waitcnt lgkmcnt(10)
    v_mfma_f32_32x32x16_bf16 a[16:31], a[168:171], v[216:219], a[16:31]
    ds_read_b64_tr_b16 a[148:149], v250 offset:14336
    ds_read_b64_tr_b16 a[150:151], v250 offset:14592
    v_rcp_f32 v243, v243
    v_mul_f32 v240, v152, v240
    v_mul_f32 v241, v153, v241
    v_mul_f32 v242, v154, v242
    v_mfma_f32_32x32x16_bf16 a[32:47], a[172:175], v[216:219], a[32:47]
    ds_read_b64_tr_b16 a[152:153], v250 offset:14848
    ds_read_b64_tr_b16 a[154:155], v250 offset:15104
    v_mul_f32 v243, v155, v243
    v_cvt_pk_bf16_f32 v228, v240, v241
    v_cvt_pk_bf16_f32 v229, v242, v243
    v_mul_f32 v244, v156, v156
    s_waitcnt lgkmcnt(10)
    v_mfma_f32_32x32x16_bf16 a[48:63], a[176:179], v[216:219], a[48:63]
    ds_read_b64_tr_b16 a[156:157], v250 offset:32768
    ds_read_b64_tr_b16 a[158:159], v250 offset:33024
    v_mul_f32 v245, v157, v157
    v_mul_f32 v246, v158, v158
    v_mul_f32 v247, v159, v159
    v_fma_f32 v244, v244, v8, v7
    v_fma_f32 v245, v245, v8, v7
    v_mfma_f32_32x32x16_bf16 a[0:15], a[180:183], v[220:223], a[0:15]
    ds_read_b64_tr_b16 a[160:161], v250 offset:33280
    ds_read_b64_tr_b16 a[162:163], v250 offset:33536
    v_fma_f32 v246, v246, v8, v7
    v_fma_f32 v247, v247, v8, v7
    v_mul_f32 v244, v244, v156
    v_mul_f32 v245, v245, v157
    v_mul_f32 v246, v246, v158
    s_waitcnt lgkmcnt(10)
    v_mfma_f32_32x32x16_bf16 a[16:31], a[184:187], v[220:223], a[16:31]
    ds_read_b64_tr_b16 a[164:165], v250 offset:16384
    ds_read_b64_tr_b16 a[166:167], v250 offset:16640
    v_mul_f32 v247, v247, v159
    v_exp_f32 v244, v244
    v_exp_f32 v245, v245
    v_mfma_f32_32x32x16_bf16 a[32:47], a[188:191], v[220:223], a[32:47]
    ds_read_b64_tr_b16 a[168:169], v250 offset:16896
    ds_read_b64_tr_b16 a[170:171], v250 offset:17152
    v_exp_f32 v246, v246
    v_exp_f32 v247, v247
    v_add_f32 v244, 1.0, v244
    s_waitcnt lgkmcnt(10)
    v_mfma_f32_32x32x16_bf16 a[48:63], a[144:147], v[220:223], a[48:63]
    ds_read_b64_tr_b16 a[172:173], v250 offset:34816
    ds_read_b64_tr_b16 a[174:175], v250 offset:35072
    s_add_u32 s26, s91, 0
    buffer_load_dwordx4 a[76:79], v1, s[8:11], s26 offen offset:3072 sc1
    v_add_f32 v245, 1.0, v245
    v_add_f32 v246, 1.0, v246
    v_add_f32 v247, 1.0, v247
    v_rcp_f32 v244, v244
    s_barrier
    v_mfma_f32_32x32x16_bf16 a[0:15], a[148:151], v[224:227], a[0:15]
    ds_read_b64_tr_b16 a[176:177], v250 offset:35328
    ds_read_b64_tr_b16 a[178:179], v250 offset:35584
    v_rcp_f32 v245, v245
    v_rcp_f32 v246, v246
    s_waitcnt lgkmcnt(10)
    v_mfma_f32_32x32x16_bf16 a[16:31], a[152:155], v[224:227], a[16:31]
    ds_read_b64_tr_b16 a[180:181], v251 offset:0
    ds_read_b64_tr_b16 a[182:183], v251 offset:256
    s_add_u32 m0, s18, 36864
    s_add_u32 s29, s93, 0
    buffer_load_dwordx4 v252, s[36:39], s29 offen offset:0 lds
    v_rcp_f32 v247, v247
    v_mul_f32 v244, v156, v244
    v_mul_f32 v245, v157, v245
    v_mul_f32 v246, v158, v246
    v_mfma_f32_32x32x16_bf16 a[32:47], a[156:159], v[224:227], a[32:47]
    ds_read_b64_tr_b16 a[184:185], v251 offset:2048
    ds_read_b64_tr_b16 a[186:187], v251 offset:2304
    v_mul_f32 v247, v159, v247
    v_cvt_pk_bf16_f32 v230, v244, v245
    v_cvt_pk_bf16_f32 v231, v246, v247
    s_add_u32 s26, s90, 16384
    buffer_store_dwordx4 v[228:231], v1, s[8:11], s26 offen offset:1024 sc1
    s_waitcnt lgkmcnt(10)
    v_mfma_f32_32x32x16_bf16 a[48:63], a[160:163], v[224:227], a[48:63]
    ds_read_b64_tr_b16 a[188:189], v251 offset:4096
    ds_read_b64_tr_b16 a[190:191], v251 offset:4352
    s_add_u32 s29, s93, 8192
    buffer_load_dwordx4 v252, s[36:39], s29 offen offset:1024 lds
    v_mfma_f32_32x32x16_bf16 a[0:15], a[164:167], v[228:231], a[0:15]
    ds_read_b64_tr_b16 a[144:145], v251 offset:6144
    ds_read_b64_tr_b16 a[146:147], v251 offset:6400
    s_waitcnt lgkmcnt(10)
    v_mfma_f32_32x32x16_bf16 a[16:31], a[168:171], v[228:231], a[16:31]
    ds_read_b64_tr_b16 a[148:149], v251 offset:8192
    ds_read_b64_tr_b16 a[150:151], v251 offset:8448
    s_add_u32 s29, s93, 16384
    buffer_load_dwordx4 v252, s[36:39], s29 offen offset:2048 lds
    v_mfma_f32_32x32x16_bf16 a[32:47], a[172:175], v[228:231], a[32:47]
    ds_read_b64_tr_b16 a[152:153], v251 offset:10240
    ds_read_b64_tr_b16 a[154:155], v251 offset:10496
    s_waitcnt lgkmcnt(10)
    v_mfma_f32_32x32x16_bf16 a[48:63], a[176:179], v[228:231], a[48:63]
    ds_read_b64_tr_b16 a[156:157], v251 offset:12288
    ds_read_b64_tr_b16 a[158:159], v251 offset:12544
    s_add_u32 s26, s91, 4096
    buffer_load_dwordx4 a[80:83], v1, s[8:11], s26 offen offset:0 sc1
    s_add_u32 s29, s93, 24576
    buffer_load_dwordx4 v252, s[36:39], s29 offen offset:3072 lds
    v_mfma_f32_32x32x16_bf16 v[16:31], a[180:183], v[160:163], 0
    ds_read_b64_tr_b16 a[160:161], v251 offset:14336
    ds_read_b64_tr_b16 a[162:163], v251 offset:14592
    s_waitcnt lgkmcnt(10)
    v_mfma_f32_32x32x16_bf16 v[16:31], a[184:187], v[164:167], v[16:31]
    ds_read_b64_tr_b16 a[164:165], v251 offset:16384
    ds_read_b64_tr_b16 a[166:167], v251 offset:16640
    s_add_u32 m0, s18, 40960
    s_add_u32 s29, s93, 36864
    buffer_load_dwordx4 v252, s[36:39], s29 offen offset:0 lds
    v_mfma_f32_32x32x16_bf16 v[16:31], a[188:191], v[168:171], v[16:31]
    ds_read_b64_tr_b16 a[168:169], v251 offset:18432
    ds_read_b64_tr_b16 a[170:171], v251 offset:18688
    s_waitcnt lgkmcnt(10)
    v_mfma_f32_32x32x16_bf16 v[16:31], a[144:147], v[172:175], v[16:31]
    ds_read_b64_tr_b16 a[172:173], v251 offset:20480
    ds_read_b64_tr_b16 a[174:175], v251 offset:20736
    s_add_u32 s29, s93, 45056
    buffer_load_dwordx4 v252, s[36:39], s29 offen offset:1024 lds
    v_mfma_f32_32x32x16_bf16 v[16:31], a[148:151], v[176:179], v[16:31]
    ds_read_b64_tr_b16 a[176:177], v251 offset:22528
    ds_read_b64_tr_b16 a[178:179], v251 offset:22784
    s_waitcnt lgkmcnt(10)
    v_mfma_f32_32x32x16_bf16 v[16:31], a[152:155], v[180:183], v[16:31]
    ds_read_b64_tr_b16 a[180:181], v251 offset:24576
    ds_read_b64_tr_b16 a[182:183], v251 offset:24832
    s_add_u32 s29, s93, 53248
    buffer_load_dwordx4 v252, s[36:39], s29 offen offset:2048 lds
    v_mfma_f32_32x32x16_bf16 v[16:31], a[156:159], v[184:187], v[16:31]
    ds_read_b64_tr_b16 a[184:185], v251 offset:26624
    ds_read_b64_tr_b16 a[186:187], v251 offset:26880
    s_mov_b32 s56, s44
    s_waitcnt lgkmcnt(10)
    v_mfma_f32_32x32x16_bf16 v[16:31], a[160:163], v[188:191], v[16:31]
    ds_read_b64_tr_b16 a[188:189], v251 offset:28672
    ds_read_b64_tr_b16 a[190:191], v251 offset:28928
    s_add_u32 s26, s91, 4096
    buffer_load_dwordx4 a[84:87], v1, s[8:11], s26 offen offset:1024 sc1
    s_add_u32 s29, s93, 61440
    buffer_load_dwordx4 v252, s[36:39], s29 offen offset:3072 lds
    s_mov_b32 s57, s45
    v_mfma_f32_32x32x16_bf16 v[16:31], a[164:167], v[192:195], v[16:31]
    ds_read_b64_tr_b16 a[144:145], v251 offset:30720
    ds_read_b64_tr_b16 a[146:147], v251 offset:30976
    s_mov_b32 s58, 1152
    s_waitcnt lgkmcnt(10)
    v_mfma_f32_32x32x16_bf16 v[16:31], a[168:171], v[196:199], v[16:31]
    ds_read_b64_tr_b16 a[148:149], v251 offset:32768
    ds_read_b64_tr_b16 a[150:151], v251 offset:33024
    s_add_u32 m0, s18, 45056
    s_add_u32 s29, s93, 73728
    buffer_load_dwordx4 v252, s[36:39], s29 offen offset:0 lds
    s_mov_b32 s59, 0x00020000
    v_mfma_f32_32x32x16_bf16 v[16:31], a[172:175], v[200:203], v[16:31]
    ds_read_b64_tr_b16 a[152:153], v251 offset:34816
    ds_read_b64_tr_b16 a[154:155], v251 offset:35072
    v_and_b32 v139, 7, v0
    v_add_u32 v137, s53, v139
    s_waitcnt lgkmcnt(10)
    v_mfma_f32_32x32x16_bf16 v[16:31], a[176:179], v[204:207], v[16:31]
    ds_read_b64_tr_b16 a[156:157], v251 offset:512
    ds_read_b64_tr_b16 a[158:159], v251 offset:768
    v_mul_u32_u24 v137, 48, v137
    v_mfma_f32_32x32x16_bf16 v[16:31], a[180:183], v[208:211], v[16:31]
    ds_read_b64_tr_b16 a[160:161], v251 offset:2560
    ds_read_b64_tr_b16 a[162:163], v251 offset:2816
    v_bfe_u32 v138, v0, 5, 1
    s_waitcnt lgkmcnt(10)
    v_mfma_f32_32x32x16_bf16 v[16:31], a[184:187], v[212:215], v[16:31]
    ds_read_b64_tr_b16 a[164:165], v251 offset:4608
    ds_read_b64_tr_b16 a[166:167], v251 offset:4864
    v_lshlrev_b32 v138, 7, v138
    v_mfma_f32_32x32x16_bf16 v[16:31], a[188:191], v[216:219], v[16:31]
    ds_read_b64_tr_b16 a[168:169], v251 offset:6656
    ds_read_b64_tr_b16 a[170:171], v251 offset:6912
    v_bfe_u32 v136, v0, 3, 1
    v_lshl_add_u32 v138, v136, 4, v138
    s_waitcnt lgkmcnt(10)
    v_mfma_f32_32x32x16_bf16 v[16:31], a[144:147], v[220:223], v[16:31]
    ds_read_b64_tr_b16 a[172:173], v251 offset:8704
    ds_read_b64_tr_b16 a[174:175], v251 offset:8960
    s_add_u32 s26, s91, 4096
    buffer_load_dwordx4 a[88:91], v1, s[8:11], s26 offen offset:2048 sc1
    v_bfe_u32 v136, v0, 4, 1
    v_mfma_f32_32x32x16_bf16 v[16:31], a[148:151], v[224:227], v[16:31]
    ds_read_b64_tr_b16 a[176:177], v251 offset:10752
    ds_read_b64_tr_b16 a[178:179], v251 offset:11008
    v_lshl_add_u32 v138, v136, 3, v138
    s_waitcnt lgkmcnt(10)
    v_mfma_f32_32x32x16_bf16 v[16:31], a[152:155], v[228:231], v[16:31]
    ds_read_b64_tr_b16 a[180:181], v251 offset:12800
    ds_read_b64_tr_b16 a[182:183], v251 offset:13056
    s_lshl_b32 s94, s3, 5
    v_mfma_f32_32x32x16_bf16 v[32:47], a[156:159], v[160:163], 0
    ds_read_b64_tr_b16 a[184:185], v251 offset:14848
    ds_read_b64_tr_b16 a[186:187], v251 offset:15104
    v_add_u32 v138, s94, v138
    s_add_u32 s94, s52, 7077888
    s_waitcnt lgkmcnt(10)
    v_mfma_f32_32x32x16_bf16 v[32:47], a[160:163], v[164:167], v[32:47]
    ds_read_b64_tr_b16 a[188:189], v251 offset:16896
    ds_read_b64_tr_b16 a[190:191], v251 offset:17152
    v_mfma_f32_32x32x16_bf16 v[32:47], a[164:167], v[168:171], v[32:47]
    ds_read_b64_tr_b16 a[144:145], v251 offset:18944
    ds_read_b64_tr_b16 a[146:147], v251 offset:19200
    s_waitcnt lgkmcnt(10)
    v_mfma_f32_32x32x16_bf16 v[32:47], a[168:171], v[172:175], v[32:47]
    ds_read_b64_tr_b16 a[148:149], v251 offset:20992
    ds_read_b64_tr_b16 a[150:151], v251 offset:21248
    v_mfma_f32_32x32x16_bf16 v[32:47], a[172:175], v[176:179], v[32:47]
    ds_read_b64_tr_b16 a[152:153], v251 offset:23040
    ds_read_b64_tr_b16 a[154:155], v251 offset:23296
    buffer_load_dwordx2 v[102:103], v10, s[8:11], s94 offen sc1
    s_add_u32 s94, s94, 8192
    s_waitcnt lgkmcnt(10)
    v_mfma_f32_32x32x16_bf16 v[32:47], a[176:179], v[180:183], v[32:47]
    ds_read_b64_tr_b16 a[156:157], v251 offset:25088
    ds_read_b64_tr_b16 a[158:159], v251 offset:25344
    s_add_u32 s26, s91, 4096
    buffer_load_dwordx4 a[92:95], v1, s[8:11], s26 offen offset:3072 sc1
    v_mfma_f32_32x32x16_bf16 v[32:47], a[180:183], v[184:187], v[32:47]
    ds_read_b64_tr_b16 a[160:161], v251 offset:27136
    ds_read_b64_tr_b16 a[162:163], v251 offset:27392
    s_waitcnt lgkmcnt(10)
    v_mfma_f32_32x32x16_bf16 v[32:47], a[184:187], v[188:191], v[32:47]
    ds_read_b64_tr_b16 a[164:165], v251 offset:29184
    ds_read_b64_tr_b16 a[166:167], v251 offset:29440
    buffer_load_dwordx2 v[104:105], v10, s[8:11], s94 offen sc1
    v_mfma_f32_32x32x16_bf16 v[32:47], a[188:191], v[192:195], v[32:47]
    ds_read_b64_tr_b16 a[168:169], v251 offset:31232
    ds_read_b64_tr_b16 a[170:171], v251 offset:31488
    s_add_u32 s94, s94, 8192
    s_waitcnt lgkmcnt(10)
    v_mfma_f32_32x32x16_bf16 v[32:47], a[144:147], v[196:199], v[32:47]
    ds_read_b64_tr_b16 a[172:173], v251 offset:33280
    ds_read_b64_tr_b16 a[174:175], v251 offset:33536
    s_waitcnt vmcnt(20)
    s_barrier
    v_mfma_f32_32x32x16_bf16 v[32:47], a[148:151], v[200:203], v[32:47]
    ds_read_b64_tr_b16 a[176:177], v251 offset:35328
    ds_read_b64_tr_b16 a[178:179], v251 offset:35584
    s_waitcnt vmcnt(14)
    v_mov_b32 v5, 2
    s_mov_b64 exec, 1
    buffer_store_dword v5, v14, s[8:11], s88 offen sc1
    s_mov_b64 exec, -1
    s_waitcnt lgkmcnt(10)
    v_mfma_f32_32x32x16_bf16 v[32:47], a[152:155], v[204:207], v[32:47]
    ds_read_b64_tr_b16 a[180:181], v248 offset:0
    ds_read_b64_tr_b16 a[182:183], v248 offset:256
    s_add_u32 m0, s18, 73728
    s_add_u32 s29, s93, 165888
    buffer_load_dwordx4 v252, s[36:39], s29 offen offset:0 lds
    buffer_load_dwordx2 v[106:107], v10, s[8:11], s94 offen sc1
    v_mfma_f32_32x32x16_bf16 v[32:47], a[156:159], v[208:211], v[32:47]
    ds_read_b64_tr_b16 a[184:185], v248 offset:2048
    ds_read_b64_tr_b16 a[186:187], v248 offset:2304
    s_add_u32 s94, s94, 8192
    s_waitcnt lgkmcnt(10)
    v_mfma_f32_32x32x16_bf16 v[32:47], a[160:163], v[212:215], v[32:47]
    ds_read_b64_tr_b16 a[188:189], v248 offset:4096
    ds_read_b64_tr_b16 a[190:191], v248 offset:4352
    s_add_u32 s26, s91, 8192
    buffer_load_dwordx4 a[96:99], v1, s[8:11], s26 offen offset:0 sc1
    s_add_u32 s29, s93, 174080
    buffer_load_dwordx4 v252, s[36:39], s29 offen offset:1024 lds
    v_mfma_f32_32x32x16_bf16 v[32:47], a[164:167], v[216:219], v[32:47]
    ds_read_b64_tr_b16 a[144:145], v248 offset:6144
    ds_read_b64_tr_b16 a[146:147], v248 offset:6400
    s_waitcnt lgkmcnt(10)
    v_mfma_f32_32x32x16_bf16 v[32:47], a[168:171], v[220:223], v[32:47]
    ds_read_b64_tr_b16 a[148:149], v248 offset:8192
    ds_read_b64_tr_b16 a[150:151], v248 offset:8448
    s_add_u32 s29, s93, 182272
    buffer_load_dwordx4 v252, s[36:39], s29 offen offset:2048 lds
    buffer_load_dwordx2 v[108:109], v10, s[8:11], s94 offen sc1
    v_mfma_f32_32x32x16_bf16 v[32:47], a[172:175], v[224:227], v[32:47]
    ds_read_b64_tr_b16 a[152:153], v248 offset:10240
    ds_read_b64_tr_b16 a[154:155], v248 offset:10496
    s_add_u32 s94, s94, 8192
    s_waitcnt lgkmcnt(10)
    v_mfma_f32_32x32x16_bf16 v[32:47], a[176:179], v[228:231], v[32:47]
    ds_read_b64_tr_b16 a[156:157], v248 offset:12288
    ds_read_b64_tr_b16 a[158:159], v248 offset:12544
    s_add_u32 s29, s93, 190464
    buffer_load_dwordx4 v252, s[36:39], s29 offen offset:3072 lds
    v_mfma_f32_32x32x16_bf16 v[48:63], a[180:183], v[160:163], 0
    ds_read_b64_tr_b16 a[160:161], v248 offset:14336
    ds_read_b64_tr_b16 a[162:163], v248 offset:14592
    s_waitcnt lgkmcnt(10)
    v_mfma_f32_32x32x16_bf16 v[48:63], a[184:187], v[164:167], v[48:63]
    ds_read_b64_tr_b16 a[164:165], v248 offset:16384
    ds_read_b64_tr_b16 a[166:167], v248 offset:16640
    s_add_u32 m0, s18, 77824
    s_add_u32 s29, s93, 202752
    buffer_load_dwordx4 v252, s[36:39], s29 offen offset:0 lds
    buffer_load_dwordx2 v[110:111], v10, s[8:11], s94 offen sc1
    v_mfma_f32_32x32x16_bf16 v[48:63], a[188:191], v[168:171], v[48:63]
    ds_read_b64_tr_b16 a[168:169], v248 offset:18432
    ds_read_b64_tr_b16 a[170:171], v248 offset:18688
    s_waitcnt lgkmcnt(10)
    v_mfma_f32_32x32x16_bf16 v[48:63], a[144:147], v[172:175], v[48:63]
    ds_read_b64_tr_b16 a[172:173], v248 offset:20480
    ds_read_b64_tr_b16 a[174:175], v248 offset:20736
    s_add_u32 s26, s91, 8192
    buffer_load_dwordx4 a[100:103], v1, s[8:11], s26 offen offset:1024 sc1
    s_add_u32 s29, s93, 210944
    buffer_load_dwordx4 v252, s[36:39], s29 offen offset:1024 lds
    v_mfma_f32_32x32x16_bf16 v[48:63], a[148:151], v[176:179], v[48:63]
    ds_read_b64_tr_b16 a[176:177], v248 offset:22528
    ds_read_b64_tr_b16 a[178:179], v248 offset:22784
    s_waitcnt lgkmcnt(10)
    v_mfma_f32_32x32x16_bf16 v[48:63], a[152:155], v[180:183], v[48:63]
    ds_read_b64_tr_b16 a[180:181], v248 offset:24576
    ds_read_b64_tr_b16 a[182:183], v248 offset:24832
    s_add_u32 s29, s93, 219136
    buffer_load_dwordx4 v252, s[36:39], s29 offen offset:2048 lds
    buffer_load_dwordx2 v[112:113], v138, s[56:59], 0 offen offset:0
    v_mfma_f32_32x32x16_bf16 v[48:63], a[156:159], v[184:187], v[48:63]
    ds_read_b64_tr_b16 a[184:185], v248 offset:26624
    ds_read_b64_tr_b16 a[186:187], v248 offset:26880
    s_waitcnt lgkmcnt(10)
    v_mfma_f32_32x32x16_bf16 v[48:63], a[160:163], v[188:191], v[48:63]
    ds_read_b64_tr_b16 a[188:189], v248 offset:28672
    ds_read_b64_tr_b16 a[190:191], v248 offset:28928
    s_add_u32 s29, s93, 227328
    buffer_load_dwordx4 v252, s[36:39], s29 offen offset:3072 lds
    v_mfma_f32_32x32x16_bf16 v[48:63], a[164:167], v[192:195], v[48:63]
    ds_read_b64_tr_b16 a[144:145], v248 offset:30720
    ds_read_b64_tr_b16 a[146:147], v248 offset:30976
    buffer_load_dwordx2 v[114:115], v138, s[56:59], 0 offen offset:256
    s_waitcnt lgkmcnt(10)
    v_mfma_f32_32x32x16_bf16 v[48:63], a[168:171], v[196:199], v[48:63]
    ds_read_b64_tr_b16 a[148:149], v248 offset:32768
    ds_read_b64_tr_b16 a[150:151], v248 offset:33024
    s_add_u32 m0, s18, 81920
    s_add_u32 s29, s93, 239616
    buffer_load_dwordx4 v252, s[36:39], s29 offen offset:0 lds
    v_mfma_f32_32x32x16_bf16 v[48:63], a[172:175], v[200:203], v[48:63]
    ds_read_b64_tr_b16 a[152:153], v248 offset:34816
    ds_read_b64_tr_b16 a[154:155], v248 offset:35072
    s_waitcnt lgkmcnt(10)
    v_mfma_f32_32x32x16_bf16 v[48:63], a[176:179], v[204:207], v[48:63]
    ds_read_b64_tr_b16 a[156:157], v248 offset:512
    ds_read_b64_tr_b16 a[158:159], v248 offset:768
    s_add_u32 s26, s91, 8192
    buffer_load_dwordx4 a[104:107], v1, s[8:11], s26 offen offset:2048 sc1
    buffer_load_dwordx2 v[116:117], v138, s[56:59], 0 offen offset:512
    v_mfma_f32_32x32x16_bf16 v[48:63], a[180:183], v[208:211], v[48:63]
    ds_read_b64_tr_b16 a[160:161], v248 offset:2560
    ds_read_b64_tr_b16 a[162:163], v248 offset:2816
    s_waitcnt lgkmcnt(10)
    v_mfma_f32_32x32x16_bf16 v[48:63], a[184:187], v[212:215], v[48:63]
    ds_read_b64_tr_b16 a[164:165], v248 offset:4608
    ds_read_b64_tr_b16 a[166:167], v248 offset:4864
    v_mfma_f32_32x32x16_bf16 v[48:63], a[188:191], v[216:219], v[48:63]
    ds_read_b64_tr_b16 a[168:169], v248 offset:6656
    ds_read_b64_tr_b16 a[170:171], v248 offset:6912
    buffer_load_dwordx2 v[118:119], v138, s[56:59], 0 offen offset:768
    s_waitcnt lgkmcnt(10)
    v_mfma_f32_32x32x16_bf16 v[48:63], a[144:147], v[220:223], v[48:63]
    ds_read_b64_tr_b16 a[172:173], v248 offset:8704
    ds_read_b64_tr_b16 a[174:175], v248 offset:8960
    v_mfma_f32_32x32x16_bf16 v[48:63], a[148:151], v[224:227], v[48:63]
    ds_read_b64_tr_b16 a[176:177], v248 offset:10752
    ds_read_b64_tr_b16 a[178:179], v248 offset:11008
    s_waitcnt lgkmcnt(10)
    v_mfma_f32_32x32x16_bf16 v[48:63], a[152:155], v[228:231], v[48:63]
    ds_read_b64_tr_b16 a[180:181], v248 offset:12800
    ds_read_b64_tr_b16 a[182:183], v248 offset:13056
    buffer_load_dwordx2 v[120:121], v138, s[56:59], 0 offen offset:1024
    v_mfma_f32_32x32x16_bf16 v[64:79], a[156:159], v[160:163], 0
    ds_read_b64_tr_b16 a[184:185], v248 offset:14848
    ds_read_b64_tr_b16 a[186:187], v248 offset:15104
    buffer_load_dword v254, v14, s[8:11], s89 offen sc1
    s_mul_i32 s94, s48, 1536
    s_waitcnt lgkmcnt(10)
    v_mfma_f32_32x32x16_bf16 v[64:79], a[160:163], v[164:167], v[64:79]
    ds_read_b64_tr_b16 a[188:189], v248 offset:16896
    ds_read_b64_tr_b16 a[190:191], v248 offset:17152
    s_add_u32 s94, s94, 9437184
    v_mfma_f32_32x32x16_bf16 v[64:79], a[164:167], v[168:171], v[64:79]
    ds_read_b64_tr_b16 a[144:145], v248 offset:18944
    ds_read_b64_tr_b16 a[146:147], v248 offset:19200
    s_waitcnt lgkmcnt(10)
    v_mfma_f32_32x32x16_bf16 v[64:79], a[168:171], v[172:175], v[64:79]
    ds_read_b64_tr_b16 a[148:149], v248 offset:20992
    ds_read_b64_tr_b16 a[150:151], v248 offset:21248
    v_mfma_f32_32x32x16_bf16 v[64:79], a[172:175], v[176:179], v[64:79]
    ds_read_b64_tr_b16 a[152:153], v248 offset:23040
    ds_read_b64_tr_b16 a[154:155], v248 offset:23296
    buffer_load_dwordx4 v[124:127], v137, s[8:11], s94 offen offset:0 sc1
    s_waitcnt lgkmcnt(10)
    v_mfma_f32_32x32x16_bf16 v[64:79], a[176:179], v[180:183], v[64:79]
    ds_read_b64_tr_b16 a[156:157], v248 offset:25088
    ds_read_b64_tr_b16 a[158:159], v248 offset:25344
    v_mfma_f32_32x32x16_bf16 v[64:79], a[180:183], v[184:187], v[64:79]
    ds_read_b64_tr_b16 a[160:161], v248 offset:27136
    ds_read_b64_tr_b16 a[162:163], v248 offset:27392
    s_waitcnt lgkmcnt(10)
    v_mfma_f32_32x32x16_bf16 v[64:79], a[184:187], v[188:191], v[64:79]
    ds_read_b64_tr_b16 a[164:165], v248 offset:29184
    ds_read_b64_tr_b16 a[166:167], v248 offset:29440
    buffer_load_dwordx4 v[128:131], v137, s[8:11], s94 offen offset:16 sc1
    v_mfma_f32_32x32x16_bf16 v[64:79], a[188:191], v[192:195], v[64:79]
    ds_read_b64_tr_b16 a[168:169], v248 offset:31232
    ds_read_b64_tr_b16 a[170:171], v248 offset:31488
    s_waitcnt lgkmcnt(10)
    v_mfma_f32_32x32x16_bf16 v[64:79], a[144:147], v[196:199], v[64:79]
    ds_read_b64_tr_b16 a[172:173], v248 offset:33280
    ds_read_b64_tr_b16 a[174:175], v248 offset:33536
    s_waitcnt vmcnt(28)
    s_barrier
    v_mfma_f32_32x32x16_bf16 v[64:79], a[148:151], v[200:203], v[64:79]
    ds_read_b64_tr_b16 a[176:177], v248 offset:35328
    ds_read_b64_tr_b16 a[178:179], v248 offset:35584
    buffer_load_dwordx4 v[132:135], v137, s[8:11], s94 offen offset:32 sc1
    s_waitcnt lgkmcnt(10)
    v_mfma_f32_32x32x16_bf16 v[64:79], a[152:155], v[204:207], v[64:79]
    ds_read_b64_tr_b16 a[180:181], v249 offset:0
    ds_read_b64_tr_b16 a[182:183], v249 offset:256
    s_add_u32 m0, s18, 110592
    s_add_u32 s29, s85, 256
    buffer_load_dwordx4 v252, s[36:39], s29 offen offset:0 lds
    v_mfma_f32_32x32x16_bf16 v[64:79], a[156:159], v[208:211], v[64:79]
    ds_read_b64_tr_b16 a[184:185], v249 offset:512
    ds_read_b64_tr_b16 a[186:187], v249 offset:768
    s_waitcnt lgkmcnt(10)
    v_mfma_f32_32x32x16_bf16 v[64:79], a[160:163], v[212:215], v[64:79]
    ds_read_b64_tr_b16 a[188:189], v249 offset:18432
    ds_read_b64_tr_b16 a[190:191], v249 offset:18688
    s_add_u32 s29, s85, 8448
    buffer_load_dwordx4 v252, s[36:39], s29 offen offset:1024 lds
    v_mfma_f32_32x32x16_bf16 v[64:79], a[164:167], v[216:219], v[64:79]
    ds_read_b64_tr_b16 a[144:145], v249 offset:18944
    ds_read_b64_tr_b16 a[146:147], v249 offset:19200
    s_waitcnt lgkmcnt(10)
    v_mfma_f32_32x32x16_bf16 v[64:79], a[168:171], v[220:223], v[64:79]
    ds_read_b64_tr_b16 a[148:149], v249 offset:2048
    ds_read_b64_tr_b16 a[150:151], v249 offset:2304
    s_add_u32 s29, s85, 16640
    buffer_load_dwordx4 v252, s[36:39], s29 offen offset:2048 lds
    v_mfma_f32_32x32x16_bf16 v[64:79], a[172:175], v[224:227], v[64:79]
    ds_read_b64_tr_b16 a[152:153], v249 offset:2560
    ds_read_b64_tr_b16 a[154:155], v249 offset:2816
    s_waitcnt lgkmcnt(10)
    v_mfma_f32_32x32x16_bf16 v[64:79], a[176:179], v[228:231], v[64:79]
    ds_read_b64_tr_b16 a[156:157], v249 offset:20480
    ds_read_b64_tr_b16 a[158:159], v249 offset:20736
    s_add_u32 s29, s85, 24832
    buffer_load_dwordx4 v252, s[36:39], s29 offen offset:3072 lds
    v_mfma_f32_32x32x16_bf16 a[0:15], a[180:183], a[64:67], a[0:15]
    ds_read_b64_tr_b16 a[160:161], v249 offset:20992
    ds_read_b64_tr_b16 a[162:163], v249 offset:21248
    s_waitcnt lgkmcnt(10)
    v_mfma_f32_32x32x16_bf16 a[16:31], a[184:187], a[64:67], a[16:31]
    ds_read_b64_tr_b16 a[164:165], v249 offset:4096
    ds_read_b64_tr_b16 a[166:167], v249 offset:4352
    s_add_u32 m0, s18, 114688
    s_add_u32 s29, s85, 37120
    buffer_load_dwordx4 v252, s[36:39], s29 offen offset:0 lds
    v_mfma_f32_32x32x16_bf16 a[32:47], a[188:191], a[64:67], a[32:47]
    ds_read_b64_tr_b16 a[168:169], v249 offset:4608
    ds_read_b64_tr_b16 a[170:171], v249 offset:4864
    s_waitcnt lgkmcnt(10)
    v_mfma_f32_32x32x16_bf16 a[48:63], a[144:147], a[64:67], a[48:63]
    ds_read_b64_tr_b16 a[172:173], v249 offset:22528
    ds_read_b64_tr_b16 a[174:175], v249 offset:22784
    s_add_u32 s29, s85, 45312
    buffer_load_dwordx4 v252, s[36:39], s29 offen offset:1024 lds
    v_mfma_f32_32x32x16_bf16 a[0:15], a[148:151], a[68:71], a[0:15]
    ds_read_b64_tr_b16 a[176:177], v249 offset:23040
    ds_read_b64_tr_b16 a[178:179], v249 offset:23296
    s_waitcnt lgkmcnt(10)
    v_mfma_f32_32x32x16_bf16 a[16:31], a[152:155], a[68:71], a[16:31]
    ds_read_b64_tr_b16 a[180:181], v249 offset:6144
    ds_read_b64_tr_b16 a[182:183], v249 offset:6400
    s_add_u32 s29, s85, 53504
    buffer_load_dwordx4 v252, s[36:39], s29 offen offset:2048 lds
    v_mfma_f32_32x32x16_bf16 a[32:47], a[156:159], a[68:71], a[32:47]
    ds_read_b64_tr_b16 a[184:185], v249 offset:6656
    ds_read_b64_tr_b16 a[186:187], v249 offset:6912
    s_waitcnt vmcnt(10)
    v_cmp_gt_u32 vcc, 2, v254
    s_cbranch_vccnz KM_slowH2
KM_backH2:
    s_waitcnt lgkmcnt(10)
    v_mfma_f32_32x32x16_bf16 a[48:63], a[160:163], a[68:71], a[48:63]
    ds_read_b64_tr_b16 a[188:189], v249 offset:24576
    ds_read_b64_tr_b16 a[190:191], v249 offset:24832
    s_add_u32 s26, s91, 8192
    buffer_load_dwordx4 a[108:111], v1, s[8:11], s26 offen offset:3072 sc1
    s_add_u32 s29, s85, 61696
    buffer_load_dwordx4 v252, s[36:39], s29 offen offset:3072 lds
    v_mfma_f32_32x32x16_bf16 a[0:15], a[164:167], a[72:75], a[0:15]
    ds_read_b64_tr_b16 a[144:145], v249 offset:25088
    ds_read_b64_tr_b16 a[146:147], v249 offset:25344
    s_waitcnt lgkmcnt(10)
    v_mfma_f32_32x32x16_bf16 a[16:31], a[168:171], a[72:75], a[16:31]
    ds_read_b64_tr_b16 a[148:149], v249 offset:8192
    ds_read_b64_tr_b16 a[150:151], v249 offset:8448
    s_add_u32 s26, s91, 12288
    buffer_load_dwordx4 a[112:115], v1, s[8:11], s26 offen offset:0 sc1
    s_add_u32 m0, s18, 118784
    s_add_u32 s29, s85, 73984
    buffer_load_dwordx4 v252, s[36:39], s29 offen offset:0 lds
    v_mfma_f32_32x32x16_bf16 a[32:47], a[172:175], a[72:75], a[32:47]
    ds_read_b64_tr_b16 a[152:153], v249 offset:8704
    ds_read_b64_tr_b16 a[154:155], v249 offset:8960
    s_waitcnt lgkmcnt(10)
    v_mfma_f32_32x32x16_bf16 a[48:63], a[176:179], a[72:75], a[48:63]
    ds_read_b64_tr_b16 a[156:157], v249 offset:26624
    ds_read_b64_tr_b16 a[158:159], v249 offset:26880
    s_add_u32 s26, s91, 12288
    buffer_load_dwordx4 a[116:119], v1, s[8:11], s26 offen offset:1024 sc1
    v_mfma_f32_32x32x16_bf16 a[0:15], a[180:183], a[76:79], a[0:15]
    ds_read_b64_tr_b16 a[160:161], v249 offset:27136
    ds_read_b64_tr_b16 a[162:163], v249 offset:27392
    s_waitcnt lgkmcnt(10)
    v_mfma_f32_32x32x16_bf16 a[16:31], a[184:187], a[76:79], a[16:31]
    ds_read_b64_tr_b16 a[164:165], v249 offset:10240
    ds_read_b64_tr_b16 a[166:167], v249 offset:10496
    s_add_u32 s26, s91, 12288
    buffer_load_dwordx4 a[120:123], v1, s[8:11], s26 offen offset:2048 sc1
    v_mfma_f32_32x32x16_bf16 a[32:47], a[188:191], a[76:79], a[32:47]
    ds_read_b64_tr_b16 a[168:169], v249 offset:10752
    ds_read_b64_tr_b16 a[170:171], v249 offset:11008
    s_waitcnt lgkmcnt(10)
    v_mfma_f32_32x32x16_bf16 a[48:63], a[144:147], a[76:79], a[48:63]
    ds_read_b64_tr_b16 a[172:173], v249 offset:28672
    ds_read_b64_tr_b16 a[174:175], v249 offset:28928
    s_add_u32 s26, s91, 12288
    buffer_load_dwordx4 a[124:127], v1, s[8:11], s26 offen offset:3072 sc1
    v_mfma_f32_32x32x16_bf16 a[0:15], a[148:151], a[80:83], a[0:15]
    ds_read_b64_tr_b16 a[176:177], v249 offset:29184
    ds_read_b64_tr_b16 a[178:179], v249 offset:29440
    s_waitcnt lgkmcnt(10)
    v_mfma_f32_32x32x16_bf16 a[16:31], a[152:155], a[80:83], a[16:31]
    ds_read_b64_tr_b16 a[180:181], v249 offset:12288
    ds_read_b64_tr_b16 a[182:183], v249 offset:12544
    s_add_u32 s26, s91, 16384
    buffer_load_dwordx4 a[128:131], v1, s[8:11], s26 offen offset:0 sc1
    v_mfma_f32_32x32x16_bf16 a[32:47], a[156:159], a[80:83], a[32:47]
    ds_read_b64_tr_b16 a[184:185], v249 offset:12800
    ds_read_b64_tr_b16 a[186:187], v249 offset:13056
    s_waitcnt lgkmcnt(10)
    v_mfma_f32_32x32x16_bf16 a[48:63], a[160:163], a[80:83], a[48:63]
    ds_read_b64_tr_b16 a[188:189], v249 offset:30720
    ds_read_b64_tr_b16 a[190:191], v249 offset:30976
    s_add_u32 s26, s91, 16384
    buffer_load_dwordx4 a[132:135], v1, s[8:11], s26 offen offset:1024 sc1
    v_mfma_f32_32x32x16_bf16 a[0:15], a[164:167], a[84:87], a[0:15]
    ds_read_b64_tr_b16 a[144:145], v249 offset:31232
    ds_read_b64_tr_b16 a[146:147], v249 offset:31488
    s_waitcnt lgkmcnt(10)
    v_mfma_f32_32x32x16_bf16 a[16:31], a[168:171], a[84:87], a[16:31]
    ds_read_b64_tr_b16 a[148:149], v249 offset:14336
    ds_read_b64_tr_b16 a[150:151], v249 offset:14592
    v_mfma_f32_32x32x16_bf16 a[32:47], a[172:175], a[84:87], a[32:47]
    ds_read_b64_tr_b16 a[152:153], v249 offset:14848
    ds_read_b64_tr_b16 a[154:155], v249 offset:15104
    s_waitcnt lgkmcnt(10)
    v_mfma_f32_32x32x16_bf16 a[48:63], a[176:179], a[84:87], a[48:63]
    ds_read_b64_tr_b16 a[156:157], v249 offset:32768
    ds_read_b64_tr_b16 a[158:159], v249 offset:33024
    v_mfma_f32_32x32x16_bf16 a[0:15], a[180:183], a[88:91], a[0:15]
    ds_read_b64_tr_b16 a[160:161], v249 offset:33280
    ds_read_b64_tr_b16 a[162:163], v249 offset:33536
    s_waitcnt lgkmcnt(10)
    v_mfma_f32_32x32x16_bf16 a[16:31], a[184:187], a[88:91], a[16:31]
    ds_read_b64_tr_b16 a[164:165], v249 offset:16384
    ds_read_b64_tr_b16 a[166:167], v249 offset:16640
    v_mfma_f32_32x32x16_bf16 a[32:47], a[188:191], a[88:91], a[32:47]
    ds_read_b64_tr_b16 a[168:169], v249 offset:16896
    ds_read_b64_tr_b16 a[170:171], v249 offset:17152
    s_waitcnt lgkmcnt(10)
    v_mfma_f32_32x32x16_bf16 a[48:63], a[144:147], a[88:91], a[48:63]
    ds_read_b64_tr_b16 a[172:173], v249 offset:34816
    ds_read_b64_tr_b16 a[174:175], v249 offset:35072
    s_barrier
    v_mfma_f32_32x32x16_bf16 a[0:15], a[148:151], a[92:95], a[0:15]
    ds_read_b64_tr_b16 a[176:177], v249 offset:35328
    ds_read_b64_tr_b16 a[178:179], v249 offset:35584
    s_waitcnt lgkmcnt(10)
    v_mfma_f32_32x32x16_bf16 a[16:31], a[152:155], a[92:95], a[16:31]
    ds_read_b64_tr_b16 a[180:181], v250 offset:0
    ds_read_b64_tr_b16 a[182:183], v250 offset:256
    s_add_u32 m0, s18, 0
    s_add_u32 s29, s85, 384
    buffer_load_dwordx4 v252, s[36:39], s29 offen offset:0 lds
    s_waitcnt vmcnt(17)
    v_mfma_f32_32x32x16_bf16 a[32:47], a[156:159], a[92:95], a[32:47]
    ds_read_b64_tr_b16 a[184:185], v250 offset:512
    ds_read_b64_tr_b16 a[186:187], v250 offset:768
    v_add_f32 v141, v124, v126
    v_add_f32 v141, v141, v128
    s_waitcnt lgkmcnt(10)
    v_mfma_f32_32x32x16_bf16 a[48:63], a[160:163], a[92:95], a[48:63]
    ds_read_b64_tr_b16 a[188:189], v250 offset:18432
    ds_read_b64_tr_b16 a[190:191], v250 offset:18688
    s_add_u32 s29, s85, 8576
    buffer_load_dwordx4 v252, s[36:39], s29 offen offset:1024 lds
    v_add_f32 v141, v141, v130
    v_mfma_f32_32x32x16_bf16 a[0:15], a[164:167], a[96:99], a[0:15]
    ds_read_b64_tr_b16 a[144:145], v250 offset:18944
    ds_read_b64_tr_b16 a[146:147], v250 offset:19200
    v_add_f32 v141, v141, v132
    v_add_f32 v141, v141, v134
    s_waitcnt lgkmcnt(10)
    v_mfma_f32_32x32x16_bf16 a[16:31], a[168:171], a[96:99], a[16:31]
    ds_read_b64_tr_b16 a[148:149], v250 offset:2048
    ds_read_b64_tr_b16 a[150:151], v250 offset:2304
    s_add_u32 s29, s85, 16768
    buffer_load_dwordx4 v252, s[36:39], s29 offen offset:2048 lds
    v_mul_f32 v141, 0x3ae38e39, v141
    v_mfma_f32_32x32x16_bf16 a[32:47], a[172:175], a[96:99], a[32:47]
    ds_read_b64_tr_b16 a[152:153], v250 offset:2560
    ds_read_b64_tr_b16 a[154:155], v250 offset:2816
    v_add_f32 v140, v125, v127
    v_add_f32 v140, v140, v129
    s_waitcnt lgkmcnt(10)
    v_mfma_f32_32x32x16_bf16 a[48:63], a[176:179], a[96:99], a[48:63]
    ds_read_b64_tr_b16 a[156:157], v250 offset:20480
    ds_read_b64_tr_b16 a[158:159], v250 offset:20736
    s_add_u32 s29, s85, 24960
    buffer_load_dwordx4 v252, s[36:39], s29 offen offset:3072 lds
    v_add_f32 v140, v140, v131
    v_mfma_f32_32x32x16_bf16 a[0:15], a[180:183], a[100:103], a[0:15]
    ds_read_b64_tr_b16 a[160:161], v250 offset:20992
    ds_read_b64_tr_b16 a[162:163], v250 offset:21248
    v_add_f32 v140, v140, v133
    v_add_f32 v140, v140, v135
    s_waitcnt lgkmcnt(10)
    v_mfma_f32_32x32x16_bf16 a[16:31], a[184:187], a[100:103], a[16:31]
    ds_read_b64_tr_b16 a[164:165], v250 offset:4096
    ds_read_b64_tr_b16 a[166:167], v250 offset:4352
    s_add_u32 m0, s18, 4096
    s_add_u32 s29, s85, 37248
    buffer_load_dwordx4 v252, s[36:39], s29 offen offset:0 lds
    s_mov_b32 s41, 0x3c2aaaab
    v_mfma_f32_32x32x16_bf16 a[32:47], a[188:191], a[100:103], a[32:47]
    ds_read_b64_tr_b16 a[168:169], v250 offset:4608
    ds_read_b64_tr_b16 a[170:171], v250 offset:4864
    v_fma_f32 v124, v124, s41, -v141
    v_fma_f32 v126, v126, s41, -v141
    s_waitcnt lgkmcnt(10)
    v_mfma_f32_32x32x16_bf16 a[48:63], a[144:147], a[100:103], a[48:63]
    ds_read_b64_tr_b16 a[172:173], v250 offset:22528
    ds_read_b64_tr_b16 a[174:175], v250 offset:22784
    s_add_u32 s29, s85, 45440
    buffer_load_dwordx4 v252, s[36:39], s29 offen offset:1024 lds
    v_fma_f32 v128, v128, s41, -v141
    v_mfma_f32_32x32x16_bf16 a[0:15], a[148:151], a[104:107], a[0:15]
    ds_read_b64_tr_b16 a[176:177], v250 offset:23040
    ds_read_b64_tr_b16 a[178:179], v250 offset:23296
    v_fma_f32 v130, v130, s41, -v141
    v_fma_f32 v132, v132, s41, -v141
    s_waitcnt lgkmcnt(10)
    v_mfma_f32_32x32x16_bf16 a[16:31], a[152:155], a[104:107], a[16:31]
    ds_read_b64_tr_b16 a[180:181], v250 offset:6144
    ds_read_b64_tr_b16 a[182:183], v250 offset:6400
    s_add_u32 s29, s85, 53632
    buffer_load_dwordx4 v252, s[36:39], s29 offen offset:2048 lds
    v_fma_f32 v134, v134, s41, -v141
    v_mul_f32 v136, v124, v124
    v_mfma_f32_32x32x16_bf16 a[32:47], a[156:159], a[104:107], a[32:47]
    ds_read_b64_tr_b16 a[184:185], v250 offset:6656
    ds_read_b64_tr_b16 a[186:187], v250 offset:6912
    v_fmac_f32 v136, v126, v126
    s_waitcnt lgkmcnt(10)
    v_mfma_f32_32x32x16_bf16 a[48:63], a[160:163], a[104:107], a[48:63]
    ds_read_b64_tr_b16 a[188:189], v250 offset:24576
    ds_read_b64_tr_b16 a[190:191], v250 offset:24832
    s_add_u32 s29, s85, 61824
    buffer_load_dwordx4 v252, s[36:39], s29 offen offset:3072 lds
    v_fmac_f32 v136, v128, v128
    v_fmac_f32 v136, v130, v130
    s_waitcnt vmcnt(16)
    v_mfma_f32_32x32x16_bf16 a[0:15], a[164:167], a[108:111], a[0:15]
    ds_read_b64_tr_b16 a[144:145], v250 offset:25088
    ds_read_b64_tr_b16 a[146:147], v250 offset:25344
    v_fmac_f32 v136, v132, v132
    s_waitcnt lgkmcnt(10)
    v_mfma_f32_32x32x16_bf16 a[16:31], a[168:171], a[108:111], a[16:31]
    ds_read_b64_tr_b16 a[148:149], v250 offset:8192
    ds_read_b64_tr_b16 a[150:151], v250 offset:8448
    s_add_u32 m0, s18, 8192
    s_add_u32 s29, s85, 74112
    buffer_load_dwordx4 v252, s[36:39], s29 offen offset:0 lds
    v_fmac_f32 v136, v134, v134
    v_fmac_f32 v140, 0x42c00000, v136
    v_mfma_f32_32x32x16_bf16 a[32:47], a[172:175], a[108:111], a[32:47]
    ds_read_b64_tr_b16 a[152:153], v250 offset:8704
    ds_read_b64_tr_b16 a[154:155], v250 offset:8960
    v_mul_f32 v140, 0x3ae38e39, v140
    s_waitcnt lgkmcnt(10)
    v_mfma_f32_32x32x16_bf16 a[48:63], a[176:179], a[108:111], a[48:63]
    ds_read_b64_tr_b16 a[156:157], v250 offset:26624
    ds_read_b64_tr_b16 a[158:159], v250 offset:26880
    v_cvt_pk_bf16_f32 v136, v140, v140
    v_lshlrev_b32 v140, 16, v136
    s_waitcnt vmcnt(15)
    v_mfma_f32_32x32x16_bf16 a[0:15], a[180:183], a[112:115], a[0:15]
    ds_read_b64_tr_b16 a[160:161], v250 offset:27136
    ds_read_b64_tr_b16 a[162:163], v250 offset:27392
    v_add_f32 v140, 0x3727c5ac, v140
    s_waitcnt lgkmcnt(10)
    v_mfma_f32_32x32x16_bf16 a[16:31], a[184:187], a[112:115], a[16:31]
    ds_read_b64_tr_b16 a[164:165], v250 offset:10240
    ds_read_b64_tr_b16 a[166:167], v250 offset:10496
    v_cvt_pk_bf16_f32 v136, v140, v140
    v_lshlrev_b32 v140, 16, v136
    v_mfma_f32_32x32x16_bf16 a[32:47], a[188:191], a[112:115], a[32:47]
    ds_read_b64_tr_b16 a[168:169], v250 offset:10752
    ds_read_b64_tr_b16 a[170:171], v250 offset:11008
    v_sqrt_f32 v140, v140
    s_waitcnt lgkmcnt(10)
    v_mfma_f32_32x32x16_bf16 a[48:63], a[144:147], a[112:115], a[48:63]
    ds_read_b64_tr_b16 a[172:173], v250 offset:28672
    ds_read_b64_tr_b16 a[174:175], v250 offset:28928
    v_cvt_pk_bf16_f32 v136, v140, v140
    v_lshlrev_b32 v140, 16, v136
    s_waitcnt vmcnt(13)
    v_mfma_f32_32x32x16_bf16 a[0:15], a[148:151], a[116:119], a[0:15]
    ds_read_b64_tr_b16 a[176:177], v250 offset:29184
    ds_read_b64_tr_b16 a[178:179], v250 offset:29440
    v_cvt_pk_bf16_f32 v136, v141, v141
    s_waitcnt lgkmcnt(10)
    v_mfma_f32_32x32x16_bf16 a[16:31], a[152:155], a[116:119], a[16:31]
    ds_read_b64_tr_b16 a[180:181], v250 offset:12288
    ds_read_b64_tr_b16 a[182:183], v250 offset:12544
    v_lshlrev_b32 v141, 16, v136
    v_rcp_f32 v140, v140
    v_mfma_f32_32x32x16_bf16 a[32:47], a[156:159], a[116:119], a[32:47]
    ds_read_b64_tr_b16 a[184:185], v250 offset:12800
    ds_read_b64_tr_b16 a[186:187], v250 offset:13056
    s_waitcnt lgkmcnt(10)
    v_mfma_f32_32x32x16_bf16 a[48:63], a[160:163], a[116:119], a[48:63]
    ds_read_b64_tr_b16 a[188:189], v250 offset:30720
    ds_read_b64_tr_b16 a[190:191], v250 offset:30976
    s_waitcnt vmcnt(12)
    v_mfma_f32_32x32x16_bf16 a[0:15], a[164:167], a[120:123], a[0:15]
    ds_read_b64_tr_b16 a[144:145], v250 offset:31232
    ds_read_b64_tr_b16 a[146:147], v250 offset:31488
    s_waitcnt lgkmcnt(10)
    v_mfma_f32_32x32x16_bf16 a[16:31], a[168:171], a[120:123], a[16:31]
    ds_read_b64_tr_b16 a[148:149], v250 offset:14336
    ds_read_b64_tr_b16 a[150:151], v250 offset:14592
    v_mfma_f32_32x32x16_bf16 a[32:47], a[172:175], a[120:123], a[32:47]
    ds_read_b64_tr_b16 a[152:153], v250 offset:14848
    ds_read_b64_tr_b16 a[154:155], v250 offset:15104
    s_waitcnt lgkmcnt(10)
    v_mfma_f32_32x32x16_bf16 a[48:63], a[176:179], a[120:123], a[48:63]
    ds_read_b64_tr_b16 a[156:157], v250 offset:32768
    ds_read_b64_tr_b16 a[158:159], v250 offset:33024
    s_waitcnt vmcnt(11)
    v_mfma_f32_32x32x16_bf16 a[0:15], a[180:183], a[124:127], a[0:15]
    ds_read_b64_tr_b16 a[160:161], v250 offset:33280
    ds_read_b64_tr_b16 a[162:163], v250 offset:33536
    s_waitcnt lgkmcnt(10)
    v_mfma_f32_32x32x16_bf16 a[16:31], a[184:187], a[124:127], a[16:31]
    ds_read_b64_tr_b16 a[164:165], v250 offset:16384
    ds_read_b64_tr_b16 a[166:167], v250 offset:16640
    v_mfma_f32_32x32x16_bf16 a[32:47], a[188:191], a[124:127], a[32:47]
    ds_read_b64_tr_b16 a[168:169], v250 offset:16896
    ds_read_b64_tr_b16 a[170:171], v250 offset:17152
    s_waitcnt lgkmcnt(10)
    v_mfma_f32_32x32x16_bf16 a[48:63], a[144:147], a[124:127], a[48:63]
    ds_read_b64_tr_b16 a[172:173], v250 offset:34816
    ds_read_b64_tr_b16 a[174:175], v250 offset:35072
    s_barrier
    s_waitcnt vmcnt(10)
    v_mfma_f32_32x32x16_bf16 a[0:15], a[148:151], a[128:131], a[0:15]
    ds_read_b64_tr_b16 a[176:177], v250 offset:35328
    ds_read_b64_tr_b16 a[178:179], v250 offset:35584
    s_waitcnt lgkmcnt(10)
    v_mfma_f32_32x32x16_bf16 a[16:31], a[152:155], a[128:131], a[16:31]
    ds_read_b64_tr_b16 a[180:181], v251 offset:0
    ds_read_b64_tr_b16 a[182:183], v251 offset:256
    v_lshrrev_b32 v2, 2, v0
    v_mul_u32_u24 v2, 1152, v2
    v_and_b32 v3, 3, v0
    v_lshl_add_u32 v2, v3, 4, v2
    v_lshrrev_b32 v3, 5, v0
    v_lshlrev_b32 v3, 9, v3
    v_sub_u32 v3, v249, v3
    v_mfma_f32_32x32x16_bf16 a[32:47], a[156:159], a[128:131], a[32:47]
    ds_read_b64_tr_b16 a[184:185], v251 offset:2048
    ds_read_b64_tr_b16 a[186:187], v251 offset:2304
    s_waitcnt lgkmcnt(10)
    v_mfma_f32_32x32x16_bf16 a[48:63], a[160:163], a[128:131], a[48:63]
    ds_read_b64_tr_b16 a[188:189], v251 offset:4096
    ds_read_b64_tr_b16 a[190:191], v251 offset:4352
    s_add_u32 m0, s18, 36864
    s_add_u32 s29, s86, 0
    buffer_load_dwordx4 v2, s[36:39], s29 offen offset:0 lds
    s_waitcnt vmcnt(10)
    v_mfma_f32_32x32x16_bf16 a[0:15], a[164:167], a[132:135], a[0:15]
    ds_read_b64_tr_b16 a[144:145], v251 offset:6144
    ds_read_b64_tr_b16 a[146:147], v251 offset:6400
    s_waitcnt lgkmcnt(10)
    v_mfma_f32_32x32x16_bf16 a[16:31], a[168:171], a[132:135], a[16:31]
    ds_read_b64_tr_b16 a[148:149], v251 offset:8192
    ds_read_b64_tr_b16 a[150:151], v251 offset:8448
    s_add_u32 s29, s86, 17408
    buffer_load_dwordx4 v2, s[36:39], s29 offen offset:1024 lds
    v_mfma_f32_32x32x16_bf16 a[32:47], a[172:175], a[132:135], a[32:47]
    ds_read_b64_tr_b16 a[152:153], v251 offset:10240
    ds_read_b64_tr_b16 a[154:155], v251 offset:10496
    s_waitcnt lgkmcnt(10)
    v_mfma_f32_32x32x16_bf16 a[48:63], a[176:179], a[132:135], a[48:63]
    ds_read_b64_tr_b16 a[156:157], v251 offset:12288
    ds_read_b64_tr_b16 a[158:159], v251 offset:12544
    s_add_u32 s29, s86, 34816
    buffer_load_dwordx4 v2, s[36:39], s29 offen offset:2048 lds
    v_mfma_f32_32x32x16_bf16 v[16:31], a[180:183], a[64:67], v[16:31]
    ds_read_b64_tr_b16 a[160:161], v251 offset:14336
    ds_read_b64_tr_b16 a[162:163], v251 offset:14592
    s_waitcnt lgkmcnt(10)
    v_mfma_f32_32x32x16_bf16 v[16:31], a[184:187], a[68:71], v[16:31]
    ds_read_b64_tr_b16 a[164:165], v251 offset:16384
    ds_read_b64_tr_b16 a[166:167], v251 offset:16640
    s_add_u32 s29, s86, 52224
    buffer_load_dwordx4 v2, s[36:39], s29 offen offset:3072 lds
    v_mfma_f32_32x32x16_bf16 v[16:31], a[188:191], a[72:75], v[16:31]
    ds_read_b64_tr_b16 a[168:169], v251 offset:18432
    ds_read_b64_tr_b16 a[170:171], v251 offset:18688
    v_accvgpr_read_b32 v232, a0
    v_accvgpr_read_b32 v233, a1
    v_accvgpr_read_b32 v234, a2
    s_waitcnt lgkmcnt(10)
    v_mfma_f32_32x32x16_bf16 v[16:31], a[144:147], a[76:79], v[16:31]
    ds_read_b64_tr_b16 a[172:173], v251 offset:20480
    ds_read_b64_tr_b16 a[174:175], v251 offset:20736
    s_add_u32 m0, s18, 40960
    s_add_u32 s29, s86, 73728
    buffer_load_dwordx4 v2, s[36:39], s29 offen offset:0 lds
    v_accvgpr_read_b32 v235, a3
    v_accvgpr_read_b32 v236, a4
    v_accvgpr_read_b32 v237, a5
    v_mfma_f32_32x32x16_bf16 v[16:31], a[148:151], a[80:83], v[16:31]
    ds_read_b64_tr_b16 a[176:177], v251 offset:22528
    ds_read_b64_tr_b16 a[178:179], v251 offset:22784
    v_accvgpr_read_b32 v238, a6
    v_accvgpr_read_b32 v239, a7
    v_cvt_pk_bf16_f32 v232, v232, v233
    v_cvt_pk_bf16_f32 v233, v234, v235
    s_waitcnt lgkmcnt(10)
    v_mfma_f32_32x32x16_bf16 v[16:31], a[152:155], a[84:87], v[16:31]
    ds_read_b64_tr_b16 a[180:181], v251 offset:24576
    ds_read_b64_tr_b16 a[182:183], v251 offset:24832
    s_add_u32 s29, s86, 91136
    buffer_load_dwordx4 v2, s[36:39], s29 offen offset:1024 lds
    v_cvt_pk_bf16_f32 v234, v236, v237
    v_cvt_pk_bf16_f32 v235, v238, v239
    v_mfma_f32_32x32x16_bf16 v[16:31], a[156:159], a[88:91], v[16:31]
    ds_read_b64_tr_b16 a[184:185], v251 offset:26624
    ds_read_b64_tr_b16 a[186:187], v251 offset:26880
    s_add_u32 s26, s22, 0
    buffer_store_dwordx4 v[232:235], v253, s[8:11], s26 offen offset:0 sc1
    v_accvgpr_read_b32 v240, a8
    v_accvgpr_read_b32 v241, a9
    v_accvgpr_read_b32 v242, a10
    s_waitcnt lgkmcnt(10)
    v_mfma_f32_32x32x16_bf16 v[16:31], a[160:163], a[92:95], v[16:31]
    ds_read_b64_tr_b16 a[188:189], v251 offset:28672
    ds_read_b64_tr_b16 a[190:191], v251 offset:28928
    s_add_u32 s29, s86, 108544
    buffer_load_dwordx4 v2, s[36:39], s29 offen offset:2048 lds
    v_accvgpr_read_b32 v243, a11
    v_accvgpr_read_b32 v244, a12
    v_accvgpr_read_b32 v245, a13
    v_mfma_f32_32x32x16_bf16 v[16:31], a[164:167], a[96:99], v[16:31]
    ds_read_b64_tr_b16 a[144:145], v251 offset:30720
    ds_read_b64_tr_b16 a[146:147], v251 offset:30976
    v_accvgpr_read_b32 v246, a14
    v_accvgpr_read_b32 v247, a15
    v_cvt_pk_bf16_f32 v240, v240, v241
    s_waitcnt lgkmcnt(10)
    v_mfma_f32_32x32x16_bf16 v[16:31], a[168:171], a[100:103], v[16:31]
    ds_read_b64_tr_b16 a[148:149], v251 offset:32768
    ds_read_b64_tr_b16 a[150:151], v251 offset:33024
    s_add_u32 s29, s86, 125952
    buffer_load_dwordx4 v2, s[36:39], s29 offen offset:3072 lds
    v_cvt_pk_bf16_f32 v241, v242, v243
    v_cvt_pk_bf16_f32 v242, v244, v245
    v_cvt_pk_bf16_f32 v243, v246, v247
    v_mfma_f32_32x32x16_bf16 v[16:31], a[172:175], a[104:107], v[16:31]
    ds_read_b64_tr_b16 a[152:153], v251 offset:34816
    ds_read_b64_tr_b16 a[154:155], v251 offset:35072
    s_add_u32 s26, s22, 0
    buffer_store_dwordx4 v[240:243], v253, s[8:11], s26 offen offset:256 sc1
    v_accvgpr_read_b32 v232, a16
    v_accvgpr_read_b32 v233, a17
    s_waitcnt lgkmcnt(10)
    v_mfma_f32_32x32x16_bf16 v[16:31], a[176:179], a[108:111], v[16:31]
    ds_read_b64_tr_b16 a[156:157], v251 offset:512
    ds_read_b64_tr_b16 a[158:159], v251 offset:768
    s_add_u32 m0, s18, 45056
    s_add_u32 s29, s86, 147456
    buffer_load_dwordx4 v2, s[36:39], s29 offen offset:0 lds
    v_accvgpr_read_b32 v234, a18
    v_accvgpr_read_b32 v235, a19
    v_accvgpr_read_b32 v236, a20
    v_accvgpr_read_b32 v237, a21
    v_mfma_f32_32x32x16_bf16 v[16:31], a[180:183], a[112:115], v[16:31]
    ds_read_b64_tr_b16 a[160:161], v251 offset:2560
    ds_read_b64_tr_b16 a[162:163], v251 offset:2816
    v_accvgpr_read_b32 v238, a22
    v_accvgpr_read_b32 v239, a23
    v_cvt_pk_bf16_f32 v232, v232, v233
    s_waitcnt lgkmcnt(10)
    v_mfma_f32_32x32x16_bf16 v[16:31], a[184:187], a[116:119], v[16:31]
    ds_read_b64_tr_b16 a[164:165], v251 offset:4608
    ds_read_b64_tr_b16 a[166:167], v251 offset:4864
    v_cvt_pk_bf16_f32 v233, v234, v235
    v_cvt_pk_bf16_f32 v234, v236, v237
    v_cvt_pk_bf16_f32 v235, v238, v239
    v_mfma_f32_32x32x16_bf16 v[16:31], a[188:191], a[120:123], v[16:31]
    ds_read_b64_tr_b16 a[168:169], v251 offset:6656
    ds_read_b64_tr_b16 a[170:171], v251 offset:6912
    s_add_u32 s26, s22, 0
    buffer_store_dwordx4 v[232:235], v253, s[8:11], s26 offen offset:512 sc1
    v_accvgpr_read_b32 v240, a24
    v_accvgpr_read_b32 v241, a25
    s_waitcnt lgkmcnt(10)
    v_mfma_f32_32x32x16_bf16 v[16:31], a[144:147], a[124:127], v[16:31]
    ds_read_b64_tr_b16 a[172:173], v251 offset:8704
    ds_read_b64_tr_b16 a[174:175], v251 offset:8960
    v_accvgpr_read_b32 v242, a26
    v_accvgpr_read_b32 v243, a27
    v_accvgpr_read_b32 v244, a28
    v_mfma_f32_32x32x16_bf16 v[16:31], a[148:151], a[128:131], v[16:31]
    ds_read_b64_tr_b16 a[176:177], v251 offset:10752
    ds_read_b64_tr_b16 a[178:179], v251 offset:11008
    v_accvgpr_read_b32 v245, a29
    v_accvgpr_read_b32 v246, a30
    v_accvgpr_read_b32 v247, a31
    v_cvt_pk_bf16_f32 v240, v240, v241
    s_waitcnt lgkmcnt(10)
    v_mfma_f32_32x32x16_bf16 v[16:31], a[152:155], a[132:135], v[16:31]
    ds_read_b64_tr_b16 a[180:181], v251 offset:12800
    ds_read_b64_tr_b16 a[182:183], v251 offset:13056
    v_cvt_pk_bf16_f32 v241, v242, v243
    v_cvt_pk_bf16_f32 v242, v244, v245
    v_cvt_pk_bf16_f32 v243, v246, v247
    v_mfma_f32_32x32x16_bf16 v[32:47], a[156:159], a[64:67], v[32:47]
    ds_read_b64_tr_b16 a[184:185], v251 offset:14848
    ds_read_b64_tr_b16 a[186:187], v251 offset:15104
    s_add_u32 s26, s22, 0
    buffer_store_dwordx4 v[240:243], v253, s[8:11], s26 offen offset:768 sc1
    v_accvgpr_read_b32 v232, a32
    s_waitcnt lgkmcnt(10)
    v_mfma_f32_32x32x16_bf16 v[32:47], a[160:163], a[68:71], v[32:47]
    ds_read_b64_tr_b16 a[188:189], v251 offset:16896
    ds_read_b64_tr_b16 a[190:191], v251 offset:17152
    v_accvgpr_read_b32 v233, a33
    v_accvgpr_read_b32 v234, a34
    v_accvgpr_read_b32 v235, a35
    v_accvgpr_read_b32 v236, a36
    v_mfma_f32_32x32x16_bf16 v[32:47], a[164:167], a[72:75], v[32:47]
    ds_read_b64_tr_b16 a[144:145], v251 offset:18944
    ds_read_b64_tr_b16 a[146:147], v251 offset:19200
    v_cvt_pk_bf16_f32 v16, v16, v17
    v_accvgpr_read_b32 v237, a37
    v_accvgpr_read_b32 v238, a38
    v_accvgpr_read_b32 v239, a39
    s_waitcnt lgkmcnt(10)
    v_mfma_f32_32x32x16_bf16 v[32:47], a[168:171], a[76:79], v[32:47]
    ds_read_b64_tr_b16 a[148:149], v251 offset:20992
    ds_read_b64_tr_b16 a[150:151], v251 offset:21248
    v_cvt_pk_bf16_f32 v17, v18, v19
    v_cvt_pk_bf16_f32 v232, v232, v233
    v_cvt_pk_bf16_f32 v233, v234, v235
    v_cvt_pk_bf16_f32 v234, v236, v237
    v_cvt_pk_bf16_f32 v235, v238, v239
    v_mfma_f32_32x32x16_bf16 v[32:47], a[172:175], a[80:83], v[32:47]
    ds_read_b64_tr_b16 a[152:153], v251 offset:23040
    ds_read_b64_tr_b16 a[154:155], v251 offset:23296
    v_cvt_pk_bf16_f32 v18, v20, v21
    v_cvt_pk_bf16_f32 v19, v22, v23
    s_add_u32 s26, s22, 0
    buffer_store_dwordx4 v[232:235], v253, s[8:11], s26 offen offset:1024 sc1
    v_accvgpr_read_b32 v240, a40
    s_waitcnt lgkmcnt(10)
    v_mfma_f32_32x32x16_bf16 v[32:47], a[176:179], a[84:87], v[32:47]
    ds_read_b64_tr_b16 a[156:157], v251 offset:25088
    ds_read_b64_tr_b16 a[158:159], v251 offset:25344
    v_accvgpr_read_b32 v241, a41
    v_accvgpr_read_b32 v242, a42
    v_accvgpr_read_b32 v243, a43
    v_accvgpr_read_b32 v244, a44
    v_mfma_f32_32x32x16_bf16 v[32:47], a[180:183], a[88:91], v[32:47]
    ds_read_b64_tr_b16 a[160:161], v251 offset:27136
    ds_read_b64_tr_b16 a[162:163], v251 offset:27392
    s_add_u32 s26, s22, 0
    buffer_store_dwordx4 v[16:19], v253, s[8:11], s26 offen offset:2048 sc1
    v_cvt_pk_bf16_f32 v20, v24, v25
    v_accvgpr_read_b32 v245, a45
    v_accvgpr_read_b32 v246, a46
    v_accvgpr_read_b32 v247, a47
    s_waitcnt lgkmcnt(10)
    v_mfma_f32_32x32x16_bf16 v[32:47], a[184:187], a[92:95], v[32:47]
    ds_read_b64_tr_b16 a[164:165], v251 offset:29184
    ds_read_b64_tr_b16 a[166:167], v251 offset:29440
    v_cvt_pk_bf16_f32 v21, v26, v27
    v_cvt_pk_bf16_f32 v240, v240, v241
    v_cvt_pk_bf16_f32 v241, v242, v243
    v_cvt_pk_bf16_f32 v242, v244, v245
    v_mfma_f32_32x32x16_bf16 v[32:47], a[188:191], a[96:99], v[32:47]
    ds_read_b64_tr_b16 a[168:169], v251 offset:31232
    ds_read_b64_tr_b16 a[170:171], v251 offset:31488
    v_cvt_pk_bf16_f32 v22, v28, v29
    v_cvt_pk_bf16_f32 v243, v246, v247
    s_add_u32 s26, s22, 0
    buffer_store_dwordx4 v[240:243], v253, s[8:11], s26 offen offset:1280 sc1
    v_accvgpr_read_b32 v232, a48
    s_waitcnt lgkmcnt(10)
    v_mfma_f32_32x32x16_bf16 v[32:47], a[144:147], a[100:103], v[32:47]
    ds_read_b64_tr_b16 a[172:173], v251 offset:33280
    ds_read_b64_tr_b16 a[174:175], v251 offset:33536
    v_cvt_pk_bf16_f32 v23, v30, v31
    v_accvgpr_read_b32 v233, a49
    v_accvgpr_read_b32 v234, a50
    v_accvgpr_read_b32 v235, a51
    s_waitcnt vmcnt(16)
    s_barrier
    v_mfma_f32_32x32x16_bf16 v[32:47], a[148:151], a[104:107], v[32:47]
    ds_read_b64_tr_b16 a[176:177], v251 offset:35328
    ds_read_b64_tr_b16 a[178:179], v251 offset:35584
    s_add_u32 s26, s22, 0
    buffer_store_dwordx4 v[20:23], v253, s[8:11], s26 offen offset:2304 sc1
    v_accvgpr_read_b32 v236, a52
    v_accvgpr_read_b32 v237, a53
    v_accvgpr_read_b32 v238, a54
    v_accvgpr_read_b32 v239, a55
    s_waitcnt lgkmcnt(10)
    v_mfma_f32_32x32x16_bf16 v[32:47], a[152:155], a[108:111], v[32:47]
    ds_read_b64_tr_b16 a[180:181], v248 offset:0
    ds_read_b64_tr_b16 a[182:183], v248 offset:256
    v_cvt_pk_bf16_f32 v232, v232, v233
    v_cvt_pk_bf16_f32 v233, v234, v235
    v_cvt_pk_bf16_f32 v234, v236, v237
    v_mfma_f32_32x32x16_bf16 v[32:47], a[156:159], a[112:115], v[32:47]
    ds_read_b64_tr_b16 a[184:185], v248 offset:2048
    ds_read_b64_tr_b16 a[186:187], v248 offset:2304
    v_cvt_pk_bf16_f32 v235, v238, v239
    s_add_u32 s26, s22, 0
    buffer_store_dwordx4 v[232:235], v253, s[8:11], s26 offen offset:1536 sc1
    s_waitcnt lgkmcnt(10)
    v_mfma_f32_32x32x16_bf16 v[32:47], a[160:163], a[116:119], v[32:47]
    ds_read_b64_tr_b16 a[188:189], v248 offset:4096
    ds_read_b64_tr_b16 a[190:191], v248 offset:4352
    v_accvgpr_read_b32 v240, a56
    v_accvgpr_read_b32 v241, a57
    v_accvgpr_read_b32 v242, a58
    v_accvgpr_read_b32 v243, a59
    v_mfma_f32_32x32x16_bf16 v[32:47], a[164:167], a[120:123], v[32:47]
    ds_read_b64_tr_b16 a[144:145], v248 offset:6144
    ds_read_b64_tr_b16 a[146:147], v248 offset:6400
    v_accvgpr_read_b32 v244, a60
    v_accvgpr_read_b32 v245, a61
    v_accvgpr_read_b32 v246, a62
    s_waitcnt lgkmcnt(10)
    v_mfma_f32_32x32x16_bf16 v[32:47], a[168:171], a[124:127], v[32:47]
    ds_read_b64_tr_b16 a[148:149], v248 offset:8192
    ds_read_b64_tr_b16 a[150:151], v248 offset:8448
    v_accvgpr_read_b32 v247, a63
    v_cvt_pk_bf16_f32 v240, v240, v241
    v_cvt_pk_bf16_f32 v241, v242, v243
    v_cvt_pk_bf16_f32 v242, v244, v245
    v_mfma_f32_32x32x16_bf16 v[32:47], a[172:175], a[128:131], v[32:47]
    ds_read_b64_tr_b16 a[152:153], v248 offset:10240
    ds_read_b64_tr_b16 a[154:155], v248 offset:10496
    v_cvt_pk_bf16_f32 v243, v246, v247
    s_add_u32 s26, s22, 0
    buffer_store_dwordx4 v[240:243], v253, s[8:11], s26 offen offset:1792 sc1
    s_waitcnt lgkmcnt(10)
    v_mfma_f32_32x32x16_bf16 v[32:47], a[176:179], a[132:135], v[32:47]
    ds_read_b64_tr_b16 a[156:157], v248 offset:12288
    ds_read_b64_tr_b16 a[158:159], v248 offset:12544
    v_mfma_f32_32x32x16_bf16 v[48:63], a[180:183], a[64:67], v[48:63]
    ds_read_b64_tr_b16 a[160:161], v248 offset:14336
    ds_read_b64_tr_b16 a[162:163], v248 offset:14592
    s_waitcnt lgkmcnt(10)
    v_mfma_f32_32x32x16_bf16 v[48:63], a[184:187], a[68:71], v[48:63]
    ds_read_b64_tr_b16 a[164:165], v248 offset:16384
    ds_read_b64_tr_b16 a[166:167], v248 offset:16640
    v_mfma_f32_32x32x16_bf16 v[48:63], a[188:191], a[72:75], v[48:63]
    ds_read_b64_tr_b16 a[168:169], v248 offset:18432
    ds_read_b64_tr_b16 a[170:171], v248 offset:18688
    v_cvt_pk_bf16_f32 v32, v32, v33
    s_waitcnt lgkmcnt(10)
    v_mfma_f32_32x32x16_bf16 v[48:63], a[144:147], a[76:79], v[48:63]
    ds_read_b64_tr_b16 a[172:173], v248 offset:20480
    ds_read_b64_tr_b16 a[174:175], v248 offset:20736
    v_cvt_pk_bf16_f32 v33, v34, v35
    v_mfma_f32_32x32x16_bf16 v[48:63], a[148:151], a[80:83], v[48:63]
    ds_read_b64_tr_b16 a[176:177], v248 offset:22528
    ds_read_b64_tr_b16 a[178:179], v248 offset:22784
    v_cvt_pk_bf16_f32 v34, v36, v37
    v_cvt_pk_bf16_f32 v35, v38, v39
    s_waitcnt lgkmcnt(10)
    v_mfma_f32_32x32x16_bf16 v[48:63], a[152:155], a[84:87], v[48:63]
    ds_read_b64_tr_b16 a[180:181], v248 offset:24576
    ds_read_b64_tr_b16 a[182:183], v248 offset:24832
    v_mfma_f32_32x32x16_bf16 v[48:63], a[156:159], a[88:91], v[48:63]
    ds_read_b64_tr_b16 a[184:185], v248 offset:26624
    ds_read_b64_tr_b16 a[186:187], v248 offset:26880
    s_add_u32 s26, s22, 0
    buffer_store_dwordx4 v[32:35], v253, s[8:11], s26 offen offset:2560 sc1
    v_cvt_pk_bf16_f32 v36, v40, v41
    s_waitcnt lgkmcnt(10)
    v_mfma_f32_32x32x16_bf16 v[48:63], a[160:163], a[92:95], v[48:63]
    ds_read_b64_tr_b16 a[188:189], v248 offset:28672
    ds_read_b64_tr_b16 a[190:191], v248 offset:28928
    v_cvt_pk_bf16_f32 v37, v42, v43
    v_mfma_f32_32x32x16_bf16 v[48:63], a[164:167], a[96:99], v[48:63]
    ds_read_b64_tr_b16 a[144:145], v248 offset:30720
    ds_read_b64_tr_b16 a[146:147], v248 offset:30976
    v_cvt_pk_bf16_f32 v38, v44, v45
    s_waitcnt lgkmcnt(10)
    v_mfma_f32_32x32x16_bf16 v[48:63], a[168:171], a[100:103], v[48:63]
    ds_read_b64_tr_b16 a[148:149], v248 offset:32768
    ds_read_b64_tr_b16 a[150:151], v248 offset:33024
    v_cvt_pk_bf16_f32 v39, v46, v47
    v_mfma_f32_32x32x16_bf16 v[48:63], a[172:175], a[104:107], v[48:63]
    ds_read_b64_tr_b16 a[152:153], v248 offset:34816
    ds_read_b64_tr_b16 a[154:155], v248 offset:35072
    s_add_u32 s26, s22, 0
    buffer_store_dwordx4 v[36:39], v253, s[8:11], s26 offen offset:2816 sc1
    s_waitcnt lgkmcnt(10)
    v_mfma_f32_32x32x16_bf16 v[48:63], a[176:179], a[108:111], v[48:63]
    ds_read_b64_tr_b16 a[156:157], v248 offset:512
    ds_read_b64_tr_b16 a[158:159], v248 offset:768
    v_mfma_f32_32x32x16_bf16 v[48:63], a[180:183], a[112:115], v[48:63]
    ds_read_b64_tr_b16 a[160:161], v248 offset:2560
    ds_read_b64_tr_b16 a[162:163], v248 offset:2816
    s_waitcnt lgkmcnt(10)
    v_mfma_f32_32x32x16_bf16 v[48:63], a[184:187], a[116:119], v[48:63]
    ds_read_b64_tr_b16 a[164:165], v248 offset:4608
    ds_read_b64_tr_b16 a[166:167], v248 offset:4864
    v_mfma_f32_32x32x16_bf16 v[48:63], a[188:191], a[120:123], v[48:63]
    ds_read_b64_tr_b16 a[168:169], v248 offset:6656
    ds_read_b64_tr_b16 a[170:171], v248 offset:6912
    s_waitcnt lgkmcnt(10)
    v_mfma_f32_32x32x16_bf16 v[48:63], a[144:147], a[124:127], v[48:63]
    ds_read_b64_tr_b16 a[172:173], v248 offset:8704
    ds_read_b64_tr_b16 a[174:175], v248 offset:8960
    v_mfma_f32_32x32x16_bf16 v[48:63], a[148:151], a[128:131], v[48:63]
    ds_read_b64_tr_b16 a[176:177], v248 offset:10752
    ds_read_b64_tr_b16 a[178:179], v248 offset:11008
    s_waitcnt lgkmcnt(10)
    v_mfma_f32_32x32x16_bf16 v[48:63], a[152:155], a[132:135], v[48:63]
    ds_read_b64_tr_b16 a[180:181], v248 offset:12800
    ds_read_b64_tr_b16 a[182:183], v248 offset:13056
    v_mfma_f32_32x32x16_bf16 v[64:79], a[156:159], a[64:67], v[64:79]
    ds_read_b64_tr_b16 a[184:185], v248 offset:14848
    ds_read_b64_tr_b16 a[186:187], v248 offset:15104
    s_waitcnt lgkmcnt(10)
    v_mfma_f32_32x32x16_bf16 v[64:79], a[160:163], a[68:71], v[64:79]
    ds_read_b64_tr_b16 a[188:189], v248 offset:16896
    ds_read_b64_tr_b16 a[190:191], v248 offset:17152
    v_mfma_f32_32x32x16_bf16 v[64:79], a[164:167], a[72:75], v[64:79]
    ds_read_b64_tr_b16 a[144:145], v248 offset:18944
    ds_read_b64_tr_b16 a[146:147], v248 offset:19200
    v_cvt_pk_bf16_f32 v48, v48, v49
    s_waitcnt lgkmcnt(10)
    v_mfma_f32_32x32x16_bf16 v[64:79], a[168:171], a[76:79], v[64:79]
    ds_read_b64_tr_b16 a[148:149], v248 offset:20992
    ds_read_b64_tr_b16 a[150:151], v248 offset:21248
    v_cvt_pk_bf16_f32 v49, v50, v51
    v_mfma_f32_32x32x16_bf16 v[64:79], a[172:175], a[80:83], v[64:79]
    ds_read_b64_tr_b16 a[152:153], v248 offset:23040
    ds_read_b64_tr_b16 a[154:155], v248 offset:23296
    v_cvt_pk_bf16_f32 v50, v52, v53
    v_cvt_pk_bf16_f32 v51, v54, v55
    s_waitcnt lgkmcnt(10)
    v_mfma_f32_32x32x16_bf16 v[64:79], a[176:179], a[84:87], v[64:79]
    ds_read_b64_tr_b16 a[156:157], v248 offset:25088
    ds_read_b64_tr_b16 a[158:159], v248 offset:25344
    v_mfma_f32_32x32x16_bf16 v[64:79], a[180:183], a[88:91], v[64:79]
    ds_read_b64_tr_b16 a[160:161], v248 offset:27136
    ds_read_b64_tr_b16 a[162:163], v248 offset:27392
    s_add_u32 s26, s22, 0
    buffer_store_dwordx4 v[48:51], v253, s[8:11], s26 offen offset:3072 sc1
    v_cvt_pk_bf16_f32 v52, v56, v57
    s_waitcnt lgkmcnt(10)
    v_mfma_f32_32x32x16_bf16 v[64:79], a[184:187], a[92:95], v[64:79]
    ds_read_b64_tr_b16 a[164:165], v248 offset:29184
    ds_read_b64_tr_b16 a[166:167], v248 offset:29440
    v_cvt_pk_bf16_f32 v53, v58, v59
    v_mfma_f32_32x32x16_bf16 v[64:79], a[188:191], a[96:99], v[64:79]
    ds_read_b64_tr_b16 a[168:169], v248 offset:31232
    ds_read_b64_tr_b16 a[170:171], v248 offset:31488
    v_cvt_pk_bf16_f32 v54, v60, v61
    s_waitcnt lgkmcnt(10)
    v_mfma_f32_32x32x16_bf16 v[64:79], a[144:147], a[100:103], v[64:79]
    ds_read_b64_tr_b16 a[172:173], v248 offset:33280
    ds_read_b64_tr_b16 a[174:175], v248 offset:33536
    v_cvt_pk_bf16_f32 v55, v62, v63
    s_waitcnt vmcnt(11)
    s_waitcnt vmcnt(1)
    s_barrier
    s_cmp_lg_u32 s3, 0
    s_cbranch_scc1 KM_noE
    v_mov_b32 v101, 1
    s_add_u32 s54, s51, 512
    s_mov_b64 exec, 1
    buffer_store_dword v101, v14, s[8:11], s54 offen sc1
    s_mov_b64 exec, -1
KM_noE:
    v_mfma_f32_32x32x16_bf16 v[64:79], a[148:151], a[104:107], v[64:79]
    ds_read_b64_tr_b16 a[176:177], v248 offset:35328
    ds_read_b64_tr_b16 a[178:179], v248 offset:35584
    s_add_u32 s26, s22, 0
    buffer_store_dwordx4 v[52:55], v253, s[8:11], s26 offen offset:3328 sc1
    s_waitcnt lgkmcnt(10)
    v_mfma_f32_32x32x16_bf16 v[64:79], a[152:155], a[108:111], v[64:79]
    ds_read_b64_tr_b16 a[180:181], v3 offset:0
    ds_read_b64_tr_b16 a[182:183], v3 offset:256
    v_mfma_f32_32x32x16_bf16 v[64:79], a[156:159], a[112:115], v[64:79]
    ds_read_b64_tr_b16 a[184:185], v3 offset:1024
    ds_read_b64_tr_b16 a[186:187], v3 offset:1280
    s_waitcnt lgkmcnt(10)
    v_mfma_f32_32x32x16_bf16 v[64:79], a[160:163], a[116:119], v[64:79]
    ds_read_b64_tr_b16 a[188:189], v3 offset:2048
    ds_read_b64_tr_b16 a[190:191], v3 offset:2304
    v_mfma_f32_32x32x16_bf16 v[64:79], a[164:167], a[120:123], v[64:79]
    ds_read_b64_tr_b16 a[144:145], v3 offset:3072
    ds_read_b64_tr_b16 a[146:147], v3 offset:3328
    s_waitcnt lgkmcnt(10)
    v_mfma_f32_32x32x16_bf16 v[64:79], a[168:171], a[124:127], v[64:79]
    ds_read_b64_tr_b16 a[148:149], v3 offset:4096
    ds_read_b64_tr_b16 a[150:151], v3 offset:4352
    v_mfma_f32_32x32x16_bf16 v[64:79], a[172:175], a[128:131], v[64:79]
    ds_read_b64_tr_b16 a[152:153], v3 offset:5120
    ds_read_b64_tr_b16 a[154:155], v3 offset:5376
    s_waitcnt lgkmcnt(10)
    v_mfma_f32_32x32x16_bf16 v[64:79], a[176:179], a[132:135], v[64:79]
    ds_read_b64_tr_b16 a[156:157], v3 offset:6144
    ds_read_b64_tr_b16 a[158:159], v3 offset:6400
    v_mfma_f32_32x32x16_bf16 v[144:159], a[180:183], v[160:163], 0
    ds_read_b64_tr_b16 a[160:161], v3 offset:7168
    ds_read_b64_tr_b16 a[162:163], v3 offset:7424
    s_waitcnt lgkmcnt(10)
    v_mfma_f32_32x32x16_bf16 v[144:159], a[184:187], v[164:167], v[144:159]
    ds_read_b64_tr_b16 a[164:165], v3 offset:8192
    ds_read_b64_tr_b16 a[166:167], v3 offset:8448
    v_mfma_f32_32x32x16_bf16 v[144:159], a[188:191], v[168:171], v[144:159]
    ds_read_b64_tr_b16 a[168:169], v3 offset:9216
    ds_read_b64_tr_b16 a[170:171], v3 offset:9472
    v_cvt_pk_bf16_f32 v64, v64, v65
    s_waitcnt lgkmcnt(10)
    v_mfma_f32_32x32x16_bf16 v[144:159], a[144:147], v[172:175], v[144:159]
    ds_read_b64_tr_b16 a[172:173], v3 offset:10240
    ds_read_b64_tr_b16 a[174:175], v3 offset:10496
    v_cvt_pk_bf16_f32 v65, v66, v67
    v_mfma_f32_32x32x16_bf16 v[144:159], a[148:151], v[176:179], v[144:159]
    ds_read_b64_tr_b16 a[176:177], v3 offset:11264
    ds_read_b64_tr_b16 a[178:179], v3 offset:11520
    v_cvt_pk_bf16_f32 v66, v68, v69
    v_cvt_pk_bf16_f32 v67, v70, v71
    s_waitcnt lgkmcnt(10)
    v_mfma_f32_32x32x16_bf16 v[144:159], a[152:155], v[180:183], v[144:159]
    ds_read_b64_tr_b16 a[180:181], v3 offset:12288
    ds_read_b64_tr_b16 a[182:183], v3 offset:12544
    v_mfma_f32_32x32x16_bf16 v[144:159], a[156:159], v[184:187], v[144:159]
    ds_read_b64_tr_b16 a[184:185], v3 offset:13312
    ds_read_b64_tr_b16 a[186:187], v3 offset:13568
    s_add_u32 s26, s22, 0
    buffer_store_dwordx4 v[64:67], v253, s[8:11], s26 offen offset:3584 sc1
    v_cvt_pk_bf16_f32 v68, v72, v73
    s_waitcnt lgkmcnt(10)
    v_mfma_f32_32x32x16_bf16 v[144:159], a[160:163], v[188:191], v[144:159]
    ds_read_b64_tr_b16 a[188:189], v3 offset:14336
    ds_read_b64_tr_b16 a[190:191], v3 offset:14592
    v_cvt_pk_bf16_f32 v69, v74, v75
    v_mfma_f32_32x32x16_bf16 v[144:159], a[164:167], v[192:195], v[144:159]
    ds_read_b64_tr_b16 a[144:145], v3 offset:15360
    ds_read_b64_tr_b16 a[146:147], v3 offset:15616
    v_cvt_pk_bf16_f32 v70, v76, v77
    s_waitcnt lgkmcnt(10)
    v_mfma_f32_32x32x16_bf16 v[144:159], a[168:171], v[196:199], v[144:159]
    ds_read_b64_tr_b16 a[148:149], v3 offset:16384
    ds_read_b64_tr_b16 a[150:151], v3 offset:16640
    v_cvt_pk_bf16_f32 v71, v78, v79
    v_mfma_f32_32x32x16_bf16 v[144:159], a[172:175], v[200:203], v[144:159]
    ds_read_b64_tr_b16 a[152:153], v3 offset:17408
    ds_read_b64_tr_b16 a[154:155], v3 offset:17664
    s_add_u32 s26, s22, 0
    buffer_store_dwordx4 v[68:71], v253, s[8:11], s26 offen offset:3840 sc1
    s_waitcnt lgkmcnt(10)
    v_mfma_f32_32x32x16_bf16 v[144:159], a[176:179], v[204:207], v[144:159]
    ds_read_b64_tr_b16 a[156:157], v3 offset:18432
    ds_read_b64_tr_b16 a[158:159], v3 offset:18688
    v_mfma_f32_32x32x16_bf16 v[144:159], a[180:183], v[208:211], v[144:159]
    ds_read_b64_tr_b16 a[160:161], v3 offset:19456
    ds_read_b64_tr_b16 a[162:163], v3 offset:19712
    s_waitcnt lgkmcnt(10)
    v_mfma_f32_32x32x16_bf16 v[144:159], a[184:187], v[212:215], v[144:159]
    ds_read_b64_tr_b16 a[164:165], v3 offset:20480
    ds_read_b64_tr_b16 a[166:167], v3 offset:20736
    v_mfma_f32_32x32x16_bf16 v[144:159], a[188:191], v[216:219], v[144:159]
    ds_read_b64_tr_b16 a[168:169], v3 offset:21504
    ds_read_b64_tr_b16 a[170:171], v3 offset:21760
    s_waitcnt lgkmcnt(10)
    v_mfma_f32_32x32x16_bf16 v[144:159], a[144:147], v[220:223], v[144:159]
    ds_read_b64_tr_b16 a[172:173], v3 offset:22528
    ds_read_b64_tr_b16 a[174:175], v3 offset:22784
    v_mfma_f32_32x32x16_bf16 v[144:159], a[148:151], v[224:227], v[144:159]
    ds_read_b64_tr_b16 a[176:177], v3 offset:23552
    ds_read_b64_tr_b16 a[178:179], v3 offset:23808
    s_waitcnt lgkmcnt(10)
    v_mfma_f32_32x32x16_bf16 v[144:159], a[152:155], v[228:231], v[144:159]
    ds_read_b64_tr_b16 a[180:181], v3 offset:24576
    ds_read_b64_tr_b16 a[182:183], v3 offset:24832
    v_mfma_f32_32x32x16_bf16 v[144:159], a[156:159], a[64:67], v[144:159]
    ds_read_b64_tr_b16 a[184:185], v3 offset:25600
    ds_read_b64_tr_b16 a[186:187], v3 offset:25856
    s_waitcnt lgkmcnt(10)
    v_mfma_f32_32x32x16_bf16 v[144:159], a[160:163], a[68:71], v[144:159]
    ds_read_b64_tr_b16 a[188:189], v3 offset:26624
    ds_read_b64_tr_b16 a[190:191], v3 offset:26880
    v_mfma_f32_32x32x16_bf16 v[144:159], a[164:167], a[72:75], v[144:159]
    ds_read_b64_tr_b16 a[144:145], v3 offset:27648
    ds_read_b64_tr_b16 a[146:147], v3 offset:27904
    s_waitcnt lgkmcnt(10)
    v_mfma_f32_32x32x16_bf16 v[144:159], a[168:171], a[76:79], v[144:159]
    ds_read_b64_tr_b16 a[148:149], v3 offset:28672
    ds_read_b64_tr_b16 a[150:151], v3 offset:28928
    v_mfma_f32_32x32x16_bf16 v[144:159], a[172:175], a[80:83], v[144:159]
    ds_read_b64_tr_b16 a[152:153], v3 offset:29696
    ds_read_b64_tr_b16 a[154:155], v3 offset:29952
    s_waitcnt lgkmcnt(10)
    v_mfma_f32_32x32x16_bf16 v[144:159], a[176:179], a[84:87], v[144:159]
    ds_read_b64_tr_b16 a[156:157], v3 offset:30720
    ds_read_b64_tr_b16 a[158:159], v3 offset:30976
    v_mfma_f32_32x32x16_bf16 v[144:159], a[180:183], a[88:91], v[144:159]
    ds_read_b64_tr_b16 a[160:161], v3 offset:31744
    ds_read_b64_tr_b16 a[162:163], v3 offset:32000
    s_waitcnt lgkmcnt(10)
    v_mfma_f32_32x32x16_bf16 v[144:159], a[184:187], a[92:95], v[144:159]
    ds_read_b64_tr_b16 a[164:165], v3 offset:32768
    ds_read_b64_tr_b16 a[166:167], v3 offset:33024
    v_mfma_f32_32x32x16_bf16 v[144:159], a[188:191], a[96:99], v[144:159]
    ds_read_b64_tr_b16 a[168:169], v3 offset:33792
    ds_read_b64_tr_b16 a[170:171], v3 offset:34048
    s_waitcnt lgkmcnt(10)
    v_mfma_f32_32x32x16_bf16 v[144:159], a[144:147], a[100:103], v[144:159]
    ds_read_b64_tr_b16 a[172:173], v3 offset:34816
    ds_read_b64_tr_b16 a[174:175], v3 offset:35072
    v_mfma_f32_32x32x16_bf16 v[144:159], a[148:151], a[104:107], v[144:159]
    ds_read_b64_tr_b16 a[176:177], v3 offset:35840
    ds_read_b64_tr_b16 a[178:179], v3 offset:36096
    s_waitcnt lgkmcnt(10)
    v_mfma_f32_32x32x16_bf16 v[144:159], a[152:155], a[108:111], v[144:159]
    v_mfma_f32_32x32x16_bf16 v[144:159], a[156:159], a[112:115], v[144:159]
    s_waitcnt lgkmcnt(6)
    v_mfma_f32_32x32x16_bf16 v[144:159], a[160:163], a[116:119], v[144:159]
    v_mfma_f32_32x32x16_bf16 v[144:159], a[164:167], a[120:123], v[144:159]
    s_waitcnt lgkmcnt(2)
    v_mfma_f32_32x32x16_bf16 v[144:159], a[168:171], a[124:127], v[144:159]
    v_mfma_f32_32x32x16_bf16 v[144:159], a[172:175], a[128:131], v[144:159]
    s_waitcnt lgkmcnt(0)
    v_mfma_f32_32x32x16_bf16 v[144:159], a[176:179], a[132:135], v[144:159]
    s_nop 11
    v_cvt_pk_bf16_f32 v144, v144, v145
    v_cvt_pk_bf16_f32 v145, v146, v147
    v_cvt_pk_bf16_f32 v146, v148, v149
    v_cvt_pk_bf16_f32 v147, v150, v151
    s_add_u32 s26, s22, 4096
    buffer_store_dwordx4 v[144:147], v253, s[8:11], s26 offen offset:0 sc1
    v_cvt_pk_bf16_f32 v148, v152, v153
    v_cvt_pk_bf16_f32 v149, v154, v155
    v_cvt_pk_bf16_f32 v150, v156, v157
    v_cvt_pk_bf16_f32 v151, v158, v159
    s_add_u32 s26, s22, 4096
    buffer_store_dwordx4 v[148:151], v253, s[8:11], s26 offen offset:256 sc1
    v_lshlrev_b32 v160, 16, v112
    v_and_b32 v161, 0xffff0000, v112
    v_lshlrev_b32 v180, 16, v102
    v_and_b32 v181, 0xffff0000, v102
    v_lshlrev_b32 v162, 16, v113
    v_and_b32 v163, 0xffff0000, v113
    v_lshlrev_b32 v182, 16, v103
    v_and_b32 v183, 0xffff0000, v103
    v_lshlrev_b32 v164, 16, v114
    v_and_b32 v165, 0xffff0000, v114
    v_lshlrev_b32 v184, 16, v104
    v_and_b32 v185, 0xffff0000, v104
    v_lshlrev_b32 v166, 16, v115
    v_and_b32 v167, 0xffff0000, v115
    v_lshlrev_b32 v186, 16, v105
    v_and_b32 v187, 0xffff0000, v105
    v_lshlrev_b32 v168, 16, v116
    v_and_b32 v169, 0xffff0000, v116
    v_lshlrev_b32 v188, 16, v106
    v_and_b32 v189, 0xffff0000, v106
    v_lshlrev_b32 v170, 16, v117
    v_and_b32 v171, 0xffff0000, v117
    v_lshlrev_b32 v190, 16, v107
    v_and_b32 v191, 0xffff0000, v107
    v_lshlrev_b32 v172, 16, v118
    v_and_b32 v173, 0xffff0000, v118
    v_lshlrev_b32 v192, 16, v108
    v_and_b32 v193, 0xffff0000, v108
    v_lshlrev_b32 v174, 16, v119
    v_and_b32 v175, 0xffff0000, v119
    v_lshlrev_b32 v194, 16, v109
    v_and_b32 v195, 0xffff0000, v109
    v_lshlrev_b32 v176, 16, v120
    v_and_b32 v177, 0xffff0000, v120
    v_lshlrev_b32 v196, 16, v110
    v_and_b32 v197, 0xffff0000, v110
    v_lshlrev_b32 v178, 16, v121
    v_and_b32 v179, 0xffff0000, v121
    v_lshlrev_b32 v198, 16, v111
    v_and_b32 v199, 0xffff0000, v111
    s_mov_b32 s62, -1
    s_mov_b32 s63, 0
    v_mov_b32 v60, 0
    v_mov_b32 v61, 0
    v_lshlrev_b32 v137, 5, v139
    v_add_u32 v137, 156672, v137
    s_lshl_b32 s54, s3, 3
    v_add_u32 v136, s54, v137
    s_lshl_b32 s54, s48, 5
    s_add_u32 s54, s54, s53
    v_add_u32 v135, s54, v139
    v_mul_u32_u24 v135, 1152, v135
    v_add_u32 v135, v135, v138
    s_cmp_eq_u32 s60, 0
    s_cselect_b32 s56, s8, s46
    s_cselect_b32 s57, s9, s47
    s_cselect_b32 s58, s10, 2359296
    s_mov_b32 s59, 0x00020000
    s_cselect_b64 vcc, -1, 0
    s_add_u32 s42, s52, 52690944
    s_cmp_eq_u32 s60, 0
    s_cselect_b32 s42, s42, 0
    s_cselect_b32 s43, 32, 1
    s_lshl_b32 s43, s43, 8
    v_cndmask_b32 v135, v135, v10, vcc
    s_add_u32 s54, s50, 512
    s_cmp_lg_u32 s3, 0
    s_cbranch_scc1 KM_go_e
KM_spin_e:
    buffer_load_dword v100, v11, s[8:11], s54 offen sc1
    s_add_u32 s55, s55, 1
    s_waitcnt vmcnt(0)
    v_cmp_eq_u32 vcc, 0, v100
    s_cbranch_vccz KM_go_e
    s_sleep 6
    s_cmp_lt_u32 s55, 262144
    s_cbranch_scc1 KM_spin_e
KM_go_e:
    s_waitcnt vmcnt(0)
    s_barrier
    s_cmp_lg_u32 s3, 0
    s_cbranch_scc1 KM_nf3
    v_mov_b32 v2, 1
    v_mov_b32 v3, 0
    s_mov_b64 exec, 1
    buffer_store_dword v2, v3, s[8:11], s51 offen sc1
    s_mov_b64 exec, -1
KM_nf3:
    s_mul_i32 s76, s73, 129024
    s_mul_i32 s77, s3, 32256
    s_add_u32 s76, s76, s77
    s_add_u32 s76, s76, 100663296
    s_add_u32 s54, s40, 0
    buffer_load_dwordx4 a[0:3], v9, s[8:11], s54 offen sc1
    s_add_u32 s54, s40, 589824
    buffer_load_dwordx4 a[4:7], v9, s[8:11], s54 offen sc1
    s_add_u32 s54, s40, 1024
    buffer_load_dwordx4 a[8:11], v9, s[8:11], s54 offen sc1
    s_add_u32 s54, s40, 590848
    buffer_load_dwordx4 a[12:15], v9, s[8:11], s54 offen sc1
    s_add_u32 s54, s40, 74752
    buffer_load_dwordx4 a[48:51], v9, s[8:11], s54 offen sc1
    s_add_u32 s54, s40, 664576
    buffer_load_dwordx4 a[52:55], v9, s[8:11], s54 offen sc1
    s_add_u32 s54, s40, 75776
    buffer_load_dwordx4 a[56:59], v9, s[8:11], s54 offen sc1
    s_add_u32 s54, s40, 665600
    buffer_load_dwordx4 a[60:63], v9, s[8:11], s54 offen sc1
    s_add_u32 s54, s40, 2048
    buffer_load_dwordx4 a[16:19], v9, s[8:11], s54 offen sc1
    s_add_u32 s54, s40, 591872
    buffer_load_dwordx4 a[20:23], v9, s[8:11], s54 offen sc1
    s_add_u32 s54, s40, 73728
    buffer_load_dwordx4 a[40:43], v9, s[8:11], s54 offen sc1
    s_add_u32 s54, s40, 663552
    buffer_load_dwordx4 a[44:47], v9, s[8:11], s54 offen sc1
    buffer_load_dword v100, v11, s[8:11], s50 offen sc1
    s_waitcnt vmcnt(12)
    v_mfma_f32_16x16x32_bf16 v[80:83], a[240:243], a[0:3], 0
    s_waitcnt vmcnt(11)
    v_mfma_f32_16x16x32_bf16 v[80:83], a[240:243], a[4:7], v[80:83]
    s_waitcnt vmcnt(10)
    v_mfma_f32_16x16x32_bf16 v[80:83], a[244:247], a[8:11], v[80:83]
    s_waitcnt vmcnt(9)
    v_mfma_f32_16x16x32_bf16 v[80:83], a[244:247], a[12:15], v[80:83]
    s_nop 7
    v_mul_f32 v80, v80, v140
    v_mul_f32 v81, v81, v140
    v_mul_f32 v82, v82, v140
    v_mul_f32 v83, v83, v140
    v_cvt_pk_bf16_f32 v16, v80, v81
    v_cvt_pk_bf16_f32 v17, v82, v83
    v_lshlrev_b32 v80, 16, v16
    v_and_b32 v81, 0xffff0000, v16
    v_lshlrev_b32 v82, 16, v17
    v_and_b32 v83, 0xffff0000, v17
    v_add_f32 v80, v80, v160
    v_add_f32 v81, v81, v161
    v_add_f32 v82, v82, v162
    v_add_f32 v83, v83, v163
    v_cvt_pk_bf16_f32 v16, v80, v81
    v_cvt_pk_bf16_f32 v17, v82, v83
    v_lshlrev_b32 v80, 16, v16
    v_and_b32 v81, 0xffff0000, v16
    v_lshlrev_b32 v82, 16, v17
    v_and_b32 v83, 0xffff0000, v17
    v_add_f32 v80, v80, v180
    v_add_f32 v81, v81, v181
    v_add_f32 v82, v82, v182
    v_add_f32 v83, v83, v183
    v_cvt_pk_bf16_f32 v16, v80, v81
    v_cvt_pk_bf16_f32 v17, v82, v83
    s_mul_i32 s54, s43, 0
    s_add_u32 s54, s54, s42
    s_cmp_eq_u32 s60, 0
    s_cbranch_scc1 KM_o0a
    buffer_store_dwordx2 v[16:17], v135, s[56:59], s54 offen
    s_branch KM_o0b
KM_o0a:
    buffer_store_dwordx2 v[16:17], v135, s[56:59], s54 offen sc1
KM_o0b:
    v_lshlrev_b32 v80, 16, v16
    v_and_b32 v81, 0xffff0000, v16
    v_lshlrev_b32 v82, 16, v17
    v_and_b32 v83, 0xffff0000, v17
    v_sub_f32 v20, v80, v141
    v_sub_f32 v21, v81, v141
    v_sub_f32 v22, v82, v141
    v_sub_f32 v23, v83, v141
    v_add_f32 v60, v60, v20
    v_fmac_f32 v61, v20, v20
    v_add_f32 v60, v60, v21
    v_fmac_f32 v61, v21, v21
    v_add_f32 v60, v60, v22
    v_fmac_f32 v61, v22, v22
    v_add_f32 v60, v60, v23
    v_fmac_f32 v61, v23, v23
    s_waitcnt vmcnt(9)
    v_mfma_f32_16x16x32_bf16 v[92:95], a[240:243], a[48:51], 0
    s_waitcnt vmcnt(8)
    v_mfma_f32_16x16x32_bf16 v[92:95], a[240:243], a[52:55], v[92:95]
    s_waitcnt vmcnt(7)
    v_mfma_f32_16x16x32_bf16 v[92:95], a[244:247], a[56:59], v[92:95]
    s_waitcnt vmcnt(6)
    v_mfma_f32_16x16x32_bf16 v[92:95], a[244:247], a[60:63], v[92:95]
    s_waitcnt vmcnt(5)
    v_mfma_f32_16x16x32_bf16 v[84:87], a[240:243], a[16:19], 0
    s_waitcnt vmcnt(4)
    v_mfma_f32_16x16x32_bf16 v[84:87], a[240:243], a[20:23], v[84:87]
    s_waitcnt vmcnt(3)
    v_mfma_f32_16x16x32_bf16 v[88:91], a[244:247], a[40:43], 0
    s_waitcnt vmcnt(2)
    v_mfma_f32_16x16x32_bf16 v[88:91], a[244:247], a[44:47], v[88:91]
    s_waitcnt vmcnt(1)
    v_cmp_eq_u32 vcc, 0, v100
    s_cbranch_vccnz KM_slowP
KM_backP:
    s_add_u32 s54, s40, 3072
    buffer_load_dwordx4 a[24:27], v9, s[8:11], s54 offen sc1
    s_add_u32 s54, s40, 592896
    buffer_load_dwordx4 a[28:31], v9, s[8:11], s54 offen sc1
    s_add_u32 s54, s92, 4096
    buffer_load_dwordx4 a[32:35], v9, s[8:11], s54 offen sc1
    s_add_u32 s54, s92, 593920
    buffer_load_dwordx4 a[36:39], v9, s[8:11], s54 offen sc1
    s_add_u32 s54, s40, 76800
    buffer_load_dwordx4 a[64:67], v9, s[8:11], s54 offen sc1
    s_add_u32 s54, s40, 666624
    buffer_load_dwordx4 a[68:71], v9, s[8:11], s54 offen sc1
    v_mul_f32 v92, v92, v140
    v_mul_f32 v93, v93, v140
    v_mul_f32 v94, v94, v140
    v_mul_f32 v95, v95, v140
    v_cvt_pk_bf16_f32 v40, v92, v93
    v_cvt_pk_bf16_f32 v41, v94, v95
    v_lshlrev_b32 v92, 16, v40
    v_and_b32 v93, 0xffff0000, v40
    v_lshlrev_b32 v94, 16, v41
    v_and_b32 v95, 0xffff0000, v41
    v_add_f32 v92, v92, v172
    v_add_f32 v93, v93, v173
    v_add_f32 v94, v94, v174
    v_add_f32 v95, v95, v175
    v_cvt_pk_bf16_f32 v40, v92, v93
    v_cvt_pk_bf16_f32 v41, v94, v95
    v_lshlrev_b32 v92, 16, v40
    v_and_b32 v93, 0xffff0000, v40
    v_lshlrev_b32 v94, 16, v41
    v_and_b32 v95, 0xffff0000, v41
    v_add_f32 v92, v92, v192
    v_add_f32 v93, v93, v193
    v_add_f32 v94, v94, v194
    v_add_f32 v95, v95, v195
    v_cvt_pk_bf16_f32 v40, v92, v93
    v_cvt_pk_bf16_f32 v41, v94, v95
    s_mul_i32 s54, s43, 3
    s_add_u32 s54, s54, s42
    s_cmp_eq_u32 s60, 0
    s_cbranch_scc1 KM_o3a
    buffer_store_dwordx2 v[40:41], v135, s[56:59], s54 offen
    s_branch KM_o3b
KM_o3a:
    buffer_store_dwordx2 v[40:41], v135, s[56:59], s54 offen sc1
KM_o3b:
    v_lshlrev_b32 v92, 16, v40
    v_and_b32 v93, 0xffff0000, v40
    v_lshlrev_b32 v94, 16, v41
    v_and_b32 v95, 0xffff0000, v41
    v_sub_f32 v44, v92, v141
    v_sub_f32 v45, v93, v141
    v_sub_f32 v46, v94, v141
    v_sub_f32 v47, v95, v141
    v_add_f32 v60, v60, v44
    v_fmac_f32 v61, v44, v44
    v_add_f32 v60, v60, v45
    v_fmac_f32 v61, v45, v45
    v_add_f32 v60, v60, v46
    v_fmac_f32 v61, v46, v46
    v_add_f32 v60, v60, v47
    v_fmac_f32 v61, v47, v47
    s_waitcnt vmcnt(6)
    v_mfma_f32_16x16x32_bf16 v[84:87], a[244:247], a[24:27], v[84:87]
    s_waitcnt vmcnt(5)
    v_mfma_f32_16x16x32_bf16 v[84:87], a[244:247], a[28:31], v[84:87]
    s_waitcnt vmcnt(4)
    v_mfma_f32_16x16x32_bf16 v[88:91], a[240:243], a[32:35], v[88:91]
    s_waitcnt vmcnt(3)
    v_mfma_f32_16x16x32_bf16 v[88:91], a[240:243], a[36:39], v[88:91]
    s_waitcnt vmcnt(2)
    v_mfma_f32_16x16x32_bf16 v[96:99], a[240:243], a[64:67], 0
    s_waitcnt vmcnt(1)
    v_mfma_f32_16x16x32_bf16 v[96:99], a[240:243], a[68:71], v[96:99]
    v_mul_f32 v84, v84, v140
    v_mul_f32 v85, v85, v140
    v_mul_f32 v86, v86, v140
    v_mul_f32 v87, v87, v140
    v_cvt_pk_bf16_f32 v24, v84, v85
    v_cvt_pk_bf16_f32 v25, v86, v87
    v_lshlrev_b32 v84, 16, v24
    v_and_b32 v85, 0xffff0000, v24
    v_lshlrev_b32 v86, 16, v25
    v_and_b32 v87, 0xffff0000, v25
    v_add_f32 v84, v84, v164
    v_add_f32 v85, v85, v165
    v_add_f32 v86, v86, v166
    v_add_f32 v87, v87, v167
    v_cvt_pk_bf16_f32 v24, v84, v85
    v_cvt_pk_bf16_f32 v25, v86, v87
    v_lshlrev_b32 v84, 16, v24
    v_and_b32 v85, 0xffff0000, v24
    v_lshlrev_b32 v86, 16, v25
    v_and_b32 v87, 0xffff0000, v25
    v_add_f32 v84, v84, v184
    v_add_f32 v85, v85, v185
    v_add_f32 v86, v86, v186
    v_add_f32 v87, v87, v187
    v_cvt_pk_bf16_f32 v24, v84, v85
    v_cvt_pk_bf16_f32 v25, v86, v87
    s_mul_i32 s54, s43, 1
    s_add_u32 s54, s54, s42
    s_cmp_eq_u32 s60, 0
    s_cbranch_scc1 KM_o1a
    buffer_store_dwordx2 v[24:25], v135, s[56:59], s54 offen
    s_branch KM_o1b
KM_o1a:
    buffer_store_dwordx2 v[24:25], v135, s[56:59], s54 offen sc1
KM_o1b:
    v_lshlrev_b32 v84, 16, v24
    v_and_b32 v85, 0xffff0000, v24
    v_lshlrev_b32 v86, 16, v25
    v_and_b32 v87, 0xffff0000, v25
    v_sub_f32 v28, v84, v141
    v_sub_f32 v29, v85, v141
    v_sub_f32 v30, v86, v141
    v_sub_f32 v31, v87, v141
    v_add_f32 v60, v60, v28
    v_fmac_f32 v61, v28, v28
    v_add_f32 v60, v60, v29
    v_fmac_f32 v61, v29, v29
    v_add_f32 v60, v60, v30
    v_fmac_f32 v61, v30, v30
    v_add_f32 v60, v60, v31
    v_fmac_f32 v61, v31, v31
    v_mul_f32 v88, v88, v140
    v_mul_f32 v89, v89, v140
    v_mul_f32 v90, v90, v140
    v_mul_f32 v91, v91, v140
    v_cvt_pk_bf16_f32 v32, v88, v89
    v_cvt_pk_bf16_f32 v33, v90, v91
    v_lshlrev_b32 v88, 16, v32
    v_and_b32 v89, 0xffff0000, v32
    v_lshlrev_b32 v90, 16, v33
    v_and_b32 v91, 0xffff0000, v33
    v_add_f32 v88, v88, v168
    v_add_f32 v89, v89, v169
    v_add_f32 v90, v90, v170
    v_add_f32 v91, v91, v171
    v_cvt_pk_bf16_f32 v32, v88, v89
    v_cvt_pk_bf16_f32 v33, v90, v91
    v_lshlrev_b32 v88, 16, v32
    v_and_b32 v89, 0xffff0000, v32
    v_lshlrev_b32 v90, 16, v33
    v_and_b32 v91, 0xffff0000, v33
    v_add_f32 v88, v88, v188
    v_add_f32 v89, v89, v189
    v_add_f32 v90, v90, v190
    v_add_f32 v91, v91, v191
    v_cvt_pk_bf16_f32 v32, v88, v89
    v_cvt_pk_bf16_f32 v33, v90, v91
    s_mul_i32 s54, s43, 2
    s_add_u32 s54, s54, s42
    s_cmp_eq_u32 s60, 0
    s_cbranch_scc1 KM_o2a
    buffer_store_dwordx2 v[32:33], v135, s[56:59], s54 offen
    s_branch KM_o2b
KM_o2a:
    buffer_store_dwordx2 v[32:33], v135, s[56:59], s54 offen sc1
KM_o2b:
    v_lshlrev_b32 v88, 16, v32
    v_and_b32 v89, 0xffff0000, v32
    v_lshlrev_b32 v90, 16, v33
    v_and_b32 v91, 0xffff0000, v33
    v_sub_f32 v36, v88, v141
    v_sub_f32 v37, v89, v141
    v_sub_f32 v38, v90, v141
    v_sub_f32 v39, v91, v141
    v_add_f32 v60, v60, v36
    v_fmac_f32 v61, v36, v36
    v_add_f32 v60, v60, v37
    v_fmac_f32 v61, v37, v37
    v_add_f32 v60, v60, v38
    v_fmac_f32 v61, v38, v38
    v_add_f32 v60, v60, v39
    v_fmac_f32 v61, v39, v39
    v_mul_f32 v96, v96, v140
    v_mul_f32 v97, v97, v140
    v_mul_f32 v98, v98, v140
    v_mul_f32 v99, v99, v140
    v_cvt_pk_bf16_f32 v48, v96, v97
    v_cvt_pk_bf16_f32 v49, v98, v99
    v_lshlrev_b32 v96, 16, v48
    v_and_b32 v97, 0xffff0000, v48
    v_lshlrev_b32 v98, 16, v49
    v_and_b32 v99, 0xffff0000, v49
    v_add_f32 v96, v96, v176
    v_add_f32 v97, v97, v177
    v_add_f32 v98, v98, v178
    v_add_f32 v99, v99, v179
    v_cvt_pk_bf16_f32 v48, v96, v97
    v_cvt_pk_bf16_f32 v49, v98, v99
    v_lshlrev_b32 v96, 16, v48
    v_and_b32 v97, 0xffff0000, v48
    v_lshlrev_b32 v98, 16, v49
    v_and_b32 v99, 0xffff0000, v49
    v_add_f32 v96, v96, v196
    v_add_f32 v97, v97, v197
    v_add_f32 v98, v98, v198
    v_add_f32 v99, v99, v199
    v_cvt_pk_bf16_f32 v48, v96, v97
    v_cvt_pk_bf16_f32 v49, v98, v99
    s_mov_b64 exec, s[62:63]
    s_mul_i32 s54, s43, 4
    s_add_u32 s54, s54, s42
    s_cmp_eq_u32 s60, 0
    s_cbranch_scc1 KM_o4a
    buffer_store_dwordx2 v[48:49], v135, s[56:59], s54 offen
    s_branch KM_o4b
KM_o4a:
    buffer_store_dwordx2 v[48:49], v135, s[56:59], s54 offen sc1
KM_o4b:
    v_lshlrev_b32 v96, 16, v48
    v_and_b32 v97, 0xffff0000, v48
    v_lshlrev_b32 v98, 16, v49
    v_and_b32 v99, 0xffff0000, v49
    v_sub_f32 v52, v96, v141
    v_sub_f32 v53, v97, v141
    v_sub_f32 v54, v98, v141
    v_sub_f32 v55, v99, v141
    v_add_f32 v60, v60, v52
    v_fmac_f32 v61, v52, v52
    v_add_f32 v60, v60, v53
    v_fmac_f32 v61, v53, v53
    v_add_f32 v60, v60, v54
    v_fmac_f32 v61, v54, v54
    v_add_f32 v60, v60, v55
    v_fmac_f32 v61, v55, v55
    s_mov_b64 exec, -1
    s_cmp_lg_u32 s60, 0
    s_cbranch_scc1 KM_done
    v_add_f32_dpp v60, v60, v60 row_ror:8 row_mask:0xf bank_mask:0xf
    v_add_f32_dpp v61, v61, v61 row_ror:8 row_mask:0xf bank_mask:0xf
    v_mov_b32 v62, v60
    v_mov_b32 v63, v61
    s_nop 0
    v_permlane16_swap_b32 v60, v62
    v_permlane16_swap_b32 v61, v63
    v_add_f32 v60, v60, v62
    v_add_f32 v61, v61, v63
    v_mov_b32 v62, v60
    v_mov_b32 v63, v61
    s_nop 0
    v_permlane32_swap_b32 v60, v62
    v_permlane32_swap_b32 v61, v63
    v_add_f32 v60, v60, v62
    v_add_f32 v61, v61, v63
    ds_write_b64 v136, v[60:61]
    s_waitcnt lgkmcnt(0)
    s_barrier
    ds_read_b128 v[64:67], v137
    ds_read_b128 v[68:71], v137 offset:16
    s_add_u32 s54, s52, 50331648
    s_waitcnt lgkmcnt(0)
    v_add_f32 v60, v64, v66
    v_add_f32 v61, v65, v67
    v_add_f32 v62, v68, v70
    v_add_f32 v63, v69, v71
    v_add_f32 v60, v60, v62
    v_add_f32 v61, v61, v63
    v_mul_f32 v60, 0x3ae38e39, v60
    v_mul_f32 v61, 0x3ae38e39, v61
    v_add_f32 v63, v60, v141
    v_fma_f32 v61, -v60, v60, v61
    v_max_f32 v61, 0, v61
    v_cvt_pk_bf16_f32 v62, v61, v61
    v_lshlrev_b32 v61, 16, v62
    v_add_f32 v61, 0x3727c5ac, v61
    v_cvt_pk_bf16_f32 v62, v61, v61
    v_lshlrev_b32 v61, 16, v62
    v_sqrt_f32 v61, v61
    v_cvt_pk_bf16_f32 v62, v63, v63
    v_lshlrev_b32 v63, 16, v62
    v_cvt_pk_bf16_f32 v62, v61, v61
    v_lshlrev_b32 v61, 16, v62
    v_rcp_f32 v61, v61
    v_sub_f32 v80, v80, v63
    v_sub_f32 v81, v81, v63
    v_sub_f32 v82, v82, v63
    v_sub_f32 v83, v83, v63
    v_cvt_pk_bf16_f32 v18, v80, v81
    v_cvt_pk_bf16_f32 v19, v82, v83
    v_lshlrev_b32 v80, 16, v18
    v_and_b32 v81, 0xffff0000, v18
    v_lshlrev_b32 v82, 16, v19
    v_and_b32 v83, 0xffff0000, v19
    v_mul_f32 v80, v80, v61
    v_mul_f32 v81, v81, v61
    v_mul_f32 v82, v82, v61
    v_mul_f32 v83, v83, v61
    v_cvt_pk_bf16_f32 v18, v80, v81
    v_cvt_pk_bf16_f32 v19, v82, v83
    buffer_store_dwordx2 v[18:19], v10, s[8:11], s54 offen sc1
    s_add_u32 s54, s54, 8192
    v_sub_f32 v84, v84, v63
    v_sub_f32 v85, v85, v63
    v_sub_f32 v86, v86, v63
    v_sub_f32 v87, v87, v63
    v_cvt_pk_bf16_f32 v26, v84, v85
    v_cvt_pk_bf16_f32 v27, v86, v87
    v_lshlrev_b32 v84, 16, v26
    v_and_b32 v85, 0xffff0000, v26
    v_lshlrev_b32 v86, 16, v27
    v_and_b32 v87, 0xffff0000, v27
    v_mul_f32 v84, v84, v61
    v_mul_f32 v85, v85, v61
    v_mul_f32 v86, v86, v61
    v_mul_f32 v87, v87, v61
    v_cvt_pk_bf16_f32 v26, v84, v85
    v_cvt_pk_bf16_f32 v27, v86, v87
    buffer_store_dwordx2 v[26:27], v10, s[8:11], s54 offen sc1
    s_add_u32 s54, s54, 8192
    v_sub_f32 v88, v88, v63
    v_sub_f32 v89, v89, v63
    v_sub_f32 v90, v90, v63
    v_sub_f32 v91, v91, v63
    v_cvt_pk_bf16_f32 v34, v88, v89
    v_cvt_pk_bf16_f32 v35, v90, v91
    v_lshlrev_b32 v88, 16, v34
    v_and_b32 v89, 0xffff0000, v34
    v_lshlrev_b32 v90, 16, v35
    v_and_b32 v91, 0xffff0000, v35
    v_mul_f32 v88, v88, v61
    v_mul_f32 v89, v89, v61
    v_mul_f32 v90, v90, v61
    v_mul_f32 v91, v91, v61
    v_cvt_pk_bf16_f32 v34, v88, v89
    v_cvt_pk_bf16_f32 v35, v90, v91
    buffer_store_dwordx2 v[34:35], v10, s[8:11], s54 offen sc1
    s_add_u32 s54, s54, 8192
    v_sub_f32 v92, v92, v63
    v_sub_f32 v93, v93, v63
    v_sub_f32 v94, v94, v63
    v_sub_f32 v95, v95, v63
    v_cvt_pk_bf16_f32 v42, v92, v93
    v_cvt_pk_bf16_f32 v43, v94, v95
    v_lshlrev_b32 v92, 16, v42
    v_and_b32 v93, 0xffff0000, v42
    v_lshlrev_b32 v94, 16, v43
    v_and_b32 v95, 0xffff0000, v43
    v_mul_f32 v92, v92, v61
    v_mul_f32 v93, v93, v61
    v_mul_f32 v94, v94, v61
    v_mul_f32 v95, v95, v61
    v_cvt_pk_bf16_f32 v42, v92, v93
    v_cvt_pk_bf16_f32 v43, v94, v95
    buffer_store_dwordx2 v[42:43], v10, s[8:11], s54 offen sc1
    s_add_u32 s54, s54, 8192
    v_sub_f32 v96, v96, v63
    v_sub_f32 v97, v97, v63
    v_sub_f32 v98, v98, v63
    v_sub_f32 v99, v99, v63
    v_cvt_pk_bf16_f32 v50, v96, v97
    v_cvt_pk_bf16_f32 v51, v98, v99
    v_lshlrev_b32 v96, 16, v50
    v_and_b32 v97, 0xffff0000, v50
    v_lshlrev_b32 v98, 16, v51
    v_and_b32 v99, 0xffff0000, v51
    v_mul_f32 v96, v96, v61
    v_mul_f32 v97, v97, v61
    v_mul_f32 v98, v98, v61
    v_mul_f32 v99, v99, v61
    v_cvt_pk_bf16_f32 v50, v96, v97
    v_cvt_pk_bf16_f32 v51, v98, v99
    s_mov_b64 exec, s[62:63]
    buffer_store_dwordx2 v[50:51], v10, s[8:11], s54 offen sc1
    s_mov_b64 exec, -1
    s_mov_b32 s60, 50331648
    s_add_u32 s8, s32, 50331648
    s_addc_u32 s9, s33, 0
    s_mov_b32 s10, 67108864
    s_add_u32 s54, s51, 256
    s_waitcnt vmcnt(0)
    s_barrier
    s_cmp_lg_u32 s3, 0
    s_cbranch_scc1 KM_nf4
    v_mov_b32 v2, 1
    v_mov_b32 v3, 0
    s_mov_b64 exec, 1
    buffer_store_dword v2, v3, s[8:11], s54 offen sc1
    s_mov_b64 exec, -1
KM_nf4:
KM_A1:
    s_mul_i32 s76, s73, 129024
    s_mul_i32 s77, s3, 32256
    s_add_u32 s76, s76, s77
    s_add_u32 s76, s76, 100663296
    s_add_u32 m0, s77, 0
    s_add_u32 s19, s76, 0
    buffer_load_dwordx4 v1, s[12:15], s19 offen offset:0 lds
    buffer_load_dwordx4 v1, s[12:15], s19 offen offset:1024 lds
    buffer_load_dwordx4 v1, s[12:15], s19 offen offset:2048 lds
    buffer_load_dwordx4 v1, s[12:15], s19 offen offset:3072 lds
    s_add_u32 m0, s77, 4096
    s_add_u32 s19, s76, 4096
    buffer_load_dwordx4 v1, s[12:15], s19 offen offset:0 lds
    buffer_load_dwordx4 v1, s[12:15], s19 offen offset:1024 lds
    buffer_load_dwordx4 v1, s[12:15], s19 offen offset:2048 lds
    buffer_load_dwordx4 v1, s[12:15], s19 offen offset:3072 lds
    s_add_u32 m0, s77, 8192
    s_add_u32 s19, s76, 8192
    buffer_load_dwordx4 v1, s[12:15], s19 offen offset:0 lds
    buffer_load_dwordx4 v1, s[12:15], s19 offen offset:1024 lds
    buffer_load_dwordx4 v1, s[12:15], s19 offen offset:2048 lds
    buffer_load_dwordx4 v1, s[12:15], s19 offen offset:3072 lds
    s_add_u32 m0, s77, 12288
    s_add_u32 s19, s76, 12288
    buffer_load_dwordx4 v1, s[12:15], s19 offen offset:0 lds
    buffer_load_dwordx4 v1, s[12:15], s19 offen offset:1024 lds
    buffer_load_dwordx4 v1, s[12:15], s19 offen offset:2048 lds
    buffer_load_dwordx4 v1, s[12:15], s19 offen offset:3072 lds
    s_add_u32 m0, s77, 16384
    s_add_u32 s19, s76, 16384
    buffer_load_dwordx4 v1, s[12:15], s19 offen offset:0 lds
    buffer_load_dwordx4 v1, s[12:15], s19 offen offset:1024 lds
    buffer_load_dwordx4 v1, s[12:15], s19 offen offset:2048 lds
    buffer_load_dwordx4 v1, s[12:15], s19 offen offset:3072 lds
    s_add_u32 m0, s77, 20480
    s_add_u32 s19, s76, 20480
    buffer_load_dwordx4 v1, s[12:15], s19 offen offset:0 lds
    buffer_load_dwordx4 v1, s[12:15], s19 offen offset:1024 lds
    buffer_load_dwordx4 v1, s[12:15], s19 offen offset:2048 lds
    buffer_load_dwordx4 v1, s[12:15], s19 offen offset:3072 lds
    s_add_u32 m0, s77, 24576
    s_add_u32 s19, s76, 24576
    buffer_load_dwordx4 v1, s[12:15], s19 offen offset:0 lds
    buffer_load_dwordx4 v1, s[12:15], s19 offen offset:1024 lds
    buffer_load_dwordx4 v1, s[12:15], s19 offen offset:2048 lds
    buffer_load_dwordx4 v1, s[12:15], s19 offen offset:3072 lds
    s_add_u32 m0, s77, 28672
    s_add_u32 s19, s76, 28672
    buffer_load_dwordx4 v1, s[12:15], s19 offen offset:0 lds
    buffer_load_dwordx4 v1, s[12:15], s19 offen offset:1024 lds
    buffer_load_dwordx4 v1, s[12:15], s19 offen offset:2048 lds
    buffer_load_dwordx4 v1, s[12:15], s19 offen offset:2560 lds
KM_A2:
    v_lshrrev_b32 v5, 4, v0
    v_and_b32 v6, 15, v0
    v_lshlrev_b32 v4, 4, v6
    v_lshl_add_u32 v4, v5, 9, v4
    v_add_u32 v7, 65536, v1
    s_add_u32 s76, s3, 2
    s_lshl_b32 s76, s76, 10
    v_add_u32 v8, s76, v1
    v_add_u32 v9, 65536, v8
    s_lshl_b32 s76, s72, 2
    s_add_u32 s77, s76, s3
    s_max_u32 s76, s76, 1
    s_sub_u32 s76, s76, 1
    s_mul_i32 s78, s77, 36864
    s_mul_i32 s79, s76, 36864
    s_add_u32 s79, s79, 256
    s_mul_i32 s77, s72, 4352
    s_max_u32 s76, s72, 1
    s_sub_u32 s76, s76, 1
    s_mul_i32 s76, s76, 4352
    s_add_u32 s76, s76, 56
    v_lshlrev_b32 v10, 2, v6
    v_add_u32 v10, s77, v10
    v_and_b32 v11, 1, v0
    v_lshlrev_b32 v11, 2, v11
    v_add_u32 v11, s76, v11
    v_cmp_gt_u32 vcc, 32, v0
    s_nop 1
    v_cndmask_b32 v10, v11, v10, vcc
    s_mov_b32 s76, 9699584
    v_lshlrev_b32 v12, 3, v5
    s_lshl_b32 s77, s3, 5
    s_add_u32 s77, s77, 16
    v_add_u32 v13, s77, v6
    v_mul_u32_u24 v14, 208, v13
    s_mov_b32 s77, 50462976
    v_bfe_u32 v128, s77, v12, 8
    v_lshl_add_u32 v128, v128, 3, v14
    s_mov_b32 s77, 100992000
    v_bfe_u32 v129, s77, v12, 8
    v_lshl_add_u32 v129, v129, 3, v14
    v_add_u32 v130, 4, v129
    v_lshlrev_b32 v15, 2, v13
    v_add_u32 v15, 32256, v15
    v_add_u32 v2, 576, v15
    v_cmp_eq_u32 vcc, 0, v5
    s_nop 1
    v_cndmask_b32 v129, v129, v15, vcc
    v_cndmask_b32 v130, v130, v2, vcc
    s_mov_b32 s77, 168364039
    v_bfe_u32 v131, s77, v12, 8
    v_lshl_add_u32 v131, v131, 3, v14
    s_mov_b32 s77, 218890251
    v_bfe_u32 v132, s77, v12, 8
    v_lshl_add_u32 v132, v132, 3, v14
    v_add_u32 v133, 4, v132
    v_lshlrev_b32 v15, 3, v13
    v_add_u32 v15, 29952, v15
    v_add_u32 v2, 1152, v15
    v_cmp_eq_u32 vcc, 1, v5
    s_nop 1
    v_cndmask_b32 v132, v132, v15, vcc
    v_cndmask_b32 v133, v133, v2, vcc
    s_mov_b32 s77, 286265102
    v_bfe_u32 v134, s77, v12, 8
    v_lshl_add_u32 v134, v134, 3, v14
    s_mov_b32 s77, 335549202
    v_bfe_u32 v135, s77, v12, 8
    v_lshl_add_u32 v135, v135, 3, v14
    v_add_u32 v136, 4, v135
    v_lshlrev_b32 v15, 3, v13
    v_add_u32 v15, 29956, v15
    v_add_u32 v2, 1152, v15
    v_cmp_eq_u32 vcc, 2, v5
    s_nop 1
    v_cndmask_b32 v135, v135, v15, vcc
    v_cndmask_b32 v136, v136, v2, vcc
    s_mov_b32 s77, 404166165
    v_bfe_u32 v137, s77, v12, 8
    v_lshl_add_u32 v137, v137, 3, v14
    s_lshl_b32 s77, s3, 5
    s_add_u32 s77, s77, 32
    v_add_u32 v13, s77, v6
    v_mul_u32_u24 v14, 208, v13
    s_mov_b32 s77, 50462976
    v_bfe_u32 v138, s77, v12, 8
    v_lshl_add_u32 v138, v138, 3, v14
    s_mov_b32 s77, 100992000
    v_bfe_u32 v139, s77, v12, 8
    v_lshl_add_u32 v139, v139, 3, v14
    v_add_u32 v140, 4, v139
    v_lshlrev_b32 v15, 2, v13
    v_add_u32 v15, 32256, v15
    v_add_u32 v2, 576, v15
    v_cmp_eq_u32 vcc, 0, v5
    s_nop 1
    v_cndmask_b32 v139, v139, v15, vcc
    v_cndmask_b32 v140, v140, v2, vcc
    s_mov_b32 s77, 168364039
    v_bfe_u32 v141, s77, v12, 8
    v_lshl_add_u32 v141, v141, 3, v14
    s_mov_b32 s77, 218890251
    v_bfe_u32 v142, s77, v12, 8
    v_lshl_add_u32 v142, v142, 3, v14
    v_add_u32 v143, 4, v142
    v_lshlrev_b32 v15, 3, v13
    v_add_u32 v15, 29952, v15
    v_add_u32 v2, 1152, v15
    v_cmp_eq_u32 vcc, 1, v5
    s_nop 1
    v_cndmask_b32 v142, v142, v15, vcc
    v_cndmask_b32 v143, v143, v2, vcc
    s_mov_b32 s77, 286265102
    v_bfe_u32 v144, s77, v12, 8
    v_lshl_add_u32 v144, v144, 3, v14
    s_mov_b32 s77, 335549202
    v_bfe_u32 v145, s77, v12, 8
    v_lshl_add_u32 v145, v145, 3, v14
    v_add_u32 v146, 4, v145
    v_lshlrev_b32 v15, 3, v13
    v_add_u32 v15, 29956, v15
    v_add_u32 v2, 1152, v15
    v_cmp_eq_u32 vcc, 2, v5
    s_nop 1
    v_cndmask_b32 v145, v145, v15, vcc
    v_cndmask_b32 v146, v146, v2, vcc
    s_mov_b32 s77, 404166165
    v_bfe_u32 v147, s77, v12, 8
    v_lshl_add_u32 v147, v147, 3, v14
    v_mul_u32_u24 v14, 208, v6
    s_mov_b32 s77, 168364039
    s_cmp_eq_u32 s3, 1
    s_cselect_b32 s77, 218890251, s77
    s_cmp_eq_u32 s3, 2
    s_cselect_b32 s77, 286265102, s77
    s_cmp_eq_u32 s3, 3
    s_cselect_b32 s77, 335549202, s77
    v_bfe_u32 v148, s77, v12, 8
    v_lshl_add_u32 v148, v148, 3, v14
    v_add_u32 v149, 4, v148
    s_lshr_b32 s80, s3, 1
    s_add_u32 s81, s80, 1
    s_bitcmp1_b32 s3, 0
    s_cselect_b32 s81, s81, 9
    s_lshl_b32 s80, s80, 2
    s_add_u32 s80, s80, 29952
    v_lshlrev_b32 v15, 3, v6
    v_add_u32 v15, s80, v15
    v_add_u32 v2, 1152, v15
    v_cmp_eq_u32 vcc, s81, v5
    s_nop 1
    v_cndmask_b32 v148, v148, v15, vcc
    v_cndmask_b32 v149, v149, v2, vcc
    s_mov_b32 s77, 404166165
    v_bfe_u32 v150, s77, v12, 8
    v_lshl_add_u32 v150, v150, 3, v14
    s_cmp_lg_u32 s3, 0
    s_cbranch_scc1 KM_go_xn
KM_spin_xn:
    buffer_load_dword v11, v10, s[8:11], s76 offen sc1
    s_add_u32 s55, s55, 1
    s_waitcnt vmcnt(0)
    v_cmp_eq_u32 vcc, 0, v11
    s_cbranch_vccz KM_go_xn
    s_sleep 6
    s_cmp_lt_u32 s55, 262144
    s_cbranch_scc1 KM_spin_xn
KM_go_xn:
    s_waitcnt vmcnt(0)
    s_barrier
    buffer_load_dwordx4 a[0:3], v4, s[8:11], s78 offen offset:0 sc1
    buffer_load_dwordx4 a[4:7], v4, s[8:11], s78 offen offset:256 sc1
    buffer_load_dwordx4 a[144:147], v4, s[8:11], s79 offen offset:0
    buffer_load_dwordx4 a[8:11], v4, s[8:11], s78 offen offset:2048 sc1
    buffer_load_dwordx4 a[12:15], v4, s[8:11], s78 offen offset:2304 sc1
    buffer_load_dwordx4 a[148:151], v4, s[8:11], s79 offen offset:2048
    s_add_u32 s78, s78, 4096
    s_add_u32 s79, s79, 4096
    buffer_load_dwordx4 a[16:19], v4, s[8:11], s78 offen offset:0 sc1
    buffer_load_dwordx4 a[20:23], v4, s[8:11], s78 offen offset:256 sc1
    buffer_load_dwordx4 a[152:155], v4, s[8:11], s79 offen offset:0
    buffer_load_dwordx4 a[24:27], v4, s[8:11], s78 offen offset:2048 sc1
    buffer_load_dwordx4 a[28:31], v4, s[8:11], s78 offen offset:2304 sc1
    buffer_load_dwordx4 a[156:159], v4, s[8:11], s79 offen offset:2048
    ds_read_b128 v[80:83], v1 offset:0
    ds_read_b128 v[84:87], v1 offset:1024
    ds_read_b128 v[88:91], v1 offset:2048
    ds_read_b128 v[92:95], v1 offset:3072
    ds_read_b128 v[96:99], v1 offset:4096
    ds_read_b128 v[100:103], v1 offset:5120
    ds_read_b128 v[104:107], v1 offset:6144
    ds_read_b128 v[108:111], v8 offset:0
    ds_read_b128 v[112:115], v1 offset:7168
    ds_read_b128 v[116:119], v1 offset:8192
    s_waitcnt vmcnt(9) lgkmcnt(9)
    v_mfma_f32_16x16x32_bf16 v[16:19], v[80:83], a[0:3], 0
    v_mfma_f32_16x16x32_bf16 v[44:47], v[80:83], a[4:7], 0
    ds_read_b128 v[120:123], v1 offset:9216
    s_waitcnt lgkmcnt(9)
    v_mfma_f32_16x16x32_bf16 v[20:23], v[84:87], a[0:3], 0
    v_mfma_f32_16x16x32_bf16 v[48:51], v[84:87], a[4:7], 0
    ds_read_b128 v[124:127], v1 offset:10240
    s_add_u32 s78, s78, 4096
    s_add_u32 s79, s79, 4096
    buffer_load_dwordx4 a[32:35], v4, s[8:11], s78 offen offset:0 sc1
    s_waitcnt lgkmcnt(9)
    v_mfma_f32_16x16x32_bf16 v[24:27], v[88:91], a[0:3], 0
    v_mfma_f32_16x16x32_bf16 v[52:55], v[88:91], a[4:7], 0
    ds_read_b128 v[80:83], v1 offset:11264
    s_waitcnt lgkmcnt(9)
    v_mfma_f32_16x16x32_bf16 v[28:31], v[92:95], a[0:3], 0
    v_mfma_f32_16x16x32_bf16 v[56:59], v[92:95], a[4:7], 0
    ds_read_b128 v[84:87], v1 offset:12288
    buffer_load_dwordx4 a[36:39], v4, s[8:11], s78 offen offset:256 sc1
    s_waitcnt lgkmcnt(9)
    v_mfma_f32_16x16x32_bf16 v[32:35], v[96:99], a[0:3], 0
    v_mfma_f32_16x16x32_bf16 v[60:63], v[96:99], a[4:7], 0
    ds_read_b128 v[88:91], v1 offset:13312
    s_waitcnt lgkmcnt(9)
    v_mfma_f32_16x16x32_bf16 v[36:39], v[100:103], a[0:3], 0
    v_mfma_f32_16x16x32_bf16 v[64:67], v[100:103], a[4:7], 0
    ds_read_b128 v[92:95], v8 offset:7168
    buffer_load_dwordx4 a[160:163], v4, s[8:11], s79 offen offset:0
    s_waitcnt lgkmcnt(9)
    v_mfma_f32_16x16x32_bf16 v[40:43], v[104:107], a[0:3], 0
    v_mfma_f32_16x16x32_bf16 v[68:71], v[104:107], a[4:7], 0
    v_mfma_f32_16x16x32_bf16 v[76:79], v[104:107], a[144:147], 0
    ds_read_b128 v[96:99], v1 offset:14336
    s_waitcnt lgkmcnt(9)
    v_mfma_f32_16x16x32_bf16 v[72:75], v[108:111], a[144:147], 0
    ds_read_b128 v[100:103], v1 offset:15360
    s_waitcnt vmcnt(9) lgkmcnt(9)
    v_mfma_f32_16x16x32_bf16 v[16:19], v[112:115], a[8:11], v[16:19]
    v_mfma_f32_16x16x32_bf16 v[44:47], v[112:115], a[12:15], v[44:47]
    ds_read_b128 v[104:107], v1 offset:16384
    s_waitcnt lgkmcnt(9)
    v_mfma_f32_16x16x32_bf16 v[20:23], v[116:119], a[8:11], v[20:23]
    v_mfma_f32_16x16x32_bf16 v[48:51], v[116:119], a[12:15], v[48:51]
    ds_read_b128 v[108:111], v1 offset:17408
    buffer_load_dwordx4 a[40:43], v4, s[8:11], s78 offen offset:2048 sc1
    s_waitcnt lgkmcnt(9)
    v_mfma_f32_16x16x32_bf16 v[24:27], v[120:123], a[8:11], v[24:27]
    v_mfma_f32_16x16x32_bf16 v[52:55], v[120:123], a[12:15], v[52:55]
    ds_read_b128 v[112:115], v1 offset:18432
    s_waitcnt lgkmcnt(9)
    v_mfma_f32_16x16x32_bf16 v[28:31], v[124:127], a[8:11], v[28:31]
    v_mfma_f32_16x16x32_bf16 v[56:59], v[124:127], a[12:15], v[56:59]
    ds_read_b128 v[116:119], v1 offset:19456
    buffer_load_dwordx4 a[44:47], v4, s[8:11], s78 offen offset:2304 sc1
    s_waitcnt lgkmcnt(9)
    v_mfma_f32_16x16x32_bf16 v[32:35], v[80:83], a[8:11], v[32:35]
    v_mfma_f32_16x16x32_bf16 v[60:63], v[80:83], a[12:15], v[60:63]
    ds_read_b128 v[120:123], v1 offset:20480
    s_waitcnt lgkmcnt(9)
    v_mfma_f32_16x16x32_bf16 v[36:39], v[84:87], a[8:11], v[36:39]
    v_mfma_f32_16x16x32_bf16 v[64:67], v[84:87], a[12:15], v[64:67]
    ds_read_b128 v[124:127], v8 offset:14336
    buffer_load_dwordx4 a[164:167], v4, s[8:11], s79 offen offset:2048
    s_waitcnt lgkmcnt(9)
    v_mfma_f32_16x16x32_bf16 v[40:43], v[88:91], a[8:11], v[40:43]
    v_mfma_f32_16x16x32_bf16 v[68:71], v[88:91], a[12:15], v[68:71]
    v_mfma_f32_16x16x32_bf16 v[76:79], v[88:91], a[148:151], v[76:79]
    ds_read_b128 v[80:83], v1 offset:21504
    s_waitcnt lgkmcnt(9)
    v_mfma_f32_16x16x32_bf16 v[72:75], v[92:95], a[148:151], v[72:75]
    ds_read_b128 v[84:87], v1 offset:22528
    s_waitcnt vmcnt(9) lgkmcnt(9)
    v_mfma_f32_16x16x32_bf16 v[16:19], v[96:99], a[16:19], v[16:19]
    v_mfma_f32_16x16x32_bf16 v[44:47], v[96:99], a[20:23], v[44:47]
    ds_read_b128 v[88:91], v1 offset:23552
    s_waitcnt lgkmcnt(9)
    v_mfma_f32_16x16x32_bf16 v[20:23], v[100:103], a[16:19], v[20:23]
    v_mfma_f32_16x16x32_bf16 v[48:51], v[100:103], a[20:23], v[48:51]
    ds_read_b128 v[92:95], v1 offset:24576
    s_add_u32 s78, s78, 4096
    s_add_u32 s79, s79, 4096
    buffer_load_dwordx4 a[48:51], v4, s[8:11], s78 offen offset:0 sc1
    s_waitcnt lgkmcnt(9)
    v_mfma_f32_16x16x32_bf16 v[24:27], v[104:107], a[16:19], v[24:27]
    v_mfma_f32_16x16x32_bf16 v[52:55], v[104:107], a[20:23], v[52:55]
    ds_read_b128 v[96:99], v1 offset:25600
    s_waitcnt lgkmcnt(9)
    v_mfma_f32_16x16x32_bf16 v[28:31], v[108:111], a[16:19], v[28:31]
    v_mfma_f32_16x16x32_bf16 v[56:59], v[108:111], a[20:23], v[56:59]
    ds_read_b128 v[100:103], v1 offset:26624
    buffer_load_dwordx4 a[52:55], v4, s[8:11], s78 offen offset:256 sc1
    s_waitcnt lgkmcnt(9)
    v_mfma_f32_16x16x32_bf16 v[32:35], v[112:115], a[16:19], v[32:35]
    v_mfma_f32_16x16x32_bf16 v[60:63], v[112:115], a[20:23], v[60:63]
    ds_read_b128 v[104:107], v1 offset:27648
    s_waitcnt lgkmcnt(9)
    v_mfma_f32_16x16x32_bf16 v[36:39], v[116:119], a[16:19], v[36:39]
    v_mfma_f32_16x16x32_bf16 v[64:67], v[116:119], a[20:23], v[64:67]
    ds_read_b128 v[108:111], v8 offset:21504
    buffer_load_dwordx4 a[168:171], v4, s[8:11], s79 offen offset:0
    s_waitcnt lgkmcnt(9)
    v_mfma_f32_16x16x32_bf16 v[40:43], v[120:123], a[16:19], v[40:43]
    v_mfma_f32_16x16x32_bf16 v[68:71], v[120:123], a[20:23], v[68:71]
    v_mfma_f32_16x16x32_bf16 v[76:79], v[120:123], a[152:155], v[76:79]
    ds_read_b128 v[112:115], v1 offset:28672
    s_waitcnt lgkmcnt(9)
    v_mfma_f32_16x16x32_bf16 v[72:75], v[124:127], a[152:155], v[72:75]
    ds_read_b128 v[116:119], v1 offset:29696
    s_waitcnt vmcnt(9) lgkmcnt(9)
    v_mfma_f32_16x16x32_bf16 v[16:19], v[80:83], a[24:27], v[16:19]
    v_mfma_f32_16x16x32_bf16 v[44:47], v[80:83], a[28:31], v[44:47]
    ds_read_b128 v[120:123], v1 offset:30720
    s_waitcnt lgkmcnt(9)
    v_mfma_f32_16x16x32_bf16 v[20:23], v[84:87], a[24:27], v[20:23]
    v_mfma_f32_16x16x32_bf16 v[48:51], v[84:87], a[28:31], v[48:51]
    ds_read_b128 v[124:127], v1 offset:31744
    buffer_load_dwordx4 a[56:59], v4, s[8:11], s78 offen offset:2048 sc1
    s_waitcnt lgkmcnt(9)
    v_mfma_f32_16x16x32_bf16 v[24:27], v[88:91], a[24:27], v[24:27]
    v_mfma_f32_16x16x32_bf16 v[52:55], v[88:91], a[28:31], v[52:55]
    ds_read_b128 v[80:83], v1 offset:32768
    s_waitcnt lgkmcnt(9)
    v_mfma_f32_16x16x32_bf16 v[28:31], v[92:95], a[24:27], v[28:31]
    v_mfma_f32_16x16x32_bf16 v[56:59], v[92:95], a[28:31], v[56:59]
    ds_read_b128 v[84:87], v1 offset:33792
    buffer_load_dwordx4 a[60:63], v4, s[8:11], s78 offen offset:2304 sc1
    s_waitcnt lgkmcnt(9)
    v_mfma_f32_16x16x32_bf16 v[32:35], v[96:99], a[24:27], v[32:35]
    v_mfma_f32_16x16x32_bf16 v[60:63], v[96:99], a[28:31], v[60:63]
    ds_read_b128 v[88:91], v1 offset:34816
    s_waitcnt lgkmcnt(9)
    v_mfma_f32_16x16x32_bf16 v[36:39], v[100:103], a[24:27], v[36:39]
    v_mfma_f32_16x16x32_bf16 v[64:67], v[100:103], a[28:31], v[64:67]
    ds_read_b128 v[92:95], v8 offset:28672
    buffer_load_dwordx4 a[172:175], v4, s[8:11], s79 offen offset:2048
    s_waitcnt lgkmcnt(9)
    v_mfma_f32_16x16x32_bf16 v[40:43], v[104:107], a[24:27], v[40:43]
    v_mfma_f32_16x16x32_bf16 v[68:71], v[104:107], a[28:31], v[68:71]
    v_mfma_f32_16x16x32_bf16 v[76:79], v[104:107], a[156:159], v[76:79]
    ds_read_b128 v[96:99], v1 offset:35840
    s_waitcnt lgkmcnt(9)
    v_mfma_f32_16x16x32_bf16 v[72:75], v[108:111], a[156:159], v[72:75]
    ds_read_b128 v[100:103], v1 offset:36864
    s_waitcnt vmcnt(9) lgkmcnt(9)
    v_mfma_f32_16x16x32_bf16 v[16:19], v[112:115], a[32:35], v[16:19]
    v_mfma_f32_16x16x32_bf16 v[44:47], v[112:115], a[36:39], v[44:47]
    ds_read_b128 v[104:107], v1 offset:37888
    s_waitcnt lgkmcnt(9)
    v_mfma_f32_16x16x32_bf16 v[20:23], v[116:119], a[32:35], v[20:23]
    v_mfma_f32_16x16x32_bf16 v[48:51], v[116:119], a[36:39], v[48:51]
    ds_read_b128 v[108:111], v1 offset:38912
    s_add_u32 s78, s78, 4096
    s_add_u32 s79, s79, 4096
    buffer_load_dwordx4 a[64:67], v4, s[8:11], s78 offen offset:0 sc1
    s_waitcnt lgkmcnt(9)
    v_mfma_f32_16x16x32_bf16 v[24:27], v[120:123], a[32:35], v[24:27]
    v_mfma_f32_16x16x32_bf16 v[52:55], v[120:123], a[36:39], v[52:55]
    ds_read_b128 v[112:115], v1 offset:39936
    s_waitcnt lgkmcnt(9)
    v_mfma_f32_16x16x32_bf16 v[28:31], v[124:127], a[32:35], v[28:31]
    v_mfma_f32_16x16x32_bf16 v[56:59], v[124:127], a[36:39], v[56:59]
    ds_read_b128 v[116:119], v1 offset:40960
    buffer_load_dwordx4 a[68:71], v4, s[8:11], s78 offen offset:256 sc1
    s_waitcnt lgkmcnt(9)
    v_mfma_f32_16x16x32_bf16 v[32:35], v[80:83], a[32:35], v[32:35]
    v_mfma_f32_16x16x32_bf16 v[60:63], v[80:83], a[36:39], v[60:63]
    ds_read_b128 v[120:123], v1 offset:41984
    s_waitcnt lgkmcnt(9)
    v_mfma_f32_16x16x32_bf16 v[36:39], v[84:87], a[32:35], v[36:39]
    v_mfma_f32_16x16x32_bf16 v[64:67], v[84:87], a[36:39], v[64:67]
    ds_read_b128 v[124:127], v8 offset:35840
    buffer_load_dwordx4 a[176:179], v4, s[8:11], s79 offen offset:0
    s_waitcnt lgkmcnt(9)
    v_mfma_f32_16x16x32_bf16 v[40:43], v[88:91], a[32:35], v[40:43]
    v_mfma_f32_16x16x32_bf16 v[68:71], v[88:91], a[36:39], v[68:71]
    v_mfma_f32_16x16x32_bf16 v[76:79], v[88:91], a[160:163], v[76:79]
    ds_read_b128 v[80:83], v1 offset:43008
    s_waitcnt lgkmcnt(9)
    v_mfma_f32_16x16x32_bf16 v[72:75], v[92:95], a[160:163], v[72:75]
    ds_read_b128 v[84:87], v1 offset:44032
    s_waitcnt vmcnt(9) lgkmcnt(9)
    v_mfma_f32_16x16x32_bf16 v[16:19], v[96:99], a[40:43], v[16:19]
    v_mfma_f32_16x16x32_bf16 v[44:47], v[96:99], a[44:47], v[44:47]
    ds_read_b128 v[88:91], v1 offset:45056
    s_waitcnt lgkmcnt(9)
    v_mfma_f32_16x16x32_bf16 v[20:23], v[100:103], a[40:43], v[20:23]
    v_mfma_f32_16x16x32_bf16 v[48:51], v[100:103], a[44:47], v[48:51]
    ds_read_b128 v[92:95], v1 offset:46080
    buffer_load_dwordx4 a[72:75], v4, s[8:11], s78 offen offset:2048 sc1
    s_waitcnt lgkmcnt(9)
    v_mfma_f32_16x16x32_bf16 v[24:27], v[104:107], a[40:43], v[24:27]
    v_mfma_f32_16x16x32_bf16 v[52:55], v[104:107], a[44:47], v[52:55]
    ds_read_b128 v[96:99], v1 offset:47104
    s_waitcnt lgkmcnt(9)
    v_mfma_f32_16x16x32_bf16 v[28:31], v[108:111], a[40:43], v[28:31]
    v_mfma_f32_16x16x32_bf16 v[56:59], v[108:111], a[44:47], v[56:59]
    ds_read_b128 v[100:103], v1 offset:48128
    buffer_load_dwordx4 a[76:79], v4, s[8:11], s78 offen offset:2304 sc1
    s_waitcnt lgkmcnt(9)
    v_mfma_f32_16x16x32_bf16 v[32:35], v[112:115], a[40:43], v[32:35]
    v_mfma_f32_16x16x32_bf16 v[60:63], v[112:115], a[44:47], v[60:63]
    ds_read_b128 v[104:107], v1 offset:49152
    s_waitcnt lgkmcnt(9)
    v_mfma_f32_16x16x32_bf16 v[36:39], v[116:119], a[40:43], v[36:39]
    v_mfma_f32_16x16x32_bf16 v[64:67], v[116:119], a[44:47], v[64:67]
    ds_read_b128 v[108:111], v8 offset:43008
    buffer_load_dwordx4 a[180:183], v4, s[8:11], s79 offen offset:2048
    s_waitcnt lgkmcnt(9)
    v_mfma_f32_16x16x32_bf16 v[40:43], v[120:123], a[40:43], v[40:43]
    v_mfma_f32_16x16x32_bf16 v[68:71], v[120:123], a[44:47], v[68:71]
    v_mfma_f32_16x16x32_bf16 v[76:79], v[120:123], a[164:167], v[76:79]
    ds_read_b128 v[112:115], v1 offset:50176
    s_waitcnt lgkmcnt(9)
    v_mfma_f32_16x16x32_bf16 v[72:75], v[124:127], a[164:167], v[72:75]
    ds_read_b128 v[116:119], v1 offset:51200
    s_waitcnt vmcnt(9) lgkmcnt(9)
    v_mfma_f32_16x16x32_bf16 v[16:19], v[80:83], a[48:51], v[16:19]
    v_mfma_f32_16x16x32_bf16 v[44:47], v[80:83], a[52:55], v[44:47]
    ds_read_b128 v[120:123], v1 offset:52224
    s_waitcnt lgkmcnt(9)
    v_mfma_f32_16x16x32_bf16 v[20:23], v[84:87], a[48:51], v[20:23]
    v_mfma_f32_16x16x32_bf16 v[48:51], v[84:87], a[52:55], v[48:51]
    ds_read_b128 v[124:127], v1 offset:53248
    s_add_u32 s78, s78, 4096
    s_add_u32 s79, s79, 4096
    buffer_load_dwordx4 a[80:83], v4, s[8:11], s78 offen offset:0 sc1
    s_waitcnt lgkmcnt(9)
    v_mfma_f32_16x16x32_bf16 v[24:27], v[88:91], a[48:51], v[24:27]
    v_mfma_f32_16x16x32_bf16 v[52:55], v[88:91], a[52:55], v[52:55]
    ds_read_b128 v[80:83], v1 offset:54272
    s_waitcnt lgkmcnt(9)
    v_mfma_f32_16x16x32_bf16 v[28:31], v[92:95], a[48:51], v[28:31]
    v_mfma_f32_16x16x32_bf16 v[56:59], v[92:95], a[52:55], v[56:59]
    ds_read_b128 v[84:87], v1 offset:55296
    buffer_load_dwordx4 a[84:87], v4, s[8:11], s78 offen offset:256 sc1
    s_waitcnt lgkmcnt(9)
    v_mfma_f32_16x16x32_bf16 v[32:35], v[96:99], a[48:51], v[32:35]
    v_mfma_f32_16x16x32_bf16 v[60:63], v[96:99], a[52:55], v[60:63]
    ds_read_b128 v[88:91], v1 offset:56320
    s_waitcnt lgkmcnt(9)
    v_mfma_f32_16x16x32_bf16 v[36:39], v[100:103], a[48:51], v[36:39]
    v_mfma_f32_16x16x32_bf16 v[64:67], v[100:103], a[52:55], v[64:67]
    ds_read_b128 v[92:95], v8 offset:50176
    buffer_load_dwordx4 a[184:187], v4, s[8:11], s79 offen offset:0
    s_waitcnt lgkmcnt(9)
    v_mfma_f32_16x16x32_bf16 v[40:43], v[104:107], a[48:51], v[40:43]
    v_mfma_f32_16x16x32_bf16 v[68:71], v[104:107], a[52:55], v[68:71]
    v_mfma_f32_16x16x32_bf16 v[76:79], v[104:107], a[168:171], v[76:79]
    ds_read_b128 v[96:99], v1 offset:57344
    s_waitcnt lgkmcnt(9)
    v_mfma_f32_16x16x32_bf16 v[72:75], v[108:111], a[168:171], v[72:75]
    ds_read_b128 v[100:103], v1 offset:58368
    s_waitcnt vmcnt(9) lgkmcnt(9)
    v_mfma_f32_16x16x32_bf16 v[16:19], v[112:115], a[56:59], v[16:19]
    v_mfma_f32_16x16x32_bf16 v[44:47], v[112:115], a[60:63], v[44:47]
    ds_read_b128 v[104:107], v1 offset:59392
    s_waitcnt lgkmcnt(9)
    v_mfma_f32_16x16x32_bf16 v[20:23], v[116:119], a[56:59], v[20:23]
    v_mfma_f32_16x16x32_bf16 v[48:51], v[116:119], a[60:63], v[48:51]
    ds_read_b128 v[108:111], v1 offset:60416
    buffer_load_dwordx4 a[88:91], v4, s[8:11], s78 offen offset:2048 sc1
    s_waitcnt lgkmcnt(9)
    v_mfma_f32_16x16x32_bf16 v[24:27], v[120:123], a[56:59], v[24:27]
    v_mfma_f32_16x16x32_bf16 v[52:55], v[120:123], a[60:63], v[52:55]
    ds_read_b128 v[112:115], v1 offset:61440
    s_waitcnt lgkmcnt(9)
    v_mfma_f32_16x16x32_bf16 v[28:31], v[124:127], a[56:59], v[28:31]
    v_mfma_f32_16x16x32_bf16 v[56:59], v[124:127], a[60:63], v[56:59]
    ds_read_b128 v[116:119], v1 offset:62464
    buffer_load_dwordx4 a[92:95], v4, s[8:11], s78 offen offset:2304 sc1
    s_waitcnt lgkmcnt(9)
    v_mfma_f32_16x16x32_bf16 v[32:35], v[80:83], a[56:59], v[32:35]
    v_mfma_f32_16x16x32_bf16 v[60:63], v[80:83], a[60:63], v[60:63]
    ds_read_b128 v[120:123], v1 offset:63488
    s_waitcnt lgkmcnt(9)
    v_mfma_f32_16x16x32_bf16 v[36:39], v[84:87], a[56:59], v[36:39]
    v_mfma_f32_16x16x32_bf16 v[64:67], v[84:87], a[60:63], v[64:67]
    ds_read_b128 v[124:127], v8 offset:57344
    buffer_load_dwordx4 a[188:191], v4, s[8:11], s79 offen offset:2048
    s_waitcnt lgkmcnt(9)
    v_mfma_f32_16x16x32_bf16 v[40:43], v[88:91], a[56:59], v[40:43]
    v_mfma_f32_16x16x32_bf16 v[68:71], v[88:91], a[60:63], v[68:71]
    v_mfma_f32_16x16x32_bf16 v[76:79], v[88:91], a[172:175], v[76:79]
    ds_read_b128 v[80:83], v1 offset:64512
    s_waitcnt lgkmcnt(9)
    v_mfma_f32_16x16x32_bf16 v[72:75], v[92:95], a[172:175], v[72:75]
    ds_read_b128 v[84:87], v7 offset:0
    s_waitcnt vmcnt(9) lgkmcnt(9)
    v_mfma_f32_16x16x32_bf16 v[16:19], v[96:99], a[64:67], v[16:19]
    v_mfma_f32_16x16x32_bf16 v[44:47], v[96:99], a[68:71], v[44:47]
    ds_read_b128 v[88:91], v7 offset:1024
    s_waitcnt lgkmcnt(9)
    v_mfma_f32_16x16x32_bf16 v[20:23], v[100:103], a[64:67], v[20:23]
    v_mfma_f32_16x16x32_bf16 v[48:51], v[100:103], a[68:71], v[48:51]
    ds_read_b128 v[92:95], v7 offset:2048
    s_add_u32 s78, s78, 4096
    s_add_u32 s79, s79, 4096
    buffer_load_dwordx4 a[96:99], v4, s[8:11], s78 offen offset:0 sc1
    s_waitcnt lgkmcnt(9)
    v_mfma_f32_16x16x32_bf16 v[24:27], v[104:107], a[64:67], v[24:27]
    v_mfma_f32_16x16x32_bf16 v[52:55], v[104:107], a[68:71], v[52:55]
    ds_read_b128 v[96:99], v7 offset:3072
    s_waitcnt lgkmcnt(9)
    v_mfma_f32_16x16x32_bf16 v[28:31], v[108:111], a[64:67], v[28:31]
    v_mfma_f32_16x16x32_bf16 v[56:59], v[108:111], a[68:71], v[56:59]
    ds_read_b128 v[100:103], v7 offset:4096
    buffer_load_dwordx4 a[100:103], v4, s[8:11], s78 offen offset:256 sc1
    s_waitcnt lgkmcnt(9)
    v_mfma_f32_16x16x32_bf16 v[32:35], v[112:115], a[64:67], v[32:35]
    v_mfma_f32_16x16x32_bf16 v[60:63], v[112:115], a[68:71], v[60:63]
    ds_read_b128 v[104:107], v7 offset:5120
    s_waitcnt lgkmcnt(9)
    v_mfma_f32_16x16x32_bf16 v[36:39], v[116:119], a[64:67], v[36:39]
    v_mfma_f32_16x16x32_bf16 v[64:67], v[116:119], a[68:71], v[64:67]
    ds_read_b128 v[108:111], v8 offset:64512
    buffer_load_dwordx4 a[192:195], v4, s[8:11], s79 offen offset:0
    s_waitcnt lgkmcnt(9)
    v_mfma_f32_16x16x32_bf16 v[40:43], v[120:123], a[64:67], v[40:43]
    v_mfma_f32_16x16x32_bf16 v[68:71], v[120:123], a[68:71], v[68:71]
    v_mfma_f32_16x16x32_bf16 v[76:79], v[120:123], a[176:179], v[76:79]
    ds_read_b128 v[112:115], v7 offset:6144
    s_waitcnt lgkmcnt(9)
    v_mfma_f32_16x16x32_bf16 v[72:75], v[124:127], a[176:179], v[72:75]
    ds_read_b128 v[116:119], v7 offset:7168
    s_waitcnt vmcnt(9) lgkmcnt(9)
    v_mfma_f32_16x16x32_bf16 v[16:19], v[80:83], a[72:75], v[16:19]
    v_mfma_f32_16x16x32_bf16 v[44:47], v[80:83], a[76:79], v[44:47]
    ds_read_b128 v[120:123], v7 offset:8192
    s_waitcnt lgkmcnt(9)
    v_mfma_f32_16x16x32_bf16 v[20:23], v[84:87], a[72:75], v[20:23]
    v_mfma_f32_16x16x32_bf16 v[48:51], v[84:87], a[76:79], v[48:51]
    ds_read_b128 v[124:127], v7 offset:9216
    buffer_load_dwordx4 a[104:107], v4, s[8:11], s78 offen offset:2048 sc1
    s_waitcnt lgkmcnt(9)
    v_mfma_f32_16x16x32_bf16 v[24:27], v[88:91], a[72:75], v[24:27]
    v_mfma_f32_16x16x32_bf16 v[52:55], v[88:91], a[76:79], v[52:55]
    ds_read_b128 v[80:83], v7 offset:10240
    s_waitcnt lgkmcnt(9)
    v_mfma_f32_16x16x32_bf16 v[28:31], v[92:95], a[72:75], v[28:31]
    v_mfma_f32_16x16x32_bf16 v[56:59], v[92:95], a[76:79], v[56:59]
    ds_read_b128 v[84:87], v7 offset:11264
    buffer_load_dwordx4 a[108:111], v4, s[8:11], s78 offen offset:2304 sc1
    s_waitcnt lgkmcnt(9)
    v_mfma_f32_16x16x32_bf16 v[32:35], v[96:99], a[72:75], v[32:35]
    v_mfma_f32_16x16x32_bf16 v[60:63], v[96:99], a[76:79], v[60:63]
    ds_read_b128 v[88:91], v7 offset:12288
    s_waitcnt lgkmcnt(9)
    v_mfma_f32_16x16x32_bf16 v[36:39], v[100:103], a[72:75], v[36:39]
    v_mfma_f32_16x16x32_bf16 v[64:67], v[100:103], a[76:79], v[64:67]
    ds_read_b128 v[92:95], v9 offset:6144
    buffer_load_dwordx4 a[196:199], v4, s[8:11], s79 offen offset:2048
    s_waitcnt lgkmcnt(9)
    v_mfma_f32_16x16x32_bf16 v[40:43], v[104:107], a[72:75], v[40:43]
    v_mfma_f32_16x16x32_bf16 v[68:71], v[104:107], a[76:79], v[68:71]
    v_mfma_f32_16x16x32_bf16 v[76:79], v[104:107], a[180:183], v[76:79]
    ds_read_b128 v[96:99], v7 offset:13312
    s_waitcnt lgkmcnt(9)
    v_mfma_f32_16x16x32_bf16 v[72:75], v[108:111], a[180:183], v[72:75]
    ds_read_b128 v[100:103], v7 offset:14336
    s_waitcnt vmcnt(9) lgkmcnt(9)
    v_mfma_f32_16x16x32_bf16 v[16:19], v[112:115], a[80:83], v[16:19]
    v_mfma_f32_16x16x32_bf16 v[44:47], v[112:115], a[84:87], v[44:47]
    ds_read_b128 v[104:107], v7 offset:15360
    s_waitcnt lgkmcnt(9)
    v_mfma_f32_16x16x32_bf16 v[20:23], v[116:119], a[80:83], v[20:23]
    v_mfma_f32_16x16x32_bf16 v[48:51], v[116:119], a[84:87], v[48:51]
    ds_read_b128 v[108:111], v7 offset:16384
    s_add_u32 s78, s78, 4096
    s_add_u32 s79, s79, 4096
    buffer_load_dwordx4 a[112:115], v4, s[8:11], s78 offen offset:0 sc1
    s_waitcnt lgkmcnt(9)
    v_mfma_f32_16x16x32_bf16 v[24:27], v[120:123], a[80:83], v[24:27]
    v_mfma_f32_16x16x32_bf16 v[52:55], v[120:123], a[84:87], v[52:55]
    ds_read_b128 v[112:115], v7 offset:17408
    s_waitcnt lgkmcnt(9)
    v_mfma_f32_16x16x32_bf16 v[28:31], v[124:127], a[80:83], v[28:31]
    v_mfma_f32_16x16x32_bf16 v[56:59], v[124:127], a[84:87], v[56:59]
    ds_read_b128 v[116:119], v7 offset:18432
    buffer_load_dwordx4 a[116:119], v4, s[8:11], s78 offen offset:256 sc1
    s_waitcnt lgkmcnt(9)
    v_mfma_f32_16x16x32_bf16 v[32:35], v[80:83], a[80:83], v[32:35]
    v_mfma_f32_16x16x32_bf16 v[60:63], v[80:83], a[84:87], v[60:63]
    ds_read_b128 v[120:123], v7 offset:19456
    s_waitcnt lgkmcnt(9)
    v_mfma_f32_16x16x32_bf16 v[36:39], v[84:87], a[80:83], v[36:39]
    v_mfma_f32_16x16x32_bf16 v[64:67], v[84:87], a[84:87], v[64:67]
    ds_read_b128 v[124:127], v9 offset:13312
    buffer_load_dwordx4 a[200:203], v4, s[8:11], s79 offen offset:0
    s_waitcnt lgkmcnt(9)
    v_mfma_f32_16x16x32_bf16 v[40:43], v[88:91], a[80:83], v[40:43]
    v_mfma_f32_16x16x32_bf16 v[68:71], v[88:91], a[84:87], v[68:71]
    v_mfma_f32_16x16x32_bf16 v[76:79], v[88:91], a[184:187], v[76:79]
    ds_read_b128 v[80:83], v7 offset:20480
    s_waitcnt lgkmcnt(9)
    v_mfma_f32_16x16x32_bf16 v[72:75], v[92:95], a[184:187], v[72:75]
    ds_read_b128 v[84:87], v7 offset:21504
    s_waitcnt vmcnt(9) lgkmcnt(9)
    v_mfma_f32_16x16x32_bf16 v[16:19], v[96:99], a[88:91], v[16:19]
    v_mfma_f32_16x16x32_bf16 v[44:47], v[96:99], a[92:95], v[44:47]
    ds_read_b128 v[88:91], v7 offset:22528
    s_waitcnt lgkmcnt(9)
    v_mfma_f32_16x16x32_bf16 v[20:23], v[100:103], a[88:91], v[20:23]
    v_mfma_f32_16x16x32_bf16 v[48:51], v[100:103], a[92:95], v[48:51]
    ds_read_b128 v[92:95], v7 offset:23552
    buffer_load_dwordx4 a[120:123], v4, s[8:11], s78 offen offset:2048 sc1
    s_waitcnt lgkmcnt(9)
    v_mfma_f32_16x16x32_bf16 v[24:27], v[104:107], a[88:91], v[24:27]
    v_mfma_f32_16x16x32_bf16 v[52:55], v[104:107], a[92:95], v[52:55]
    ds_read_b128 v[96:99], v7 offset:24576
    s_waitcnt lgkmcnt(9)
    v_mfma_f32_16x16x32_bf16 v[28:31], v[108:111], a[88:91], v[28:31]
    v_mfma_f32_16x16x32_bf16 v[56:59], v[108:111], a[92:95], v[56:59]
    ds_read_b128 v[100:103], v7 offset:25600
    buffer_load_dwordx4 a[124:127], v4, s[8:11], s78 offen offset:2304 sc1
    s_waitcnt lgkmcnt(9)
    v_mfma_f32_16x16x32_bf16 v[32:35], v[112:115], a[88:91], v[32:35]
    v_mfma_f32_16x16x32_bf16 v[60:63], v[112:115], a[92:95], v[60:63]
    ds_read_b128 v[104:107], v7 offset:26624
    s_waitcnt lgkmcnt(9)
    v_mfma_f32_16x16x32_bf16 v[36:39], v[116:119], a[88:91], v[36:39]
    v_mfma_f32_16x16x32_bf16 v[64:67], v[116:119], a[92:95], v[64:67]
    ds_read_b128 v[108:111], v9 offset:20480
    buffer_load_dwordx4 a[204:207], v4, s[8:11], s79 offen offset:2048
    s_waitcnt lgkmcnt(9)
    v_mfma_f32_16x16x32_bf16 v[40:43], v[120:123], a[88:91], v[40:43]
    v_mfma_f32_16x16x32_bf16 v[68:71], v[120:123], a[92:95], v[68:71]
    v_mfma_f32_16x16x32_bf16 v[76:79], v[120:123], a[188:191], v[76:79]
    ds_read_b128 v[112:115], v7 offset:27648
    s_waitcnt lgkmcnt(9)
    v_mfma_f32_16x16x32_bf16 v[72:75], v[124:127], a[188:191], v[72:75]
    ds_read_b128 v[116:119], v7 offset:28672
    s_waitcnt vmcnt(9) lgkmcnt(9)
    v_mfma_f32_16x16x32_bf16 v[16:19], v[80:83], a[96:99], v[16:19]
    v_mfma_f32_16x16x32_bf16 v[44:47], v[80:83], a[100:103], v[44:47]
    ds_read_b128 v[120:123], v7 offset:29696
    s_waitcnt lgkmcnt(9)
    v_mfma_f32_16x16x32_bf16 v[20:23], v[84:87], a[96:99], v[20:23]
    v_mfma_f32_16x16x32_bf16 v[48:51], v[84:87], a[100:103], v[48:51]
    ds_read_b128 v[124:127], v7 offset:30720
    s_add_u32 s78, s78, 4096
    s_add_u32 s79, s79, 4096
    buffer_load_dwordx4 a[128:131], v4, s[8:11], s78 offen offset:0 sc1
    s_waitcnt lgkmcnt(9)
    v_mfma_f32_16x16x32_bf16 v[24:27], v[88:91], a[96:99], v[24:27]
    v_mfma_f32_16x16x32_bf16 v[52:55], v[88:91], a[100:103], v[52:55]
    ds_read_b128 v[80:83], v7 offset:31744
    s_waitcnt lgkmcnt(9)
    v_mfma_f32_16x16x32_bf16 v[28:31], v[92:95], a[96:99], v[28:31]
    v_mfma_f32_16x16x32_bf16 v[56:59], v[92:95], a[100:103], v[56:59]
    ds_read_b128 v[84:87], v7 offset:32768
    buffer_load_dwordx4 a[132:135], v4, s[8:11], s78 offen offset:256 sc1
    s_waitcnt lgkmcnt(9)
    v_mfma_f32_16x16x32_bf16 v[32:35], v[96:99], a[96:99], v[32:35]
    v_mfma_f32_16x16x32_bf16 v[60:63], v[96:99], a[100:103], v[60:63]
    ds_read_b128 v[88:91], v7 offset:33792
    s_waitcnt lgkmcnt(9)
    v_mfma_f32_16x16x32_bf16 v[36:39], v[100:103], a[96:99], v[36:39]
    v_mfma_f32_16x16x32_bf16 v[64:67], v[100:103], a[100:103], v[64:67]
    ds_read_b128 v[92:95], v9 offset:27648
    buffer_load_dwordx4 a[208:211], v4, s[8:11], s79 offen offset:0
    s_waitcnt lgkmcnt(9)
    v_mfma_f32_16x16x32_bf16 v[40:43], v[104:107], a[96:99], v[40:43]
    v_mfma_f32_16x16x32_bf16 v[68:71], v[104:107], a[100:103], v[68:71]
    v_mfma_f32_16x16x32_bf16 v[76:79], v[104:107], a[192:195], v[76:79]
    ds_read_b128 v[96:99], v7 offset:34816
    s_waitcnt lgkmcnt(9)
    v_mfma_f32_16x16x32_bf16 v[72:75], v[108:111], a[192:195], v[72:75]
    ds_read_b128 v[100:103], v7 offset:35840
    s_waitcnt vmcnt(9) lgkmcnt(9)
    v_mfma_f32_16x16x32_bf16 v[16:19], v[112:115], a[104:107], v[16:19]
    v_mfma_f32_16x16x32_bf16 v[44:47], v[112:115], a[108:111], v[44:47]
    ds_read_b128 v[104:107], v7 offset:36864
    s_barrier
    s_waitcnt lgkmcnt(9)
    v_mfma_f32_16x16x32_bf16 v[20:23], v[116:119], a[104:107], v[20:23]
    v_mfma_f32_16x16x32_bf16 v[48:51], v[116:119], a[108:111], v[48:51]
    ds_read_b128 v[108:111], v7 offset:37888
    buffer_load_dwordx4 a[136:139], v4, s[8:11], s78 offen offset:2048 sc1
    s_waitcnt lgkmcnt(9)
    v_mfma_f32_16x16x32_bf16 v[24:27], v[120:123], a[104:107], v[24:27]
    v_mfma_f32_16x16x32_bf16 v[52:55], v[120:123], a[108:111], v[52:55]
    ds_read_b128 v[112:115], v7 offset:38912
    s_waitcnt lgkmcnt(9)
    v_mfma_f32_16x16x32_bf16 v[28:31], v[124:127], a[104:107], v[28:31]
    v_mfma_f32_16x16x32_bf16 v[56:59], v[124:127], a[108:111], v[56:59]
    ds_read_b128 v[116:119], v7 offset:39936
    buffer_load_dwordx4 a[140:143], v4, s[8:11], s78 offen offset:2304 sc1
    s_waitcnt lgkmcnt(9)
    v_mfma_f32_16x16x32_bf16 v[32:35], v[80:83], a[104:107], v[32:35]
    v_mfma_f32_16x16x32_bf16 v[60:63], v[80:83], a[108:111], v[60:63]
    ds_read_b128 v[120:123], v7 offset:40960
    s_waitcnt lgkmcnt(9)
    v_mfma_f32_16x16x32_bf16 v[36:39], v[84:87], a[104:107], v[36:39]
    v_mfma_f32_16x16x32_bf16 v[64:67], v[84:87], a[108:111], v[64:67]
    ds_read_b128 v[124:127], v9 offset:34816
    buffer_load_dwordx4 a[212:215], v4, s[8:11], s79 offen offset:2048
    s_waitcnt lgkmcnt(9)
    v_mfma_f32_16x16x32_bf16 v[40:43], v[88:91], a[104:107], v[40:43]
    v_mfma_f32_16x16x32_bf16 v[68:71], v[88:91], a[108:111], v[68:71]
    v_mfma_f32_16x16x32_bf16 v[76:79], v[88:91], a[196:199], v[76:79]
    ds_read_b128 v[80:83], v7 offset:41984
    s_waitcnt lgkmcnt(9)
    v_mfma_f32_16x16x32_bf16 v[72:75], v[92:95], a[196:199], v[72:75]
    ds_read_b128 v[84:87], v7 offset:43008
    s_waitcnt vmcnt(9) lgkmcnt(9)
    v_mfma_f32_16x16x32_bf16 v[16:19], v[96:99], a[112:115], v[16:19]
    v_mfma_f32_16x16x32_bf16 v[44:47], v[96:99], a[116:119], v[44:47]
    ds_read_b128 v[88:91], v7 offset:44032
    s_waitcnt lgkmcnt(9)
    v_mfma_f32_16x16x32_bf16 v[20:23], v[100:103], a[112:115], v[20:23]
    v_mfma_f32_16x16x32_bf16 v[48:51], v[100:103], a[116:119], v[48:51]
    ds_read_b128 v[92:95], v7 offset:45056
    s_waitcnt lgkmcnt(9)
    v_mfma_f32_16x16x32_bf16 v[24:27], v[104:107], a[112:115], v[24:27]
    v_mfma_f32_16x16x32_bf16 v[52:55], v[104:107], a[116:119], v[52:55]
    ds_read_b128 v[96:99], v7 offset:46080
    s_waitcnt lgkmcnt(9)
    v_mfma_f32_16x16x32_bf16 v[28:31], v[108:111], a[112:115], v[28:31]
    v_mfma_f32_16x16x32_bf16 v[56:59], v[108:111], a[116:119], v[56:59]
    ds_read_b128 v[100:103], v7 offset:47104
    s_waitcnt lgkmcnt(9)
    v_mfma_f32_16x16x32_bf16 v[32:35], v[112:115], a[112:115], v[32:35]
    v_mfma_f32_16x16x32_bf16 v[60:63], v[112:115], a[116:119], v[60:63]
    ds_read_b128 v[104:107], v7 offset:48128
    s_waitcnt lgkmcnt(9)
    v_mfma_f32_16x16x32_bf16 v[36:39], v[116:119], a[112:115], v[36:39]
    v_mfma_f32_16x16x32_bf16 v[64:67], v[116:119], a[116:119], v[64:67]
    ds_read_b128 v[108:111], v9 offset:41984
    s_waitcnt lgkmcnt(9)
    v_mfma_f32_16x16x32_bf16 v[40:43], v[120:123], a[112:115], v[40:43]
    v_mfma_f32_16x16x32_bf16 v[68:71], v[120:123], a[116:119], v[68:71]
    v_mfma_f32_16x16x32_bf16 v[76:79], v[120:123], a[200:203], v[76:79]
    ds_read_b128 v[112:115], v7 offset:49152
    s_waitcnt lgkmcnt(9)
    v_mfma_f32_16x16x32_bf16 v[72:75], v[124:127], a[200:203], v[72:75]
    ds_read_b128 v[116:119], v7 offset:50176
    s_waitcnt vmcnt(6) lgkmcnt(9)
    v_mfma_f32_16x16x32_bf16 v[16:19], v[80:83], a[120:123], v[16:19]
    v_mfma_f32_16x16x32_bf16 v[44:47], v[80:83], a[124:127], v[44:47]
    ds_read_b128 v[120:123], v7 offset:51200
    s_waitcnt lgkmcnt(9)
    v_mfma_f32_16x16x32_bf16 v[20:23], v[84:87], a[120:123], v[20:23]
    v_mfma_f32_16x16x32_bf16 v[48:51], v[84:87], a[124:127], v[48:51]
    ds_read_b128 v[124:127], v7 offset:52224
    s_waitcnt lgkmcnt(9)
    v_mfma_f32_16x16x32_bf16 v[24:27], v[88:91], a[120:123], v[24:27]
    v_mfma_f32_16x16x32_bf16 v[52:55], v[88:91], a[124:127], v[52:55]
    ds_read_b128 v[80:83], v7 offset:53248
    s_waitcnt lgkmcnt(9)
    v_mfma_f32_16x16x32_bf16 v[28:31], v[92:95], a[120:123], v[28:31]
    v_mfma_f32_16x16x32_bf16 v[56:59], v[92:95], a[124:127], v[56:59]
    ds_read_b128 v[84:87], v7 offset:54272
    s_waitcnt lgkmcnt(9)
    v_mfma_f32_16x16x32_bf16 v[32:35], v[96:99], a[120:123], v[32:35]
    v_mfma_f32_16x16x32_bf16 v[60:63], v[96:99], a[124:127], v[60:63]
    ds_read_b128 v[88:91], v7 offset:55296
    s_waitcnt lgkmcnt(9)
    v_mfma_f32_16x16x32_bf16 v[36:39], v[100:103], a[120:123], v[36:39]
    v_mfma_f32_16x16x32_bf16 v[64:67], v[100:103], a[124:127], v[64:67]
    ds_read_b128 v[92:95], v9 offset:49152
    s_waitcnt lgkmcnt(9)
    v_mfma_f32_16x16x32_bf16 v[40:43], v[104:107], a[120:123], v[40:43]
    v_mfma_f32_16x16x32_bf16 v[68:71], v[104:107], a[124:127], v[68:71]
    v_mfma_f32_16x16x32_bf16 v[76:79], v[104:107], a[204:207], v[76:79]
    ds_read_b128 v[96:99], v7 offset:56320
    s_waitcnt lgkmcnt(9)
    v_mfma_f32_16x16x32_bf16 v[72:75], v[108:111], a[204:207], v[72:75]
    ds_read_b128 v[100:103], v7 offset:57344
    s_waitcnt vmcnt(3) lgkmcnt(9)
    v_mfma_f32_16x16x32_bf16 v[16:19], v[112:115], a[128:131], v[16:19]
    v_mfma_f32_16x16x32_bf16 v[44:47], v[112:115], a[132:135], v[44:47]
    ds_read_b128 v[104:107], v7 offset:58368
    s_waitcnt lgkmcnt(9)
    v_mfma_f32_16x16x32_bf16 v[20:23], v[116:119], a[128:131], v[20:23]
    v_mfma_f32_16x16x32_bf16 v[48:51], v[116:119], a[132:135], v[48:51]
    ds_read_b128 v[108:111], v7 offset:59392
    s_waitcnt lgkmcnt(9)
    v_mfma_f32_16x16x32_bf16 v[24:27], v[120:123], a[128:131], v[24:27]
    v_mfma_f32_16x16x32_bf16 v[52:55], v[120:123], a[132:135], v[52:55]
    ds_read_b128 v[112:115], v7 offset:60416
    s_waitcnt lgkmcnt(9)
    v_mfma_f32_16x16x32_bf16 v[28:31], v[124:127], a[128:131], v[28:31]
    v_mfma_f32_16x16x32_bf16 v[56:59], v[124:127], a[132:135], v[56:59]
    ds_read_b128 v[116:119], v7 offset:61440
    s_waitcnt lgkmcnt(9)
    v_mfma_f32_16x16x32_bf16 v[32:35], v[80:83], a[128:131], v[32:35]
    v_mfma_f32_16x16x32_bf16 v[60:63], v[80:83], a[132:135], v[60:63]
    ds_read_b128 v[120:123], v7 offset:62464
    s_waitcnt lgkmcnt(9)
    v_mfma_f32_16x16x32_bf16 v[36:39], v[84:87], a[128:131], v[36:39]
    v_mfma_f32_16x16x32_bf16 v[64:67], v[84:87], a[132:135], v[64:67]
    ds_read_b128 v[124:127], v9 offset:56320
    s_waitcnt lgkmcnt(9)
    v_mfma_f32_16x16x32_bf16 v[40:43], v[88:91], a[128:131], v[40:43]
    v_mfma_f32_16x16x32_bf16 v[68:71], v[88:91], a[132:135], v[68:71]
    v_mfma_f32_16x16x32_bf16 v[76:79], v[88:91], a[208:211], v[76:79]
    s_waitcnt lgkmcnt(8)
    v_mfma_f32_16x16x32_bf16 v[72:75], v[92:95], a[208:211], v[72:75]
    s_waitcnt vmcnt(0) lgkmcnt(7)
    v_mfma_f32_16x16x32_bf16 v[16:19], v[96:99], a[136:139], v[16:19]
    v_mfma_f32_16x16x32_bf16 v[44:47], v[96:99], a[140:143], v[44:47]
    s_waitcnt lgkmcnt(6)
    v_mfma_f32_16x16x32_bf16 v[20:23], v[100:103], a[136:139], v[20:23]
    v_mfma_f32_16x16x32_bf16 v[48:51], v[100:103], a[140:143], v[48:51]
    s_waitcnt lgkmcnt(5)
    v_mfma_f32_16x16x32_bf16 v[24:27], v[104:107], a[136:139], v[24:27]
    v_mfma_f32_16x16x32_bf16 v[52:55], v[104:107], a[140:143], v[52:55]
    s_waitcnt lgkmcnt(4)
    v_mfma_f32_16x16x32_bf16 v[28:31], v[108:111], a[136:139], v[28:31]
    v_mfma_f32_16x16x32_bf16 v[56:59], v[108:111], a[140:143], v[56:59]
    s_waitcnt lgkmcnt(3)
    v_mfma_f32_16x16x32_bf16 v[32:35], v[112:115], a[136:139], v[32:35]
    v_mfma_f32_16x16x32_bf16 v[60:63], v[112:115], a[140:143], v[60:63]
    s_waitcnt lgkmcnt(2)
    v_mfma_f32_16x16x32_bf16 v[36:39], v[116:119], a[136:139], v[36:39]
    v_mfma_f32_16x16x32_bf16 v[64:67], v[116:119], a[140:143], v[64:67]
    s_waitcnt lgkmcnt(1)
    v_mfma_f32_16x16x32_bf16 v[40:43], v[120:123], a[136:139], v[40:43]
    v_mfma_f32_16x16x32_bf16 v[68:71], v[120:123], a[140:143], v[68:71]
    v_mfma_f32_16x16x32_bf16 v[76:79], v[120:123], a[212:215], v[76:79]
    s_waitcnt lgkmcnt(0)
    v_mfma_f32_16x16x32_bf16 v[72:75], v[124:127], a[212:215], v[72:75]
    v_cvt_pk_bf16_f32 v160, v16, v17
    v_cvt_pk_bf16_f32 v161, v18, v19
    ds_write_b64 v128, v[160:161]
    v_cvt_pk_bf16_f32 v162, v20, v21
    v_cvt_pk_bf16_f32 v163, v22, v23
    ds_write_b32 v129, v162
    ds_write_b32 v130, v163
    v_cvt_pk_bf16_f32 v164, v24, v25
    v_cvt_pk_bf16_f32 v165, v26, v27
    ds_write_b64 v131, v[164:165]
    v_cvt_pk_bf16_f32 v166, v28, v29
    v_cvt_pk_bf16_f32 v167, v30, v31
    ds_write_b32 v132, v166
    ds_write_b32 v133, v167
    v_cvt_pk_bf16_f32 v168, v32, v33
    v_cvt_pk_bf16_f32 v169, v34, v35
    ds_write_b64 v134, v[168:169]
    v_cvt_pk_bf16_f32 v170, v36, v37
    v_cvt_pk_bf16_f32 v171, v38, v39
    ds_write_b32 v135, v170
    ds_write_b32 v136, v171
    v_cvt_pk_bf16_f32 v172, v40, v41
    v_cvt_pk_bf16_f32 v173, v42, v43
    ds_write_b64 v137, v[172:173]
    v_cvt_pk_bf16_f32 v174, v44, v45
    v_cvt_pk_bf16_f32 v175, v46, v47
    ds_write_b64 v138, v[174:175]
    v_cvt_pk_bf16_f32 v176, v48, v49
    v_cvt_pk_bf16_f32 v177, v50, v51
    ds_write_b32 v139, v176
    ds_write_b32 v140, v177
    v_cvt_pk_bf16_f32 v178, v52, v53
    v_cvt_pk_bf16_f32 v179, v54, v55
    ds_write_b64 v141, v[178:179]
    v_cvt_pk_bf16_f32 v180, v56, v57
    v_cvt_pk_bf16_f32 v181, v58, v59
    ds_write_b32 v142, v180
    ds_write_b32 v143, v181
    v_cvt_pk_bf16_f32 v182, v60, v61
    v_cvt_pk_bf16_f32 v183, v62, v63
    ds_write_b64 v144, v[182:183]
    v_cvt_pk_bf16_f32 v184, v64, v65
    v_cvt_pk_bf16_f32 v185, v66, v67
    ds_write_b32 v145, v184
    ds_write_b32 v146, v185
    v_cvt_pk_bf16_f32 v186, v68, v69
    v_cvt_pk_bf16_f32 v187, v70, v71
    ds_write_b64 v147, v[186:187]
    v_cvt_pk_bf16_f32 v188, v72, v73
    v_cvt_pk_bf16_f32 v189, v74, v75
    v_cvt_pk_bf16_f32 v190, v76, v77
    v_cvt_pk_bf16_f32 v191, v78, v79
    ds_write_b32 v148, v188
    ds_write_b32 v149, v189
    ds_write_b64 v150, v[190:191]
    s_lshr_b32 s80, s3, 1
    s_and_b32 s81, s3, 1
    s_lshl_b32 s76, s81, 6
    v_add_u32 v15, s76, v0
    v_add_u32 v14, 2, v15
    v_mul_u32_u24 v10, 208, v14
    s_lshl_b32 s76, s80, 5
    v_add_u32 v11, s76, v10
    s_mul_i32 s76, s80, 576
    s_add_u32 s76, s76, 32256
    v_lshlrev_b32 v12, 2, v14
    v_add_u32 v12, s76, v12
    s_mul_i32 s76, s80, 1152
    s_add_u32 s76, s76, 29952
    v_lshlrev_b32 v14, 3, v14
    v_add_u32 v14, s76, v14
    s_lshl_b32 s76, s72, 7
    v_add_u32 v15, s76, v15
    s_waitcnt lgkmcnt(0)
    s_barrier
    ds_read_b128 v[16:19], v11 offset:2912
    ds_read_b128 v[20:23], v11 offset:2928
    ds_read_b128 v[28:31], v11 offset:2976
    ds_read_b128 v[32:35], v11 offset:2992
    ds_read_b128 v[36:39], v11 offset:2560
    ds_read_b128 v[40:43], v11 offset:2576
    ds_read_b128 v[44:47], v11 offset:2144
    ds_read_b128 v[48:51], v11 offset:2160
    ds_read_b128 v[52:55], v11 offset:1728
    ds_read_b128 v[56:59], v11 offset:1744
    ds_read_b128 v[60:63], v11 offset:1312
    ds_read_b128 v[64:67], v11 offset:1328
    ds_read_b128 v[68:71], v11 offset:896
    ds_read_b128 v[72:75], v11 offset:912
    ds_read_b128 v[76:79], v11 offset:480
    ds_read_b128 v[80:83], v11 offset:496
    ds_read_b128 v[84:87], v11 offset:64
    ds_read_b128 v[88:91], v11 offset:80
    ds_read_b32 v24, v12 offset:56
    ds_read_b64 v[92:93], v14 offset:112
    ds_read_b64 v[94:95], v14 offset:96
    ds_read_b64 v[96:97], v14 offset:80
    ds_read_b64 v[98:99], v14 offset:64
    ds_read_b64 v[100:101], v14 offset:48
    ds_read_b64 v[102:103], v14 offset:32
    ds_read_b64 v[104:105], v14 offset:16
    ds_read_b64 v[106:107], v14 offset:0
    s_waitcnt lgkmcnt(15)
    v_dot2_f32_bf16 v172, v16, v28, 0
    v_dot2_f32_bf16 v173, v16, v36, 0
    v_dot2_f32_bf16 v174, v16, v44, 0
    v_dot2_f32_bf16 v175, v16, v52, 0
    s_cmp_eq_u32 s61, 1
    s_cbranch_scc1 KM_Awo1
    s_add_u32 m0, s69, 0
    s_add_u32 s19, s71, 0
    buffer_load_dwordx4 v1, s[12:15], s19 offen offset:0 lds
KM_Awo1:
    v_dot2_f32_bf16 v172, v17, v29, v172
    v_dot2_f32_bf16 v173, v17, v37, v173
    v_dot2_f32_bf16 v174, v17, v45, v174
    v_dot2_f32_bf16 v175, v17, v53, v175
    ds_read_b128 v[108:111], v11 offset:3040
    ds_read_b128 v[112:115], v11 offset:3056
    v_dot2_f32_bf16 v172, v18, v30, v172
    v_dot2_f32_bf16 v173, v18, v38, v173
    v_dot2_f32_bf16 v174, v18, v46, v174
    v_dot2_f32_bf16 v175, v18, v54, v175
    s_cmp_eq_u32 s61, 1
    s_cbranch_scc1 KM_Awo2
    buffer_load_dwordx4 v1, s[12:15], s19 offen offset:1024 lds
    buffer_load_dwordx4 v1, s[12:15], s19 offen offset:2048 lds
KM_Awo2:
    v_dot2_f32_bf16 v172, v19, v31, v172
    v_dot2_f32_bf16 v173, v19, v39, v173
    v_dot2_f32_bf16 v174, v19, v47, v174
    v_dot2_f32_bf16 v175, v19, v55, v175
    ds_read_b128 v[116:119], v11 offset:2624
    ds_read_b128 v[120:123], v11 offset:2640
    v_dot2_f32_bf16 v172, v20, v32, v172
    v_dot2_f32_bf16 v173, v20, v40, v173
    v_dot2_f32_bf16 v174, v20, v48, v174
    v_dot2_f32_bf16 v175, v20, v56, v175
    s_cmp_eq_u32 s61, 1
    s_cbranch_scc1 KM_Awo3
    buffer_load_dwordx4 v1, s[12:15], s19 offen offset:3072 lds
    s_add_u32 m0, s69, 4096
    s_add_u32 s19, s71, 4096
KM_Awo3:
    v_dot2_f32_bf16 v172, v21, v33, v172
    v_dot2_f32_bf16 v173, v21, v41, v173
    v_dot2_f32_bf16 v174, v21, v49, v174
    v_dot2_f32_bf16 v175, v21, v57, v175
    ds_read_b128 v[124:127], v11 offset:2208
    ds_read_b128 v[128:131], v11 offset:2224
    v_dot2_f32_bf16 v172, v22, v34, v172
    v_dot2_f32_bf16 v173, v22, v42, v173
    v_dot2_f32_bf16 v174, v22, v50, v174
    v_dot2_f32_bf16 v175, v22, v58, v175
    s_cmp_eq_u32 s61, 1
    s_cbranch_scc1 KM_Awo4
    buffer_load_dwordx4 v1, s[12:15], s19 offen offset:0 lds
    buffer_load_dwordx4 v1, s[12:15], s19 offen offset:1024 lds
KM_Awo4:
    v_dot2_f32_bf16 v172, v23, v35, v172
    v_dot2_f32_bf16 v173, v23, v43, v173
    v_dot2_f32_bf16 v174, v23, v51, v174
    v_dot2_f32_bf16 v175, v23, v59, v175
    ds_read_b128 v[132:135], v11 offset:1792
    ds_read_b128 v[136:139], v11 offset:1808
    s_waitcnt lgkmcnt(15)
    v_dot2_f32_bf16 v176, v16, v60, 0
    v_dot2_f32_bf16 v177, v16, v68, 0
    v_dot2_f32_bf16 v178, v16, v76, 0
    v_dot2_f32_bf16 v179, v16, v84, 0
    s_cmp_eq_u32 s61, 1
    s_cbranch_scc1 KM_Awo5
    buffer_load_dwordx4 v1, s[12:15], s19 offen offset:2048 lds
    buffer_load_dwordx4 v1, s[12:15], s19 offen offset:3072 lds
KM_Awo5:
    v_dot2_f32_bf16 v176, v17, v61, v176
    v_dot2_f32_bf16 v177, v17, v69, v177
    v_dot2_f32_bf16 v178, v17, v77, v178
    v_dot2_f32_bf16 v179, v17, v85, v179
    ds_read_b128 v[140:143], v11 offset:1376
    ds_read_b128 v[144:147], v11 offset:1392
    v_dot2_f32_bf16 v176, v18, v62, v176
    v_dot2_f32_bf16 v177, v18, v70, v177
    v_dot2_f32_bf16 v178, v18, v78, v178
    v_dot2_f32_bf16 v179, v18, v86, v179
    s_cmp_eq_u32 s61, 1
    s_cbranch_scc1 KM_Awo6
    s_add_u32 m0, s69, 8192
    s_add_u32 s19, s71, 8192
    buffer_load_dwordx4 v1, s[12:15], s19 offen offset:0 lds
KM_Awo6:
    v_dot2_f32_bf16 v176, v19, v63, v176
    v_dot2_f32_bf16 v177, v19, v71, v177
    v_dot2_f32_bf16 v178, v19, v79, v178
    v_dot2_f32_bf16 v179, v19, v87, v179
    ds_read_b128 v[148:151], v11 offset:960
    ds_read_b128 v[152:155], v11 offset:976
    v_dot2_f32_bf16 v176, v20, v64, v176
    v_dot2_f32_bf16 v177, v20, v72, v177
    v_dot2_f32_bf16 v178, v20, v80, v178
    v_dot2_f32_bf16 v179, v20, v88, v179
    s_cmp_eq_u32 s61, 1
    s_cbranch_scc1 KM_Awo7
    buffer_load_dwordx4 v1, s[12:15], s19 offen offset:1024 lds
    buffer_load_dwordx4 v1, s[12:15], s19 offen offset:2048 lds
KM_Awo7:
    v_dot2_f32_bf16 v176, v21, v65, v176
    v_dot2_f32_bf16 v177, v21, v73, v177
    v_dot2_f32_bf16 v178, v21, v81, v178
    v_dot2_f32_bf16 v179, v21, v89, v179
    ds_read_b128 v[156:159], v11 offset:544
    ds_read_b128 v[160:163], v11 offset:560
    v_dot2_f32_bf16 v176, v22, v66, v176
    v_dot2_f32_bf16 v177, v22, v74, v177
    v_dot2_f32_bf16 v178, v22, v82, v178
    v_dot2_f32_bf16 v179, v22, v90, v179
    s_cmp_eq_u32 s61, 1
    s_cbranch_scc1 KM_Awo8
    buffer_load_dwordx4 v1, s[12:15], s19 offen offset:3072 lds
    s_add_u32 m0, s69, 12288
    s_add_u32 s19, s71, 12288
KM_Awo8:
    v_dot2_f32_bf16 v176, v23, v67, v176
    v_dot2_f32_bf16 v177, v23, v75, v177
    v_dot2_f32_bf16 v178, v23, v83, v178
    v_dot2_f32_bf16 v179, v23, v91, v179
    ds_read_b128 v[164:167], v11 offset:128
    ds_read_b128 v[168:171], v11 offset:144
    s_waitcnt lgkmcnt(15)
    v_dot2_f32_bf16 v172, v24, v92, v172
    v_dot2_f32_bf16 v173, v24, v94, v173
    v_dot2_f32_bf16 v174, v24, v96, v174
    v_dot2_f32_bf16 v175, v24, v98, v175
    v_dot2_f32_bf16 v176, v24, v100, v176
    v_dot2_f32_bf16 v177, v24, v102, v177
    v_dot2_f32_bf16 v178, v24, v104, v178
    v_dot2_f32_bf16 v179, v24, v106, v179
    v_mov_b32 v25, 0xf149f2ca
    v_cmp_le_u32 s[84:85], 2, v15
    v_cmp_le_u32 s[86:87], 4, v15
    v_cmp_le_u32 s[88:89], 6, v15
    v_cmp_le_u32 s[90:91], 8, v15
    v_cmp_le_u32 s[92:93], 10, v15
    v_cmp_le_u32 s[94:95], 12, v15
    v_cmp_le_u32 s[96:97], 14, v15
    v_cndmask_b32 v173, v25, v173, s[84:85]
    v_cndmask_b32 v174, v25, v174, s[86:87]
    v_cndmask_b32 v175, v25, v175, s[88:89]
    v_cndmask_b32 v176, v25, v176, s[90:91]
    v_cndmask_b32 v177, v25, v177, s[92:93]
    v_cndmask_b32 v178, v25, v178, s[94:95]
    v_cndmask_b32 v179, v25, v179, s[96:97]
    v_max3_f32 v26, v172, v173, v174
    v_max3_f32 v27, v175, v176, v177
    v_max3_f32 v26, v26, v178, v179
    v_max_f32 v26, v26, v27
    s_mov_b32 s76, 0x3eae1a93
    s_cmp_eq_u32 s61, 1
    s_cbranch_scc1 KM_Awo9
    buffer_load_dwordx4 v1, s[12:15], s19 offen offset:0 lds
    buffer_load_dwordx4 v1, s[12:15], s19 offen offset:1024 lds
    buffer_load_dwordx4 v1, s[12:15], s19 offen offset:2048 lds
KM_Awo9:
    v_sub_f32 v172, v172, v26
    v_sub_f32 v173, v173, v26
    v_sub_f32 v174, v174, v26
    v_sub_f32 v175, v175, v26
    v_sub_f32 v176, v176, v26
    v_sub_f32 v177, v177, v26
    v_sub_f32 v178, v178, v26
    v_sub_f32 v179, v179, v26
    v_mul_f32 v172, s76, v172
    v_mul_f32 v173, s76, v173
    v_mul_f32 v174, s76, v174
    v_mul_f32 v175, s76, v175
    v_mul_f32 v176, s76, v176
    v_mul_f32 v177, s76, v177
    v_mul_f32 v178, s76, v178
    v_mul_f32 v179, s76, v179
    s_cmp_eq_u32 s61, 1
    s_cbranch_scc1 KM_Awo10
    buffer_load_dwordx4 v1, s[12:15], s19 offen offset:3072 lds
    s_add_u32 m0, s69, 16384
    s_add_u32 s19, s71, 16384
    buffer_load_dwordx4 v1, s[12:15], s19 offen offset:0 lds
KM_Awo10:
    v_exp_f32 v172, v172
    v_exp_f32 v173, v173
    v_exp_f32 v174, v174
    v_exp_f32 v175, v175
    v_exp_f32 v176, v176
    v_exp_f32 v177, v177
    v_exp_f32 v178, v178
    v_exp_f32 v179, v179
    s_cmp_eq_u32 s61, 1
    s_cbranch_scc1 KM_Awo11
    buffer_load_dwordx4 v1, s[12:15], s19 offen offset:1024 lds
    buffer_load_dwordx4 v1, s[12:15], s19 offen offset:2048 lds
    buffer_load_dwordx4 v1, s[12:15], s19 offen offset:3072 lds
KM_Awo11:
    v_add_f32 v26, v172, v173
    v_add_f32 v27, v174, v175
    v_add_f32 v25, v176, v177
    v_add_f32 v24, v178, v179
    v_add_f32 v26, v26, v27
    v_add_f32 v25, v25, v24
    v_add_f32 v26, v26, v25
    v_rcp_f32 v26, v26
    s_mov_b32 s76, 0x05040100
    s_mov_b32 s77, 0x07060302
    v_mul_f32 v172, v172, v26
    v_mul_f32 v173, v173, v26
    v_mul_f32 v174, v174, v26
    v_mul_f32 v175, v175, v26
    v_mul_f32 v176, v176, v26
    v_mul_f32 v177, v177, v26
    v_mul_f32 v178, v178, v26
    v_mul_f32 v179, v179, v26
    v_cvt_pk_bf16_f32 v16, v172, v173
    v_cvt_pk_bf16_f32 v17, v174, v175
    v_cvt_pk_bf16_f32 v18, v176, v177
    v_cvt_pk_bf16_f32 v19, v178, v179
    s_waitcnt lgkmcnt(12)
    v_perm_b32 v184, v116, v108, s76
    v_perm_b32 v185, v116, v108, s77
    v_perm_b32 v186, v117, v109, s76
    v_perm_b32 v187, v117, v109, s77
    v_perm_b32 v188, v118, v110, s76
    v_perm_b32 v189, v118, v110, s77
    v_perm_b32 v190, v119, v111, s76
    v_perm_b32 v191, v119, v111, s77
    v_perm_b32 v192, v120, v112, s76
    v_perm_b32 v193, v120, v112, s77
    v_perm_b32 v194, v121, v113, s76
    v_perm_b32 v195, v121, v113, s77
    v_perm_b32 v196, v122, v114, s76
    v_perm_b32 v197, v122, v114, s77
    v_perm_b32 v198, v123, v115, s76
    v_perm_b32 v199, v123, v115, s77
    v_perm_b32 v200, v95, v93, s76
    v_perm_b32 v201, v95, v93, s77
    s_cmp_eq_u32 s61, 1
    s_cbranch_scc1 KM_Awo12
    s_add_u32 m0, s69, 20480
    s_add_u32 s19, s71, 20480
    buffer_load_dwordx4 v1, s[12:15], s19 offen offset:0 lds
    buffer_load_dwordx4 v1, s[12:15], s19 offen offset:1024 lds
KM_Awo12:
    v_dot2_f32_bf16 v28, v184, v16, 0
    v_dot2_f32_bf16 v29, v185, v16, 0
    v_dot2_f32_bf16 v30, v186, v16, 0
    v_dot2_f32_bf16 v31, v187, v16, 0
    v_dot2_f32_bf16 v32, v188, v16, 0
    v_dot2_f32_bf16 v33, v189, v16, 0
    v_dot2_f32_bf16 v34, v190, v16, 0
    v_dot2_f32_bf16 v35, v191, v16, 0
    v_dot2_f32_bf16 v36, v192, v16, 0
    v_dot2_f32_bf16 v37, v193, v16, 0
    v_dot2_f32_bf16 v38, v194, v16, 0
    v_dot2_f32_bf16 v39, v195, v16, 0
    v_dot2_f32_bf16 v40, v196, v16, 0
    v_dot2_f32_bf16 v41, v197, v16, 0
    v_dot2_f32_bf16 v42, v198, v16, 0
    v_dot2_f32_bf16 v43, v199, v16, 0
    v_dot2_f32_bf16 v44, v200, v16, 0
    v_dot2_f32_bf16 v45, v201, v16, 0
    s_waitcnt lgkmcnt(8)
    v_perm_b32 v202, v132, v124, s76
    v_perm_b32 v203, v132, v124, s77
    v_perm_b32 v204, v133, v125, s76
    v_perm_b32 v205, v133, v125, s77
    v_perm_b32 v206, v134, v126, s76
    v_perm_b32 v207, v134, v126, s77
    v_perm_b32 v208, v135, v127, s76
    v_perm_b32 v209, v135, v127, s77
    v_perm_b32 v210, v136, v128, s76
    v_perm_b32 v211, v136, v128, s77
    v_perm_b32 v212, v137, v129, s76
    v_perm_b32 v213, v137, v129, s77
    v_perm_b32 v214, v138, v130, s76
    v_perm_b32 v215, v138, v130, s77
    v_perm_b32 v216, v139, v131, s76
    v_perm_b32 v217, v139, v131, s77
    v_perm_b32 v218, v99, v97, s76
    v_perm_b32 v219, v99, v97, s77
    s_cmp_eq_u32 s61, 1
    s_cbranch_scc1 KM_Awo13
    buffer_load_dwordx4 v1, s[12:15], s19 offen offset:2048 lds
    buffer_load_dwordx4 v1, s[12:15], s19 offen offset:3072 lds
    s_add_u32 m0, s69, 24576
    s_add_u32 s19, s71, 24576
KM_Awo13:
    v_dot2_f32_bf16 v28, v202, v17, v28
    v_dot2_f32_bf16 v29, v203, v17, v29
    v_dot2_f32_bf16 v30, v204, v17, v30
    v_dot2_f32_bf16 v31, v205, v17, v31
    v_dot2_f32_bf16 v32, v206, v17, v32
    v_dot2_f32_bf16 v33, v207, v17, v33
    v_dot2_f32_bf16 v34, v208, v17, v34
    v_dot2_f32_bf16 v35, v209, v17, v35
    v_dot2_f32_bf16 v36, v210, v17, v36
    v_dot2_f32_bf16 v37, v211, v17, v37
    v_dot2_f32_bf16 v38, v212, v17, v38
    v_dot2_f32_bf16 v39, v213, v17, v39
    v_dot2_f32_bf16 v40, v214, v17, v40
    v_dot2_f32_bf16 v41, v215, v17, v41
    v_dot2_f32_bf16 v42, v216, v17, v42
    v_dot2_f32_bf16 v43, v217, v17, v43
    v_dot2_f32_bf16 v44, v218, v17, v44
    v_dot2_f32_bf16 v45, v219, v17, v45
    s_waitcnt lgkmcnt(4)
    v_perm_b32 v184, v148, v140, s76
    v_perm_b32 v185, v148, v140, s77
    v_perm_b32 v186, v149, v141, s76
    v_perm_b32 v187, v149, v141, s77
    v_perm_b32 v188, v150, v142, s76
    v_perm_b32 v189, v150, v142, s77
    v_perm_b32 v190, v151, v143, s76
    v_perm_b32 v191, v151, v143, s77
    v_perm_b32 v192, v152, v144, s76
    v_perm_b32 v193, v152, v144, s77
    v_perm_b32 v194, v153, v145, s76
    v_perm_b32 v195, v153, v145, s77
    v_perm_b32 v196, v154, v146, s76
    v_perm_b32 v197, v154, v146, s77
    v_perm_b32 v198, v155, v147, s76
    v_perm_b32 v199, v155, v147, s77
    v_perm_b32 v200, v103, v101, s76
    v_perm_b32 v201, v103, v101, s77
    s_cmp_eq_u32 s61, 1
    s_cbranch_scc1 KM_Awo14
    buffer_load_dwordx4 v1, s[12:15], s19 offen offset:0 lds
    buffer_load_dwordx4 v1, s[12:15], s19 offen offset:1024 lds
    buffer_load_dwordx4 v1, s[12:15], s19 offen offset:2048 lds
KM_Awo14:
    v_dot2_f32_bf16 v28, v184, v18, v28
    v_dot2_f32_bf16 v29, v185, v18, v29
    v_dot2_f32_bf16 v30, v186, v18, v30
    v_dot2_f32_bf16 v31, v187, v18, v31
    v_dot2_f32_bf16 v32, v188, v18, v32
    v_dot2_f32_bf16 v33, v189, v18, v33
    v_dot2_f32_bf16 v34, v190, v18, v34
    v_dot2_f32_bf16 v35, v191, v18, v35
    v_dot2_f32_bf16 v36, v192, v18, v36
    v_dot2_f32_bf16 v37, v193, v18, v37
    v_dot2_f32_bf16 v38, v194, v18, v38
    v_dot2_f32_bf16 v39, v195, v18, v39
    v_dot2_f32_bf16 v40, v196, v18, v40
    v_dot2_f32_bf16 v41, v197, v18, v41
    v_dot2_f32_bf16 v42, v198, v18, v42
    v_dot2_f32_bf16 v43, v199, v18, v43
    v_dot2_f32_bf16 v44, v200, v18, v44
    v_dot2_f32_bf16 v45, v201, v18, v45
    s_waitcnt lgkmcnt(0)
    v_perm_b32 v202, v164, v156, s76
    v_perm_b32 v203, v164, v156, s77
    v_perm_b32 v204, v165, v157, s76
    v_perm_b32 v205, v165, v157, s77
    v_perm_b32 v206, v166, v158, s76
    v_perm_b32 v207, v166, v158, s77
    v_perm_b32 v208, v167, v159, s76
    v_perm_b32 v209, v167, v159, s77
    v_perm_b32 v210, v168, v160, s76
    v_perm_b32 v211, v168, v160, s77
    v_perm_b32 v212, v169, v161, s76
    v_perm_b32 v213, v169, v161, s77
    v_perm_b32 v214, v170, v162, s76
    v_perm_b32 v215, v170, v162, s77
    v_perm_b32 v216, v171, v163, s76
    v_perm_b32 v217, v171, v163, s77
    v_perm_b32 v218, v107, v105, s76
    v_perm_b32 v219, v107, v105, s77
    v_dot2_f32_bf16 v28, v202, v19, v28
    v_dot2_f32_bf16 v29, v203, v19, v29
    v_dot2_f32_bf16 v30, v204, v19, v30
    v_dot2_f32_bf16 v31, v205, v19, v31
    v_dot2_f32_bf16 v32, v206, v19, v32
    v_dot2_f32_bf16 v33, v207, v19, v33
    v_dot2_f32_bf16 v34, v208, v19, v34
    v_dot2_f32_bf16 v35, v209, v19, v35
    v_dot2_f32_bf16 v36, v210, v19, v36
    v_dot2_f32_bf16 v37, v211, v19, v37
    v_dot2_f32_bf16 v38, v212, v19, v38
    v_dot2_f32_bf16 v39, v213, v19, v39
    v_dot2_f32_bf16 v40, v214, v19, v40
    v_dot2_f32_bf16 v41, v215, v19, v41
    v_dot2_f32_bf16 v42, v216, v19, v42
    v_dot2_f32_bf16 v43, v217, v19, v43
    v_dot2_f32_bf16 v44, v218, v19, v44
    v_dot2_f32_bf16 v45, v219, v19, v45
    v_lshrrev_b32 v2, 5, v15
    v_mul_u32_u24 v2, 36864, v2
    v_and_b32 v3, 31, v15
    v_lshl_add_u32 v20, v3, 4, v2
    s_lshr_b32 s76, s73, 1
    s_mul_i32 s76, s76, 9
    s_and_b32 s77, s73, 1
    s_lshl_b32 s78, s77, 2
    s_add_u32 s78, s78, s76
    s_lshl_b32 s79, s80, 1
    s_add_u32 s78, s78, s79
    s_lshl_b32 s78, s78, 9
    s_add_u32 s78, s78, 4718592
    s_add_u32 s76, s76, 8
    s_lshl_b32 s76, s76, 9
    s_lshl_b32 s77, s77, 3
    s_add_u32 s76, s76, s77
    s_lshl_b32 s77, s80, 2
    s_add_u32 s76, s76, s77
    s_add_u32 s76, s76, 4718592
    v_cvt_pk_bf16_f32 v48, v28, v29
    v_cvt_pk_bf16_f32 v49, v30, v31
    v_cvt_pk_bf16_f32 v50, v32, v33
    v_cvt_pk_bf16_f32 v51, v34, v35
    v_cvt_pk_bf16_f32 v52, v36, v37
    v_cvt_pk_bf16_f32 v53, v38, v39
    v_cvt_pk_bf16_f32 v54, v40, v41
    v_cvt_pk_bf16_f32 v55, v42, v43
    v_cvt_pk_bf16_f32 v56, v44, v45
    buffer_store_dwordx4 v[48:51], v20, s[8:11], s78 offen sc1
    buffer_store_dwordx4 v[52:55], v20, s[8:11], s78 offen offset:512 sc1
    buffer_store_dword v56, v20, s[8:11], s76 offen sc1
    s_mul_i32 s76, s72, 4352
    s_lshl_b32 s77, s73, 2
    s_add_u32 s76, s76, s77
    s_add_u32 s76, s76, 9699712
    s_waitcnt vmcnt(0)
    s_barrier
    s_cmp_lg_u32 s3, 0
    s_cbranch_scc1 KM_nf5
    v_mov_b32 v2, 1
    v_mov_b32 v3, 0
    s_mov_b64 exec, 1
    buffer_store_dword v2, v3, s[8:11], s76 offen sc1
    s_mov_b64 exec, -1
KM_nf5:
    s_branch KM_B
KM_done:
KM_end:
    s_endpgm
KM_slowH1:
    s_sleep 4
    buffer_load_dword v254, v14, s[8:11], s89 offen sc1
    s_add_u32 s55, s55, 1
    s_waitcnt vmcnt(0)
    v_cmp_gt_u32 vcc, 1, v254
    s_cbranch_vccz KM_backH1
    s_cmp_lt_u32 s55, 262144
    s_cbranch_scc1 KM_slowH1
    s_branch KM_backH1
KM_slowH2:
    s_sleep 4
    buffer_load_dword v254, v14, s[8:11], s89 offen sc1
    s_add_u32 s55, s55, 1
    s_waitcnt vmcnt(0)
    v_cmp_gt_u32 vcc, 2, v254
    s_cbranch_vccz KM_backH2
    s_cmp_lt_u32 s55, 262144
    s_cbranch_scc1 KM_slowH2
    s_branch KM_backH2
KM_slowP:
    s_sleep 8
    buffer_load_dword v100, v11, s[8:11], s50 offen sc1
    s_add_u32 s55, s55, 1
    s_waitcnt vmcnt(0)
    v_cmp_eq_u32 vcc, 0, v100
    s_cbranch_vccz KM_backP
    s_cmp_lt_u32 s55, 262144
    s_cbranch_scc1 KM_slowP
    s_branch KM_backP
.p2align 4
CODE_END:
.section .rodata,"a"
.p2align 6
.amdhsa_kernel k0_kernel
  .amdhsa_next_free_vgpr 96
  .amdhsa_next_free_sgpr 72
  .amdhsa_accum_offset 96
  .amdhsa_group_segment_fixed_size 0
  .amdhsa_kernarg_size 88
  .amdhsa_user_sgpr_count 2
  .amdhsa_user_sgpr_kernarg_segment_ptr 1
  .amdhsa_system_sgpr_workgroup_id_x 1
.end_amdhsa_kernel
.p2align 6
.amdhsa_kernel km_kernel
  .amdhsa_next_free_vgpr 512
  .amdhsa_next_free_sgpr 102
  .amdhsa_accum_offset 256
  .amdhsa_group_segment_fixed_size 0
  .amdhsa_kernarg_size 88
  .amdhsa_user_sgpr_count 2
  .amdhsa_user_sgpr_kernarg_segment_ptr 1
  .amdhsa_system_sgpr_workgroup_id_x 1
.end_amdhsa_kernel
```
